```python
import torch

def _softmax(x, axis=-1):
    return torch.softmax(x, dim=axis)
def _gelu(x):
    return torch.nn.functional.gelu(x, approximate="tanh")
def _silu(x):
    return torch.nn.functional.silu(x)
def _sigmoid(x):
    return torch.sigmoid(x)
def _layernorm(x, axis=-1, eps=1e-5):
    m = x.mean(dim=axis, keepdim=True)
    v = x.var(dim=axis, keepdim=True, unbiased=False)
    return (x - m) / torch.sqrt(v + eps)
def _scatter_add(tgt, idx, src, axis=0):
    return tgt.clone().index_add_(axis, idx, src)
def _segment_sum(src, seg, n):
    out = torch.zeros((n,) + src.shape[1:], dtype=src.dtype)
    return out.index_add_(0, seg, src)
def _pad(x, pw):
    flat = tuple(v for pair in reversed(pw) for v in pair)
    return torch.nn.functional.pad(x, flat)

kernel_name = 'sequential_preLN__sliding_block__mixer_token_mlp__prompt'

def setup_inputs():

    _w = (lambda a: (lambda t: t.to(torch.bfloat16) if t.is_floating_point() else t)(torch.as_tensor(a)))
    def _A_setup():
        B, S, D = 1, 2048, 448
        return {
            "x": _w((lambda *s: torch.randn(*s, dtype=torch.bfloat16) * 0.05)(B, S, D)),
            "wqkv": _w((lambda *s: torch.randn(*s, dtype=torch.bfloat16) * 0.05)(D, 3 * D)),
            "wo": _w((lambda *s: torch.randn(*s, dtype=torch.bfloat16) * 0.05)(D, D)),
        }
    _A_in = _A_setup()

    def _B_setup():
        B, S, D, F = 1, 2048, 448, 1792
        return {
            "x": _w((lambda *s: torch.randn(*s, dtype=torch.bfloat16) * 0.05)(B, S, D)),
            "w1": _w((lambda *s: torch.randn(*s, dtype=torch.bfloat16) * 1.6)(S, F) * (S ** -0.5)),
            "b1": _w((lambda *s: torch.randn(*s, dtype=torch.bfloat16) * 1.6)(F) * 0.02),
            "w2": _w((lambda *s: torch.randn(*s, dtype=torch.bfloat16) * 0.2)(F, S) * (F ** -0.5)),
            "b2": _w((lambda *s: torch.randn(*s, dtype=torch.bfloat16) * 0.2)(S) * 0.02),
        }
    _B_in = _B_setup()

    return {
        "A_x": _A_in["x"],
        "A_wqkv": _A_in["wqkv"],
        "A_wo": _A_in["wo"],
        "B_x": _B_in["x"],
        "B_w1": _B_in["w1"],
        "B_b1": _B_in["b1"],
        "B_w2": _B_in["w2"],
        "B_b2": _B_in["b2"],
    }

def reference(A_x, A_wqkv, A_wo, B_x, B_w1, B_b1, B_w2, B_b2):
    def _A_ref(x, wqkv, wo):
        B, S, D = x.shape
        H = 16; Dh = D // H; W = 256
        qkv = (lambda x, *d: x.permute(*d))((x @ wqkv).reshape(B, S, 3, H, Dh), 2, 0, 3, 1, 4)
        q, k, v = qkv[0], qkv[1], qkv[2]
        scores = torch.einsum("bhqd,bhkd->bhqk", q, k) * (Dh ** -0.5)
        idx = torch.arange(S)
        mask = (idx[:, None] - idx[None, :] >= 0) & (idx[:, None] - idx[None, :] < W)
        scores = torch.where(mask[None, None], scores, -1e9)
        p = _softmax(scores, axis=-1)
        o = torch.einsum("bhqk,bhkd->bhqd", p, v)
        return (lambda x, *d: x.permute(*d))(o, 0, 2, 1, 3).reshape(B, S, D) @ wo

    def _B_ref(x, w1, b1, w2, b2):
        B, S, D = x.shape
        h = _layernorm(x, axis=-1)
        u = torch.einsum("bsd,sf->bdf", h, w1) + b1
        u = _gelu(u)
        y = torch.einsum("bdf,fs->bds", u, w2) + b2
        return (lambda x, *d: x.permute(*d))(y, 0, 2, 1)

    x = A_x
    h = x + _A_ref(_layernorm(x, axis=-1), A_wqkv, A_wo)
    h2 = h + _B_ref(_layernorm(h, axis=-1), B_w1, B_b1, B_w2, B_b2)
    return h2
```

```asm
; @launch grid=(256,1,1) block=(256,1,1) lds=163840
.amdgcn_target "amdgcn-amd-amdhsa--gfx950"
.text
.globl sequential_preLN__sliding_block__mixer_token_mlp__prompt_kernel
.p2align 8
.type sequential_preLN__sliding_block__mixer_token_mlp__prompt_kernel,@function
sequential_preLN__sliding_block__mixer_token_mlp__prompt_kernel:
    s_cmp_ge_u32 s2, 256
    s_cbranch_scc1 sequential_preLN__sliding_block__mixer_token_mlp__prompt_kernel_done
    s_load_dwordx4 s[8:11], s[0:1], 0
    s_load_dwordx2 s[4:5], s[0:1], 80
    s_load_dwordx4 s[16:19], s[0:1], 32
    s_load_dwordx4 s[20:23], s[0:1], 48
    s_load_dwordx2 s[24:25], s[0:1], 16
    s_load_dwordx4 s[96:99], s[0:1], 64
    v_lshrrev_b32 v18, 6, v0
    v_and_b32 v1, 63, v0
    v_readfirstlane_b32 s36, v18
    s_and_b32 s42, s2, 7
    s_lshr_b32 s43, s2, 3
    s_lshr_b32 s41, s42, 1
    s_lshl_b32 s41, s41, 2
    s_and_b32 s40, s43, 3
    s_add_u32 s41, s41, s40
    s_and_b32 s40, s42, 1
    s_lshl_b32 s40, s40, 3
    s_lshr_b32 s43, s43, 2
    s_add_u32 s40, s40, s43
    s_and_b32 s42, s40, 7
    s_cmp_eq_u32 s42, 7
    s_cselect_b32 s42, 3, s42
    s_lshl_b32 s37, s42, 7
    s_add_u32 s42, s42, 1
    s_cmp_eq_u32 s42, 7
    s_cselect_b32 s42, 0, s42
    s_lshl_b32 s38, s42, 7
    s_add_u32 s42, s42, 1
    s_cmp_eq_u32 s42, 7
    s_cselect_b32 s42, 0, s42
    s_lshl_b32 s39, s42, 7
    s_add_u32 s42, s42, 1
    s_cmp_eq_u32 s42, 7
    s_cselect_b32 s42, 0, s42
    s_lshl_b32 s47, s42, 7
    s_add_u32 s42, s42, 1
    s_cmp_eq_u32 s42, 7
    s_cselect_b32 s42, 0, s42
    s_lshl_b32 s48, s42, 7
    s_add_u32 s42, s42, 1
    s_cmp_eq_u32 s42, 7
    s_cselect_b32 s42, 0, s42
    s_lshl_b32 s49, s42, 7
    s_add_u32 s42, s42, 1
    s_cmp_eq_u32 s42, 7
    s_cselect_b32 s42, 0, s42
    s_lshl_b32 s50, s42, 7
    s_mul_i32 s42, s40, 56
    s_and_b32 s43, s40, 1
    s_lshl_b32 s43, s43, 3
    s_sub_u32 s42, s42, s43
    s_mul_i32 s43, s36, 43008
    s_add_u32 s42, s42, s43
    v_lshrrev_b32 v18, 2, v1
    v_mul_u32_u24 v18, 2688, v18
    v_and_b32 v19, 3, v1
    v_lshlrev_b32 v19, 4, v19
    v_add3_u32 v4, v18, v19, s42
    s_lshl_b32 s42, s41, 2
    s_add_u32 s42, s42, s36
    s_mul_i32 s42, s42, 28672
    v_lshrrev_b32 v18, 3, v1
    v_mul_u32_u24 v18, 896, v18
    v_lshrrev_b32 v19, 4, v1
    v_and_b32 v20, 7, v1
    v_xor_b32 v19, v19, v20
    v_lshlrev_b32 v19, 4, v19
    v_add3_u32 v5, v18, v19, s42
    v_xor_b32 v19, 64, v19
    v_add3_u32 v6, v18, v19, s42
    v_add_u32 v7, 12288, v5
    v_add_u32 v6, 6144, v6
    v_add_u32 v8, 12288, v6
    s_mul_i32 s44, s36, 3072
    s_lshl_b32 s45, s36, 14
    s_add_u32 s45, s45, 89600
    s_waitcnt lgkmcnt(0)
    s_mov_b32 s28, s8
    s_mov_b32 s29, s9
    s_mov_b32 s30, 1835008
    s_mov_b32 s31, 0x00020000
    s_mov_b32 s32, s10
    s_mov_b32 s33, s11
    s_mov_b32 s34, 1204224
    s_mov_b32 s35, 0x00020000
    s_mov_b32 s12, s4
    s_mov_b32 s13, s5
    s_mov_b32 s14, 16777216
    s_mov_b32 s15, 0x00020000
    s_mov_b32 s84, s98
    s_mov_b32 s85, s99
    s_mov_b32 s86, 256
    s_mov_b32 s87, 0x00020000
    s_lshl2_add_u32 s3, s2, s36
    v_lshlrev_b32 v240, 4, v1
    s_cmp_lg_u32 s3, 0
    s_cbranch_scc1 k1z_1
    v_mov_b32 v236, 0
    v_mov_b32 v237, 0
    v_mov_b32 v238, 0
    v_mov_b32 v239, 0
    s_mov_b32 s83, 15204352
    buffer_store_dwordx4 v[236:239], v240, s[12:15], s83 offen offset:0 sc1
    buffer_store_dwordx4 v[236:239], v240, s[12:15], s83 offen offset:1024 sc1
    buffer_store_dwordx4 v[236:239], v240, s[12:15], s83 offen offset:2048 sc1
    buffer_store_dwordx4 v[236:239], v240, s[12:15], s83 offen offset:3072 sc1
    s_mov_b32 s83, 15208448
    buffer_store_dwordx4 v[236:239], v240, s[12:15], s83 offen offset:0 sc1
    buffer_store_dwordx4 v[236:239], v240, s[12:15], s83 offen offset:1024 sc1
    buffer_store_dwordx4 v[236:239], v240, s[12:15], s83 offen offset:2048 sc1
    buffer_store_dwordx4 v[236:239], v240, s[12:15], s83 offen offset:3072 sc1
    s_mov_b32 s83, 15212544
    buffer_store_dwordx4 v[236:239], v240, s[12:15], s83 offen offset:0 sc1
    buffer_store_dwordx4 v[236:239], v240, s[12:15], s83 offen offset:1024 sc1
    buffer_store_dwordx4 v[236:239], v240, s[12:15], s83 offen offset:2048 sc1
    buffer_store_dwordx4 v[236:239], v240, s[12:15], s83 offen offset:3072 sc1
    s_mov_b32 s83, 15216640
    buffer_store_dwordx4 v[236:239], v240, s[12:15], s83 offen offset:0 sc1
    buffer_store_dwordx4 v[236:239], v240, s[12:15], s83 offen offset:1024 sc1
    buffer_store_dwordx4 v[236:239], v240, s[12:15], s83 offen offset:2048 sc1
    buffer_store_dwordx4 v[236:239], v240, s[12:15], s83 offen offset:3072 sc1
    s_mov_b32 s83, 15220736
    buffer_store_dwordx4 v[236:239], v240, s[12:15], s83 offen offset:0 sc1
    buffer_store_dwordx4 v[236:239], v240, s[12:15], s83 offen offset:1024 sc1
    buffer_store_dwordx4 v[236:239], v240, s[12:15], s83 offen offset:2048 sc1
    buffer_store_dwordx4 v[236:239], v240, s[12:15], s83 offen offset:3072 sc1
    s_mov_b32 s83, 15224832
    buffer_store_dwordx4 v[236:239], v240, s[12:15], s83 offen offset:0 sc1
    buffer_store_dwordx4 v[236:239], v240, s[12:15], s83 offen offset:1024 sc1
    buffer_store_dwordx4 v[236:239], v240, s[12:15], s83 offen offset:2048 sc1
    buffer_store_dwordx4 v[236:239], v240, s[12:15], s83 offen offset:3072 sc1
    s_mov_b32 s83, 15228928
    buffer_store_dwordx4 v[236:239], v240, s[12:15], s83 offen offset:0 sc1
    buffer_store_dwordx4 v[236:239], v240, s[12:15], s83 offen offset:1024 sc1
    buffer_store_dwordx4 v[236:239], v240, s[12:15], s83 offen offset:2048 sc1
    buffer_store_dwordx4 v[236:239], v240, s[12:15], s83 offen offset:3072 sc1
    s_mov_b32 s83, 15233024
    buffer_store_dwordx4 v[236:239], v240, s[12:15], s83 offen offset:0 sc1
    buffer_store_dwordx4 v[236:239], v240, s[12:15], s83 offen offset:1024 sc1
    buffer_store_dwordx4 v[236:239], v240, s[12:15], s83 offen offset:2048 sc1
    buffer_store_dwordx4 v[236:239], v240, s[12:15], s83 offen offset:3072 sc1
k1z_1:
    s_mul_i32 s82, s40, 147456
    s_lshl2_add_u32 s42, s41, s36
    s_lshl_b32 s42, s42, 11
    s_add_u32 s82, s82, s42
    s_add_u32 s83, s82, 4734976
    s_add_u32 s82, s82, 2113536
    v_mov_b32 v236, -1
    v_mov_b32 v237, -1
    v_mov_b32 v238, -1
    v_mov_b32 v239, -1
    buffer_store_dwordx4 v[236:239], v240, s[12:15], s82 offen offset:0 sc1
    buffer_store_dwordx4 v[236:239], v240, s[12:15], s82 offen offset:1024 sc1
    buffer_store_dwordx4 v[236:239], v240, s[12:15], s83 offen offset:0 sc1
    buffer_store_dwordx4 v[236:239], v240, s[12:15], s83 offen offset:1024 sc1
    s_add_u32 m0, s45, 0
    s_nop 0
    buffer_load_dwordx4 v5, s[28:31], s37 offen offset:0 lds
    buffer_load_dwordx4 v6, s[28:31], s37 offen offset:1024 lds
    buffer_load_dwordx4 v7, s[28:31], s37 offen offset:2048 lds
    buffer_load_dwordx4 v8, s[28:31], s37 offen offset:3072 lds
    s_mul_i32 s46, s37, 1344
    s_add_u32 m0, s44, 0
    s_nop 0
    buffer_load_dwordx4 v4, s[32:35], s46 offen offset:0 lds
    s_add_u32 m0, s44, 128
    s_nop 0
    buffer_load_dwordx4 v4, s[32:35], s46 offen offset:896 lds
    s_add_u32 m0, s44, 256
    s_nop 0
    buffer_load_dwordx4 v4, s[32:35], s46 offen offset:1792 lds
    s_add_u32 m0, s45, 4096
    s_nop 0
    buffer_load_dwordx4 v5, s[28:31], s38 offen offset:0 lds
    buffer_load_dwordx4 v6, s[28:31], s38 offen offset:1024 lds
    buffer_load_dwordx4 v7, s[28:31], s38 offen offset:2048 lds
    buffer_load_dwordx4 v8, s[28:31], s38 offen offset:3072 lds
    s_mul_i32 s46, s38, 1344
    s_add_u32 m0, s44, 12800
    s_nop 0
    buffer_load_dwordx4 v4, s[32:35], s46 offen offset:0 lds
    s_add_u32 m0, s44, 12928
    s_nop 0
    buffer_load_dwordx4 v4, s[32:35], s46 offen offset:896 lds
    s_add_u32 m0, s44, 13056
    s_nop 0
    buffer_load_dwordx4 v4, s[32:35], s46 offen offset:1792 lds
    s_cmp_lg_u32 s3, 0
    s_cbranch_scc1 k1go_2
    v_mov_b32 v242, -1
    s_waitcnt vmcnt(18)
    s_mov_b64 exec, 1
    buffer_store_dword v242, off, s[84:87], 0 sc1
    s_mov_b64 exec, -1
k1go_2:
    v_lshrrev_b32 v2, 5, v1
    v_and_b32 v3, 31, v1
    v_lshrrev_b32 v18, 5, v0
    v_mul_u32_u24 v18, 12800, v18
    v_lshl_add_u32 v18, v3, 4, v18
    v_mov_b32 v28, 0x3f803f80
    v_mov_b32 v29, 0x3f803f80
    v_mov_b32 v30, 0x3f803f80
    v_mov_b32 v31, 0x3f803f80
    v_cmp_gt_u32 vcc, 224, v0
    s_and_saveexec_b64 s[58:59], vcc
    ds_write_b128 v18, v[28:31] offset:12288
    s_mov_b64 exec, s[58:59]
    v_bfe_u32 v18, v1, 1, 3
    v_xor_b32 v18, v18, v2
    v_lshlrev_b32 v18, 4, v18
    v_lshl_add_u32 v19, v3, 7, s45
    v_xor_b32 v20, 0, v18
    v_add_u32 v9, v20, v19
    v_xor_b32 v20, 32, v18
    v_add_u32 v10, v20, v19
    v_xor_b32 v20, 64, v18
    v_add_u32 v11, v20, v19
    v_xor_b32 v20, 96, v18
    v_add_u32 v12, v20, v19
    v_bfe_u32 v18, v1, 2, 2
    v_lshlrev_b32 v18, 6, v18
    v_bfe_u32 v19, v1, 4, 1
    v_and_b32 v20, 3, v1
    v_lshlrev_b32 v20, 3, v20
    v_lshl_add_u32 v19, v19, 5, v20
    v_add_u32 v18, v18, v19
    v_lshl_add_u32 v17, v2, 9, v18
    v_add_u32 v18, 12288, v18
    s_and_b32 s42, s40, 1
    s_cmp_eq_u32 s42, 1
    s_cselect_b32 s43, 0, 0x13
    s_cselect_b64 s[52:53], -1, 0
    s_cselect_b32 s54, -1, 0
    s_mov_b32 s55, 0
    s_mov_b32 s56, 0
    s_cselect_b32 s57, 0, -1
    s_cselect_b32 s70, 0x0000000f, 0xf0000000
    s_mov_b32 s71, s70
    v_and_b32 v19, 0x13, v1
    v_cmp_eq_u32 vcc, s43, v19
    s_nop 0
    v_add_u32 v20, 0, v17
    v_cndmask_b32 v13, v20, v18, vcc
    v_add_u32 v20, 3072, v17
    v_cndmask_b32 v14, v20, v18, vcc
    v_add_u32 v20, 6144, v17
    v_cndmask_b32 v15, v20, v18, vcc
    v_add_u32 v20, 9216, v17
    v_cndmask_b32 v16, v20, v18, vcc
    v_and_b32 v18, 15, v1
    v_bfe_u32 v19, v1, 4, 1
    v_cmp_eq_u32 vcc, v18, v19
    s_waitcnt lgkmcnt(0)
    s_nop 1
    v_cndmask_b32 v28, 0, v28, vcc
    v_cndmask_b32 v29, 0, v29, vcc
    v_cndmask_b32 v30, 0, v30, vcc
    v_cndmask_b32 v31, 0, v31, vcc
    s_mov_b32 s72, 0xaaaaaaaa
    s_mov_b32 s73, 0xaaaaaaaa
    s_mov_b32 s74, 0xcccccccc
    s_mov_b32 s75, 0xcccccccc
    s_mov_b32 s76, 0xff00ff00
    s_mov_b32 s77, 0xff00ff00
    s_mov_b32 s78, 0xffff0000
    s_mov_b32 s79, 0xffff0000
    s_mov_b32 s80, 0xf0f0f0f0
    s_mov_b32 s81, 0xf0f0f0f0
    s_lshl_b32 s94, s2, 2
    s_add_u32 s94, s94, s36
    v_mov_b32 v236, -1
    v_mov_b32 v237, -1
    v_mov_b32 v238, -1
    v_mov_b32 v239, -1
    v_lshlrev_b32 v240, 4, v1
    v_lshlrev_b32 v241, 2, v1
    v_lshlrev_b32 v241, 6, v1
    s_mul_i32 s51, s36, 4096
    s_add_u32 s51, s51, 15204352
    s_waitcnt vmcnt(7)
    s_barrier
    ds_read_b128 v[108:111], v9 offset:0
    ds_read_b128 v[112:115], v10 offset:0
    ds_read_b64_tr_b16 v[140:141], v13 offset:0
    ds_read_b64_tr_b16 v[142:143], v13 offset:256
    ds_read_b64_tr_b16 v[144:145], v17 offset:1024
    ds_read_b64_tr_b16 v[146:147], v17 offset:1280
    ds_read_b64_tr_b16 v[148:149], v17 offset:2048
    ds_read_b64_tr_b16 v[150:151], v17 offset:2304
    ds_read_b128 v[116:119], v11 offset:0
    ds_read_b128 v[120:123], v12 offset:0
    s_waitcnt lgkmcnt(8)
    v_mfma_f32_32x32x16_bf16 v[92:107], v[108:111], v[108:111], 0
    s_waitcnt lgkmcnt(2)
    ds_read_b64_tr_b16 v[152:153], v14 offset:0
    ds_read_b64_tr_b16 v[154:155], v14 offset:256
    v_mfma_f32_32x32x16_bf16 v[44:59], v[140:143], v[108:111], 0
    ds_read_b64_tr_b16 v[156:157], v17 offset:4096
    ds_read_b64_tr_b16 v[158:159], v17 offset:4352
    s_mul_i32 s46, s39, 1344
    s_add_u32 m0, s44, 25600
    s_nop 0
    buffer_load_dwordx4 v4, s[32:35], s46 offen offset:0 lds
    v_mfma_f32_32x32x16_bf16 v[60:75], v[144:147], v[108:111], 0
    ds_read_b64_tr_b16 v[160:161], v17 offset:5120
    ds_read_b64_tr_b16 v[162:163], v17 offset:5376
    v_mfma_f32_32x32x16_bf16 v[76:91], v[108:111], v[148:151], 0
    s_add_u32 m0, s45, 8192
    s_nop 0
    buffer_load_dwordx4 v5, s[28:31], s39 offen offset:0 lds
    s_cmp_lg_u32 s36, 0
    s_cbranch_scc1 k1cs_3
    v_mfma_f32_16x16x32_bf16 v[32:35], v[28:31], v[140:143], 0
    v_mfma_f32_16x16x32_bf16 v[36:39], v[28:31], v[144:147], 0
    v_mfma_f32_16x16x32_bf16 v[40:43], v[28:31], v[148:151], 0
k1cs_3:
    v_mfma_f32_32x32x16_bf16 v[92:107], v[112:115], v[112:115], v[92:107]
    s_waitcnt lgkmcnt(0)
    ds_read_b64_tr_b16 v[140:141], v15 offset:0
    ds_read_b64_tr_b16 v[142:143], v15 offset:256
    v_mfma_f32_32x32x16_bf16 v[44:59], v[152:155], v[112:115], v[44:59]
    ds_read_b64_tr_b16 v[144:145], v17 offset:7168
    ds_read_b64_tr_b16 v[146:147], v17 offset:7424
    s_add_u32 m0, s44, 25728
    s_nop 0
    buffer_load_dwordx4 v4, s[32:35], s46 offen offset:896 lds
    v_mfma_f32_32x32x16_bf16 v[60:75], v[156:159], v[112:115], v[60:75]
    ds_read_b64_tr_b16 v[148:149], v17 offset:8192
    ds_read_b64_tr_b16 v[150:151], v17 offset:8448
    v_mfma_f32_32x32x16_bf16 v[76:91], v[112:115], v[160:163], v[76:91]
    s_add_u32 m0, s45, 8192
    s_nop 0
    buffer_load_dwordx4 v6, s[28:31], s39 offen offset:1024 lds
    s_cmp_lg_u32 s36, 1
    s_cbranch_scc1 k1cs_4
    v_mfma_f32_16x16x32_bf16 v[32:35], v[28:31], v[152:155], 0
    v_mfma_f32_16x16x32_bf16 v[36:39], v[28:31], v[156:159], 0
    v_mfma_f32_16x16x32_bf16 v[40:43], v[28:31], v[160:163], 0
k1cs_4:
    v_mfma_f32_32x32x16_bf16 v[92:107], v[116:119], v[116:119], v[92:107]
    s_waitcnt lgkmcnt(0)
    ds_read_b64_tr_b16 v[152:153], v16 offset:0
    ds_read_b64_tr_b16 v[154:155], v16 offset:256
    v_mfma_f32_32x32x16_bf16 v[44:59], v[140:143], v[116:119], v[44:59]
    ds_read_b64_tr_b16 v[156:157], v17 offset:10240
    ds_read_b64_tr_b16 v[158:159], v17 offset:10496
    s_add_u32 m0, s44, 25856
    s_nop 0
    buffer_load_dwordx4 v4, s[32:35], s46 offen offset:1792 lds
    v_mfma_f32_32x32x16_bf16 v[60:75], v[144:147], v[116:119], v[60:75]
    ds_read_b64_tr_b16 v[160:161], v17 offset:11264
    ds_read_b64_tr_b16 v[162:163], v17 offset:11520
    v_mfma_f32_32x32x16_bf16 v[76:91], v[116:119], v[148:151], v[76:91]
    s_add_u32 m0, s45, 8192
    s_nop 0
    buffer_load_dwordx4 v7, s[28:31], s39 offen offset:2048 lds
    s_cmp_lg_u32 s36, 2
    s_cbranch_scc1 k1cs_5
    v_mfma_f32_16x16x32_bf16 v[32:35], v[28:31], v[140:143], 0
    v_mfma_f32_16x16x32_bf16 v[36:39], v[28:31], v[144:147], 0
    v_mfma_f32_16x16x32_bf16 v[40:43], v[28:31], v[148:151], 0
k1cs_5:
    v_mfma_f32_32x32x16_bf16 v[92:107], v[120:123], v[120:123], v[92:107]
    s_waitcnt vmcnt(6)
    s_waitcnt lgkmcnt(0)
    s_barrier
    ds_read_b128 v[124:127], v9 offset:4096
    ds_read_b128 v[128:131], v10 offset:4096
    ds_read_b64_tr_b16 v[140:141], v13 offset:12800
    ds_read_b64_tr_b16 v[142:143], v13 offset:13056
    v_mfma_f32_32x32x16_bf16 v[44:59], v[152:155], v[120:123], v[44:59]
    ds_read_b64_tr_b16 v[144:145], v17 offset:13824
    ds_read_b64_tr_b16 v[146:147], v17 offset:14080
    v_mfma_f32_32x32x16_bf16 v[60:75], v[156:159], v[120:123], v[60:75]
    ds_read_b64_tr_b16 v[148:149], v17 offset:14848
    ds_read_b64_tr_b16 v[150:151], v17 offset:15104
    ds_read_b128 v[132:135], v11 offset:4096
    ds_read_b128 v[136:139], v12 offset:4096
    v_mfma_f32_32x32x16_bf16 v[76:91], v[120:123], v[160:163], v[76:91]
    s_add_u32 m0, s45, 8192
    s_nop 0
    buffer_load_dwordx4 v8, s[28:31], s39 offen offset:3072 lds
    buffer_load_dword v242, off, s[84:87], 0 sc1
    s_cmp_lg_u32 s36, 3
    s_cbranch_scc1 k1cs_6
    v_mfma_f32_16x16x32_bf16 v[32:35], v[28:31], v[152:155], 0
    v_mfma_f32_16x16x32_bf16 v[36:39], v[28:31], v[156:159], 0
    v_mfma_f32_16x16x32_bf16 v[40:43], v[28:31], v[160:163], 0
k1cs_6:
    s_waitcnt lgkmcnt(8)
    v_mfma_f32_32x32x16_bf16 v[92:107], v[124:127], v[124:127], v[92:107]
    s_waitcnt lgkmcnt(2)
    ds_read_b64_tr_b16 v[152:153], v14 offset:12800
    ds_read_b64_tr_b16 v[154:155], v14 offset:13056
    v_mfma_f32_32x32x16_bf16 v[44:59], v[140:143], v[124:127], v[44:59]
    ds_read_b64_tr_b16 v[156:157], v17 offset:16896
    ds_read_b64_tr_b16 v[158:159], v17 offset:17152
    s_mul_i32 s46, s47, 1344
    s_add_u32 m0, s44, 38400
    s_nop 0
    buffer_load_dwordx4 v4, s[32:35], s46 offen offset:0 lds
    v_mfma_f32_32x32x16_bf16 v[60:75], v[144:147], v[124:127], v[60:75]
    ds_read_b64_tr_b16 v[160:161], v17 offset:17920
    ds_read_b64_tr_b16 v[162:163], v17 offset:18176
    v_mfma_f32_32x32x16_bf16 v[76:91], v[124:127], v[148:151], v[76:91]
    s_add_u32 m0, s45, 12288
    s_nop 0
    buffer_load_dwordx4 v5, s[28:31], s47 offen offset:0 lds
    s_cmp_lg_u32 s36, 0
    s_cbranch_scc1 k1cs_7
    v_mfma_f32_16x16x32_bf16 v[32:35], v[28:31], v[140:143], v[32:35]
    v_mfma_f32_16x16x32_bf16 v[36:39], v[28:31], v[144:147], v[36:39]
    v_mfma_f32_16x16x32_bf16 v[40:43], v[28:31], v[148:151], v[40:43]
k1cs_7:
    v_mfma_f32_32x32x16_bf16 v[92:107], v[128:131], v[128:131], v[92:107]
    s_waitcnt lgkmcnt(0)
    ds_read_b64_tr_b16 v[140:141], v15 offset:12800
    ds_read_b64_tr_b16 v[142:143], v15 offset:13056
    v_mfma_f32_32x32x16_bf16 v[44:59], v[152:155], v[128:131], v[44:59]
    ds_read_b64_tr_b16 v[144:145], v17 offset:19968
    ds_read_b64_tr_b16 v[146:147], v17 offset:20224
    s_add_u32 m0, s44, 38528
    s_nop 0
    buffer_load_dwordx4 v4, s[32:35], s46 offen offset:896 lds
    v_mfma_f32_32x32x16_bf16 v[60:75], v[156:159], v[128:131], v[60:75]
    ds_read_b64_tr_b16 v[148:149], v17 offset:20992
    ds_read_b64_tr_b16 v[150:151], v17 offset:21248
    v_mfma_f32_32x32x16_bf16 v[76:91], v[128:131], v[160:163], v[76:91]
    s_add_u32 m0, s45, 12288
    s_nop 0
    buffer_load_dwordx4 v6, s[28:31], s47 offen offset:1024 lds
    s_cmp_lg_u32 s36, 1
    s_cbranch_scc1 k1cs_8
    v_mfma_f32_16x16x32_bf16 v[32:35], v[28:31], v[152:155], v[32:35]
    v_mfma_f32_16x16x32_bf16 v[36:39], v[28:31], v[156:159], v[36:39]
    v_mfma_f32_16x16x32_bf16 v[40:43], v[28:31], v[160:163], v[40:43]
k1cs_8:
    v_mfma_f32_32x32x16_bf16 v[92:107], v[132:135], v[132:135], v[92:107]
    s_waitcnt lgkmcnt(0)
    ds_read_b64_tr_b16 v[152:153], v16 offset:12800
    ds_read_b64_tr_b16 v[154:155], v16 offset:13056
    v_mfma_f32_32x32x16_bf16 v[44:59], v[140:143], v[132:135], v[44:59]
    ds_read_b64_tr_b16 v[156:157], v17 offset:23040
    ds_read_b64_tr_b16 v[158:159], v17 offset:23296
    s_add_u32 m0, s44, 38656
    s_nop 0
    buffer_load_dwordx4 v4, s[32:35], s46 offen offset:1792 lds
    v_mfma_f32_32x32x16_bf16 v[60:75], v[144:147], v[132:135], v[60:75]
    ds_read_b64_tr_b16 v[160:161], v17 offset:24064
    ds_read_b64_tr_b16 v[162:163], v17 offset:24320
    v_mfma_f32_32x32x16_bf16 v[76:91], v[132:135], v[148:151], v[76:91]
    s_add_u32 m0, s45, 12288
    s_nop 0
    buffer_load_dwordx4 v7, s[28:31], s47 offen offset:2048 lds
    s_cmp_lg_u32 s36, 2
    s_cbranch_scc1 k1cs_9
    v_mfma_f32_16x16x32_bf16 v[32:35], v[28:31], v[140:143], v[32:35]
    v_mfma_f32_16x16x32_bf16 v[36:39], v[28:31], v[144:147], v[36:39]
    v_mfma_f32_16x16x32_bf16 v[40:43], v[28:31], v[148:151], v[40:43]
k1cs_9:
    v_mfma_f32_32x32x16_bf16 v[92:107], v[136:139], v[136:139], v[92:107]
    s_waitcnt vmcnt(6)
    s_waitcnt lgkmcnt(0)
    s_barrier
    ds_read_b128 v[108:111], v9 offset:8192
    ds_read_b128 v[112:115], v10 offset:8192
    s_cmp_lg_u32 s36, 0
    s_cbranch_scc1 k1fl_10
    s_mov_b32 s42, 0
k1lp_12:
    v_cmp_ne_u32 vcc, -1, v242
    s_cbranch_vccz k1ok_11
    buffer_load_dword v242, off, s[84:87], 0 sc1
    s_add_u32 s42, s42, 1
    s_cmp_lt_u32 s42, 20000
    s_waitcnt vmcnt(0)
    s_cbranch_scc1 k1lp_12
k1ok_11:
    s_mul_i32 s42, s2, 64
    s_add_u32 s42, s42, 15204352
    s_mov_b64 exec, 1
    buffer_store_dword v236, off, s[12:15], s42 sc1
    s_mov_b64 exec, -1
k1fl_10:
    ds_read_b64_tr_b16 v[140:141], v13 offset:25600
    ds_read_b64_tr_b16 v[142:143], v13 offset:25856
    v_mfma_f32_32x32x16_bf16 v[44:59], v[152:155], v[136:139], v[44:59]
    ds_read_b64_tr_b16 v[144:145], v17 offset:26624
    ds_read_b64_tr_b16 v[146:147], v17 offset:26880
    v_mfma_f32_32x32x16_bf16 v[60:75], v[156:159], v[136:139], v[60:75]
    ds_read_b64_tr_b16 v[148:149], v17 offset:27648
    ds_read_b64_tr_b16 v[150:151], v17 offset:27904
    ds_read_b128 v[116:119], v11 offset:8192
    ds_read_b128 v[120:123], v12 offset:8192
    v_mfma_f32_32x32x16_bf16 v[76:91], v[136:139], v[160:163], v[76:91]
    s_add_u32 m0, s45, 12288
    s_nop 0
    buffer_load_dwordx4 v8, s[28:31], s47 offen offset:3072 lds
    s_cmp_lg_u32 s36, 3
    s_cbranch_scc1 k1cs_13
    v_mfma_f32_16x16x32_bf16 v[32:35], v[28:31], v[152:155], v[32:35]
    v_mfma_f32_16x16x32_bf16 v[36:39], v[28:31], v[156:159], v[36:39]
    v_mfma_f32_16x16x32_bf16 v[40:43], v[28:31], v[160:163], v[40:43]
k1cs_13:
    s_waitcnt lgkmcnt(8)
    v_mfma_f32_32x32x16_bf16 v[92:107], v[108:111], v[108:111], v[92:107]
    s_waitcnt lgkmcnt(2)
    ds_read_b64_tr_b16 v[152:153], v14 offset:25600
    ds_read_b64_tr_b16 v[154:155], v14 offset:25856
    v_mfma_f32_32x32x16_bf16 v[44:59], v[140:143], v[108:111], v[44:59]
    ds_read_b64_tr_b16 v[156:157], v17 offset:29696
    ds_read_b64_tr_b16 v[158:159], v17 offset:29952
    s_mul_i32 s46, s48, 1344
    s_add_u32 m0, s44, 51200
    s_nop 0
    buffer_load_dwordx4 v4, s[32:35], s46 offen offset:0 lds
    v_mfma_f32_32x32x16_bf16 v[60:75], v[144:147], v[108:111], v[60:75]
    ds_read_b64_tr_b16 v[160:161], v17 offset:30720
    ds_read_b64_tr_b16 v[162:163], v17 offset:30976
    v_mfma_f32_32x32x16_bf16 v[76:91], v[108:111], v[148:151], v[76:91]
    s_add_u32 m0, s45, 0
    s_nop 0
    buffer_load_dwordx4 v5, s[28:31], s48 offen offset:0 lds
    s_cmp_lg_u32 s36, 0
    s_cbranch_scc1 k1cs_14
    v_mfma_f32_16x16x32_bf16 v[32:35], v[28:31], v[140:143], v[32:35]
    v_mfma_f32_16x16x32_bf16 v[36:39], v[28:31], v[144:147], v[36:39]
    v_mfma_f32_16x16x32_bf16 v[40:43], v[28:31], v[148:151], v[40:43]
k1cs_14:
    v_mfma_f32_32x32x16_bf16 v[92:107], v[112:115], v[112:115], v[92:107]
    s_waitcnt lgkmcnt(0)
    ds_read_b64_tr_b16 v[140:141], v15 offset:25600
    ds_read_b64_tr_b16 v[142:143], v15 offset:25856
    v_mfma_f32_32x32x16_bf16 v[44:59], v[152:155], v[112:115], v[44:59]
    ds_read_b64_tr_b16 v[144:145], v17 offset:32768
    ds_read_b64_tr_b16 v[146:147], v17 offset:33024
    s_add_u32 m0, s44, 51328
    s_nop 0
    buffer_load_dwordx4 v4, s[32:35], s46 offen offset:896 lds
    v_mfma_f32_32x32x16_bf16 v[60:75], v[156:159], v[112:115], v[60:75]
    ds_read_b64_tr_b16 v[148:149], v17 offset:33792
    ds_read_b64_tr_b16 v[150:151], v17 offset:34048
    v_mfma_f32_32x32x16_bf16 v[76:91], v[112:115], v[160:163], v[76:91]
    s_add_u32 m0, s45, 0
    s_nop 0
    buffer_load_dwordx4 v6, s[28:31], s48 offen offset:1024 lds
    s_cmp_lg_u32 s36, 1
    s_cbranch_scc1 k1cs_15
    v_mfma_f32_16x16x32_bf16 v[32:35], v[28:31], v[152:155], v[32:35]
    v_mfma_f32_16x16x32_bf16 v[36:39], v[28:31], v[156:159], v[36:39]
    v_mfma_f32_16x16x32_bf16 v[40:43], v[28:31], v[160:163], v[40:43]
k1cs_15:
    v_mfma_f32_32x32x16_bf16 v[92:107], v[116:119], v[116:119], v[92:107]
    s_waitcnt lgkmcnt(0)
    ds_read_b64_tr_b16 v[152:153], v16 offset:25600
    ds_read_b64_tr_b16 v[154:155], v16 offset:25856
    v_mfma_f32_32x32x16_bf16 v[44:59], v[140:143], v[116:119], v[44:59]
    ds_read_b64_tr_b16 v[156:157], v17 offset:35840
    ds_read_b64_tr_b16 v[158:159], v17 offset:36096
    s_add_u32 m0, s44, 51456
    s_nop 0
    buffer_load_dwordx4 v4, s[32:35], s46 offen offset:1792 lds
    v_mfma_f32_32x32x16_bf16 v[60:75], v[144:147], v[116:119], v[60:75]
    ds_read_b64_tr_b16 v[160:161], v17 offset:36864
    ds_read_b64_tr_b16 v[162:163], v17 offset:37120
    v_mfma_f32_32x32x16_bf16 v[76:91], v[116:119], v[148:151], v[76:91]
    s_add_u32 m0, s45, 0
    s_nop 0
    buffer_load_dwordx4 v7, s[28:31], s48 offen offset:2048 lds
    s_cmp_lg_u32 s36, 2
    s_cbranch_scc1 k1cs_16
    v_mfma_f32_16x16x32_bf16 v[32:35], v[28:31], v[140:143], v[32:35]
    v_mfma_f32_16x16x32_bf16 v[36:39], v[28:31], v[144:147], v[36:39]
    v_mfma_f32_16x16x32_bf16 v[40:43], v[28:31], v[148:151], v[40:43]
k1cs_16:
    v_mfma_f32_32x32x16_bf16 v[92:107], v[120:123], v[120:123], v[92:107]
    s_waitcnt vmcnt(6)
    s_waitcnt lgkmcnt(0)
    s_barrier
    ds_read_b128 v[124:127], v9 offset:12288
    ds_read_b128 v[128:131], v10 offset:12288
    ds_read_b64_tr_b16 v[140:141], v13 offset:38400
    ds_read_b64_tr_b16 v[142:143], v13 offset:38656
    v_mfma_f32_32x32x16_bf16 v[44:59], v[152:155], v[120:123], v[44:59]
    ds_read_b64_tr_b16 v[144:145], v17 offset:39424
    ds_read_b64_tr_b16 v[146:147], v17 offset:39680
    v_mfma_f32_32x32x16_bf16 v[60:75], v[156:159], v[120:123], v[60:75]
    ds_read_b64_tr_b16 v[148:149], v17 offset:40448
    ds_read_b64_tr_b16 v[150:151], v17 offset:40704
    ds_read_b128 v[132:135], v11 offset:12288
    ds_read_b128 v[136:139], v12 offset:12288
    v_mfma_f32_32x32x16_bf16 v[76:91], v[120:123], v[160:163], v[76:91]
    s_add_u32 m0, s45, 0
    s_nop 0
    buffer_load_dwordx4 v8, s[28:31], s48 offen offset:3072 lds
    s_cmp_lg_u32 s36, 3
    s_cbranch_scc1 k1cs_17
    v_mfma_f32_16x16x32_bf16 v[32:35], v[28:31], v[152:155], v[32:35]
    v_mfma_f32_16x16x32_bf16 v[36:39], v[28:31], v[156:159], v[36:39]
    v_mfma_f32_16x16x32_bf16 v[40:43], v[28:31], v[160:163], v[40:43]
k1cs_17:
    s_waitcnt lgkmcnt(8)
    v_mfma_f32_32x32x16_bf16 v[92:107], v[124:127], v[124:127], v[92:107]
    s_waitcnt lgkmcnt(2)
    ds_read_b64_tr_b16 v[152:153], v14 offset:38400
    ds_read_b64_tr_b16 v[154:155], v14 offset:38656
    v_mfma_f32_32x32x16_bf16 v[44:59], v[140:143], v[124:127], v[44:59]
    ds_read_b64_tr_b16 v[156:157], v17 offset:42496
    ds_read_b64_tr_b16 v[158:159], v17 offset:42752
    s_mul_i32 s46, s49, 1344
    s_add_u32 m0, s44, 64000
    s_nop 0
    buffer_load_dwordx4 v4, s[32:35], s46 offen offset:0 lds
    v_mfma_f32_32x32x16_bf16 v[60:75], v[144:147], v[124:127], v[60:75]
    ds_read_b64_tr_b16 v[160:161], v17 offset:43520
    ds_read_b64_tr_b16 v[162:163], v17 offset:43776
    v_mfma_f32_32x32x16_bf16 v[76:91], v[124:127], v[148:151], v[76:91]
    s_add_u32 m0, s45, 4096
    s_nop 0
    buffer_load_dwordx4 v5, s[28:31], s49 offen offset:0 lds
    s_cmp_lg_u32 s36, 0
    s_cbranch_scc1 k1cs_18
    v_mfma_f32_16x16x32_bf16 v[32:35], v[28:31], v[140:143], v[32:35]
    v_mfma_f32_16x16x32_bf16 v[36:39], v[28:31], v[144:147], v[36:39]
    v_mfma_f32_16x16x32_bf16 v[40:43], v[28:31], v[148:151], v[40:43]
k1cs_18:
    v_mfma_f32_32x32x16_bf16 v[92:107], v[128:131], v[128:131], v[92:107]
    s_waitcnt lgkmcnt(0)
    ds_read_b64_tr_b16 v[140:141], v15 offset:38400
    ds_read_b64_tr_b16 v[142:143], v15 offset:38656
    v_mfma_f32_32x32x16_bf16 v[44:59], v[152:155], v[128:131], v[44:59]
    ds_read_b64_tr_b16 v[144:145], v17 offset:45568
    ds_read_b64_tr_b16 v[146:147], v17 offset:45824
    s_add_u32 m0, s44, 64128
    s_nop 0
    buffer_load_dwordx4 v4, s[32:35], s46 offen offset:896 lds
    v_mfma_f32_32x32x16_bf16 v[60:75], v[156:159], v[128:131], v[60:75]
    ds_read_b64_tr_b16 v[148:149], v17 offset:46592
    ds_read_b64_tr_b16 v[150:151], v17 offset:46848
    v_mfma_f32_32x32x16_bf16 v[76:91], v[128:131], v[160:163], v[76:91]
    s_add_u32 m0, s45, 4096
    s_nop 0
    buffer_load_dwordx4 v6, s[28:31], s49 offen offset:1024 lds
    s_cmp_lg_u32 s36, 1
    s_cbranch_scc1 k1cs_19
    v_mfma_f32_16x16x32_bf16 v[32:35], v[28:31], v[152:155], v[32:35]
    v_mfma_f32_16x16x32_bf16 v[36:39], v[28:31], v[156:159], v[36:39]
    v_mfma_f32_16x16x32_bf16 v[40:43], v[28:31], v[160:163], v[40:43]
k1cs_19:
    v_mfma_f32_32x32x16_bf16 v[92:107], v[132:135], v[132:135], v[92:107]
    s_waitcnt lgkmcnt(0)
    ds_read_b64_tr_b16 v[152:153], v16 offset:38400
    ds_read_b64_tr_b16 v[154:155], v16 offset:38656
    v_mfma_f32_32x32x16_bf16 v[44:59], v[140:143], v[132:135], v[44:59]
    ds_read_b64_tr_b16 v[156:157], v17 offset:48640
    ds_read_b64_tr_b16 v[158:159], v17 offset:48896
    s_add_u32 m0, s44, 64256
    s_nop 0
    buffer_load_dwordx4 v4, s[32:35], s46 offen offset:1792 lds
    v_mfma_f32_32x32x16_bf16 v[60:75], v[144:147], v[132:135], v[60:75]
    ds_read_b64_tr_b16 v[160:161], v17 offset:49664
    ds_read_b64_tr_b16 v[162:163], v17 offset:49920
    v_mfma_f32_32x32x16_bf16 v[76:91], v[132:135], v[148:151], v[76:91]
    s_add_u32 m0, s45, 4096
    s_nop 0
    buffer_load_dwordx4 v7, s[28:31], s49 offen offset:2048 lds
    s_cmp_lg_u32 s36, 2
    s_cbranch_scc1 k1cs_20
    v_mfma_f32_16x16x32_bf16 v[32:35], v[28:31], v[140:143], v[32:35]
    v_mfma_f32_16x16x32_bf16 v[36:39], v[28:31], v[144:147], v[36:39]
    v_mfma_f32_16x16x32_bf16 v[40:43], v[28:31], v[148:151], v[40:43]
k1cs_20:
    v_mfma_f32_32x32x16_bf16 v[92:107], v[136:139], v[136:139], v[92:107]
    s_waitcnt vmcnt(6)
    s_waitcnt lgkmcnt(0)
    s_barrier
    ds_read_b128 v[108:111], v9 offset:0
    ds_read_b128 v[112:115], v10 offset:0
    ds_read_b64_tr_b16 v[140:141], v13 offset:51200
    ds_read_b64_tr_b16 v[142:143], v13 offset:51456
    v_mfma_f32_32x32x16_bf16 v[44:59], v[152:155], v[136:139], v[44:59]
    ds_read_b64_tr_b16 v[144:145], v17 offset:52224
    ds_read_b64_tr_b16 v[146:147], v17 offset:52480
    v_mfma_f32_32x32x16_bf16 v[60:75], v[156:159], v[136:139], v[60:75]
    ds_read_b64_tr_b16 v[148:149], v17 offset:53248
    ds_read_b64_tr_b16 v[150:151], v17 offset:53504
    ds_read_b128 v[116:119], v11 offset:0
    ds_read_b128 v[120:123], v12 offset:0
    v_mfma_f32_32x32x16_bf16 v[76:91], v[136:139], v[160:163], v[76:91]
    s_add_u32 m0, s45, 4096
    s_nop 0
    buffer_load_dwordx4 v8, s[28:31], s49 offen offset:3072 lds
    s_cmp_lg_u32 s36, 3
    s_cbranch_scc1 k1cs_21
    v_mfma_f32_16x16x32_bf16 v[32:35], v[28:31], v[152:155], v[32:35]
    v_mfma_f32_16x16x32_bf16 v[36:39], v[28:31], v[156:159], v[36:39]
    v_mfma_f32_16x16x32_bf16 v[40:43], v[28:31], v[160:163], v[40:43]
k1cs_21:
    s_waitcnt lgkmcnt(8)
    v_mfma_f32_32x32x16_bf16 v[92:107], v[108:111], v[108:111], v[92:107]
    s_waitcnt lgkmcnt(2)
    ds_read_b64_tr_b16 v[152:153], v14 offset:51200
    ds_read_b64_tr_b16 v[154:155], v14 offset:51456
    v_mfma_f32_32x32x16_bf16 v[44:59], v[140:143], v[108:111], v[44:59]
    ds_read_b64_tr_b16 v[156:157], v17 offset:55296
    ds_read_b64_tr_b16 v[158:159], v17 offset:55552
    s_mul_i32 s46, s50, 1344
    s_add_u32 m0, s44, 76800
    s_nop 0
    buffer_load_dwordx4 v4, s[32:35], s46 offen offset:0 lds
    v_mfma_f32_32x32x16_bf16 v[60:75], v[144:147], v[108:111], v[60:75]
    ds_read_b64_tr_b16 v[160:161], v17 offset:56320
    ds_read_b64_tr_b16 v[162:163], v17 offset:56576
    v_mfma_f32_32x32x16_bf16 v[76:91], v[108:111], v[148:151], v[76:91]
    s_add_u32 m0, s45, 8192
    s_nop 0
    buffer_load_dwordx4 v5, s[28:31], s50 offen offset:0 lds
    s_cmp_lg_u32 s36, 0
    s_cbranch_scc1 k1cs_22
    v_mfma_f32_16x16x32_bf16 v[32:35], v[28:31], v[140:143], v[32:35]
    v_mfma_f32_16x16x32_bf16 v[36:39], v[28:31], v[144:147], v[36:39]
    v_mfma_f32_16x16x32_bf16 v[40:43], v[28:31], v[148:151], v[40:43]
k1cs_22:
    v_mfma_f32_32x32x16_bf16 v[92:107], v[112:115], v[112:115], v[92:107]
    s_waitcnt lgkmcnt(0)
    ds_read_b64_tr_b16 v[140:141], v15 offset:51200
    ds_read_b64_tr_b16 v[142:143], v15 offset:51456
    v_mfma_f32_32x32x16_bf16 v[44:59], v[152:155], v[112:115], v[44:59]
    ds_read_b64_tr_b16 v[144:145], v17 offset:58368
    ds_read_b64_tr_b16 v[146:147], v17 offset:58624
    s_add_u32 m0, s44, 76928
    s_nop 0
    buffer_load_dwordx4 v4, s[32:35], s46 offen offset:896 lds
    v_mfma_f32_32x32x16_bf16 v[60:75], v[156:159], v[112:115], v[60:75]
    ds_read_b64_tr_b16 v[148:149], v17 offset:59392
    ds_read_b64_tr_b16 v[150:151], v17 offset:59648
    v_mfma_f32_32x32x16_bf16 v[76:91], v[112:115], v[160:163], v[76:91]
    s_add_u32 m0, s45, 8192
    s_nop 0
    buffer_load_dwordx4 v6, s[28:31], s50 offen offset:1024 lds
    s_cmp_lg_u32 s36, 1
    s_cbranch_scc1 k1cs_23
    v_mfma_f32_16x16x32_bf16 v[32:35], v[28:31], v[152:155], v[32:35]
    v_mfma_f32_16x16x32_bf16 v[36:39], v[28:31], v[156:159], v[36:39]
    v_mfma_f32_16x16x32_bf16 v[40:43], v[28:31], v[160:163], v[40:43]
k1cs_23:
    v_mfma_f32_32x32x16_bf16 v[92:107], v[116:119], v[116:119], v[92:107]
    s_waitcnt lgkmcnt(0)
    ds_read_b64_tr_b16 v[152:153], v16 offset:51200
    ds_read_b64_tr_b16 v[154:155], v16 offset:51456
    v_mfma_f32_32x32x16_bf16 v[44:59], v[140:143], v[116:119], v[44:59]
    ds_read_b64_tr_b16 v[156:157], v17 offset:61440
    ds_read_b64_tr_b16 v[158:159], v17 offset:61696
    s_add_u32 m0, s44, 77056
    s_nop 0
    buffer_load_dwordx4 v4, s[32:35], s46 offen offset:1792 lds
    v_mfma_f32_32x32x16_bf16 v[60:75], v[144:147], v[116:119], v[60:75]
    ds_read_b64_tr_b16 v[160:161], v17 offset:62464
    ds_read_b64_tr_b16 v[162:163], v17 offset:62720
    v_mfma_f32_32x32x16_bf16 v[76:91], v[116:119], v[148:151], v[76:91]
    s_add_u32 m0, s45, 8192
    s_nop 0
    buffer_load_dwordx4 v7, s[28:31], s50 offen offset:2048 lds
    s_cmp_lg_u32 s36, 2
    s_cbranch_scc1 k1cs_24
    v_mfma_f32_16x16x32_bf16 v[32:35], v[28:31], v[140:143], v[32:35]
    v_mfma_f32_16x16x32_bf16 v[36:39], v[28:31], v[144:147], v[36:39]
    v_mfma_f32_16x16x32_bf16 v[40:43], v[28:31], v[148:151], v[40:43]
k1cs_24:
    v_mfma_f32_32x32x16_bf16 v[92:107], v[120:123], v[120:123], v[92:107]
    s_waitcnt vmcnt(6)
    v_add_u32 v17, 64000, v17
    v_add_u32 v13, 64000, v13
    v_add_u32 v14, 64000, v14
    v_add_u32 v15, 64000, v15
    v_add_u32 v16, 64000, v16
    s_waitcnt lgkmcnt(0)
    s_barrier
    ds_read_b128 v[124:127], v9 offset:4096
    ds_read_b128 v[128:131], v10 offset:4096
    ds_read_b64_tr_b16 v[140:141], v13 offset:0
    ds_read_b64_tr_b16 v[142:143], v13 offset:256
    v_mfma_f32_32x32x16_bf16 v[44:59], v[152:155], v[120:123], v[44:59]
    ds_read_b64_tr_b16 v[144:145], v17 offset:1024
    ds_read_b64_tr_b16 v[146:147], v17 offset:1280
    v_mfma_f32_32x32x16_bf16 v[60:75], v[156:159], v[120:123], v[60:75]
    ds_read_b64_tr_b16 v[148:149], v17 offset:2048
    ds_read_b64_tr_b16 v[150:151], v17 offset:2304
    ds_read_b128 v[132:135], v11 offset:4096
    ds_read_b128 v[136:139], v12 offset:4096
    v_mfma_f32_32x32x16_bf16 v[76:91], v[120:123], v[160:163], v[76:91]
    s_add_u32 m0, s45, 8192
    s_nop 0
    buffer_load_dwordx4 v8, s[28:31], s50 offen offset:3072 lds
    s_cmp_lg_u32 s36, 3
    s_cbranch_scc1 k1cs_25
    v_mfma_f32_16x16x32_bf16 v[32:35], v[28:31], v[152:155], v[32:35]
    v_mfma_f32_16x16x32_bf16 v[36:39], v[28:31], v[156:159], v[36:39]
    v_mfma_f32_16x16x32_bf16 v[40:43], v[28:31], v[160:163], v[40:43]
k1cs_25:
    s_waitcnt lgkmcnt(8)
    v_mfma_f32_32x32x16_bf16 v[92:107], v[124:127], v[124:127], v[92:107]
    s_waitcnt lgkmcnt(2)
    ds_read_b64_tr_b16 v[152:153], v14 offset:0
    ds_read_b64_tr_b16 v[154:155], v14 offset:256
    v_mfma_f32_32x32x16_bf16 v[44:59], v[140:143], v[124:127], v[44:59]
    ds_read_b64_tr_b16 v[156:157], v17 offset:4096
    ds_read_b64_tr_b16 v[158:159], v17 offset:4352
    v_mfma_f32_32x32x16_bf16 v[60:75], v[144:147], v[124:127], v[60:75]
    ds_read_b64_tr_b16 v[160:161], v17 offset:5120
    ds_read_b64_tr_b16 v[162:163], v17 offset:5376
    v_mfma_f32_32x32x16_bf16 v[76:91], v[124:127], v[148:151], v[76:91]
    s_cmp_lg_u32 s36, 0
    s_cbranch_scc1 k1cs_26
    v_mfma_f32_16x16x32_bf16 v[32:35], v[28:31], v[140:143], v[32:35]
    v_mfma_f32_16x16x32_bf16 v[36:39], v[28:31], v[144:147], v[36:39]
    v_mfma_f32_16x16x32_bf16 v[40:43], v[28:31], v[148:151], v[40:43]
k1cs_26:
    v_mfma_f32_32x32x16_bf16 v[92:107], v[128:131], v[128:131], v[92:107]
    s_waitcnt lgkmcnt(0)
    ds_read_b64_tr_b16 v[140:141], v15 offset:0
    ds_read_b64_tr_b16 v[142:143], v15 offset:256
    v_mfma_f32_32x32x16_bf16 v[44:59], v[152:155], v[128:131], v[44:59]
    ds_read_b64_tr_b16 v[144:145], v17 offset:7168
    ds_read_b64_tr_b16 v[146:147], v17 offset:7424
    v_mfma_f32_32x32x16_bf16 v[60:75], v[156:159], v[128:131], v[60:75]
    ds_read_b64_tr_b16 v[148:149], v17 offset:8192
    ds_read_b64_tr_b16 v[150:151], v17 offset:8448
    v_mfma_f32_32x32x16_bf16 v[76:91], v[128:131], v[160:163], v[76:91]
    s_cmp_lg_u32 s36, 1
    s_cbranch_scc1 k1cs_27
    v_mfma_f32_16x16x32_bf16 v[32:35], v[28:31], v[152:155], v[32:35]
    v_mfma_f32_16x16x32_bf16 v[36:39], v[28:31], v[156:159], v[36:39]
    v_mfma_f32_16x16x32_bf16 v[40:43], v[28:31], v[160:163], v[40:43]
k1cs_27:
    v_mfma_f32_32x32x16_bf16 v[92:107], v[132:135], v[132:135], v[92:107]
    s_waitcnt lgkmcnt(0)
    ds_read_b64_tr_b16 v[152:153], v16 offset:0
    ds_read_b64_tr_b16 v[154:155], v16 offset:256
    v_mfma_f32_32x32x16_bf16 v[44:59], v[140:143], v[132:135], v[44:59]
    ds_read_b64_tr_b16 v[156:157], v17 offset:10240
    ds_read_b64_tr_b16 v[158:159], v17 offset:10496
    v_mfma_f32_32x32x16_bf16 v[60:75], v[144:147], v[132:135], v[60:75]
    ds_read_b64_tr_b16 v[160:161], v17 offset:11264
    ds_read_b64_tr_b16 v[162:163], v17 offset:11520
    v_mfma_f32_32x32x16_bf16 v[76:91], v[132:135], v[148:151], v[76:91]
    s_cmp_lg_u32 s36, 2
    s_cbranch_scc1 k1cs_28
    v_mfma_f32_16x16x32_bf16 v[32:35], v[28:31], v[140:143], v[32:35]
    v_mfma_f32_16x16x32_bf16 v[36:39], v[28:31], v[144:147], v[36:39]
    v_mfma_f32_16x16x32_bf16 v[40:43], v[28:31], v[148:151], v[40:43]
k1cs_28:
    v_mfma_f32_32x32x16_bf16 v[92:107], v[136:139], v[136:139], v[92:107]
    s_waitcnt vmcnt(0)
    s_waitcnt lgkmcnt(0)
    s_barrier
    ds_read_b128 v[108:111], v9 offset:8192
    ds_read_b128 v[112:115], v10 offset:8192
    ds_read_b64_tr_b16 v[140:141], v13 offset:12800
    ds_read_b64_tr_b16 v[142:143], v13 offset:13056
    v_mfma_f32_32x32x16_bf16 v[44:59], v[152:155], v[136:139], v[44:59]
    ds_read_b64_tr_b16 v[144:145], v17 offset:13824
    ds_read_b64_tr_b16 v[146:147], v17 offset:14080
    v_mfma_f32_32x32x16_bf16 v[60:75], v[156:159], v[136:139], v[60:75]
    ds_read_b64_tr_b16 v[148:149], v17 offset:14848
    ds_read_b64_tr_b16 v[150:151], v17 offset:15104
    ds_read_b128 v[116:119], v11 offset:8192
    ds_read_b128 v[120:123], v12 offset:8192
    v_mfma_f32_32x32x16_bf16 v[76:91], v[136:139], v[160:163], v[76:91]
    buffer_load_dword v242, v241, s[12:15], s51 offen sc1
    s_cmp_lg_u32 s36, 3
    s_cbranch_scc1 k1cs_29
    v_mfma_f32_16x16x32_bf16 v[32:35], v[28:31], v[152:155], v[32:35]
    v_mfma_f32_16x16x32_bf16 v[36:39], v[28:31], v[156:159], v[36:39]
    v_mfma_f32_16x16x32_bf16 v[40:43], v[28:31], v[160:163], v[40:43]
k1cs_29:
    s_waitcnt lgkmcnt(8)
    v_mfma_f32_32x32x16_bf16 v[92:107], v[108:111], v[108:111], v[92:107]
    s_waitcnt lgkmcnt(2)
    ds_read_b64_tr_b16 v[152:153], v14 offset:12800
    ds_read_b64_tr_b16 v[154:155], v14 offset:13056
    v_mfma_f32_32x32x16_bf16 v[44:59], v[140:143], v[108:111], v[44:59]
    ds_read_b64_tr_b16 v[156:157], v17 offset:16896
    ds_read_b64_tr_b16 v[158:159], v17 offset:17152
    v_mfma_f32_32x32x16_bf16 v[60:75], v[144:147], v[108:111], v[60:75]
    ds_read_b64_tr_b16 v[160:161], v17 offset:17920
    ds_read_b64_tr_b16 v[162:163], v17 offset:18176
    v_mfma_f32_32x32x16_bf16 v[76:91], v[108:111], v[148:151], v[76:91]
    s_mov_b32 s88, s24
    s_mov_b32 s89, s25
    s_mov_b32 s90, 401408
    s_mov_b32 s91, 0x00020000
    s_lshr_b32 s92, s2, 3
    s_mul_i32 s92, s92, 4
    s_add_u32 s92, s92, s36
    s_lshl_b32 s92, s92, 12
    v_lshlrev_b32 v228, 6, v1
    buffer_load_dword v230, v228, s[88:91], s92 offen
    s_mov_b32 s88, s16
    s_mov_b32 s89, s17
    s_mov_b32 s90, 7340032
    s_mov_b32 s91, 0x00020000
    s_lshr_b32 s92, s2, 3
    s_mul_i32 s92, s92, 229376
    s_mul_i32 s93, s36, 57344
    s_add_u32 s92, s92, s93
    s_bfe_u32 s93, s2, 0x20001
    s_mul_i32 s93, s93, 896
    s_add_u32 s92, s92, s93
    v_lshrrev_b32 v228, 3, v1
    v_mul_u32_u24 v228, 3584, v228
    v_and_b32 v229, 7, v1
    v_min_u32 v229, 6, v229
    v_lshl_add_u32 v228, v229, 7, v228
    s_and_b32 s93, s2, 1
    s_mul_i32 s93, s93, 28672
    s_add_u32 s92, s92, s93
    buffer_load_dword v232, v228, s[88:91], s92 offen
    s_cmp_lg_u32 s36, 0
    s_cbranch_scc1 k1cs_30
    v_mfma_f32_16x16x32_bf16 v[32:35], v[28:31], v[140:143], v[32:35]
    v_mfma_f32_16x16x32_bf16 v[36:39], v[28:31], v[144:147], v[36:39]
    v_mfma_f32_16x16x32_bf16 v[40:43], v[28:31], v[148:151], v[40:43]
k1cs_30:
    v_mfma_f32_32x32x16_bf16 v[92:107], v[112:115], v[112:115], v[92:107]
    s_waitcnt lgkmcnt(0)
    ds_read_b64_tr_b16 v[140:141], v15 offset:12800
    ds_read_b64_tr_b16 v[142:143], v15 offset:13056
    v_mfma_f32_32x32x16_bf16 v[44:59], v[152:155], v[112:115], v[44:59]
    ds_read_b64_tr_b16 v[144:145], v17 offset:19968
    ds_read_b64_tr_b16 v[146:147], v17 offset:20224
    v_mfma_f32_32x32x16_bf16 v[60:75], v[156:159], v[112:115], v[60:75]
    ds_read_b64_tr_b16 v[148:149], v17 offset:20992
    ds_read_b64_tr_b16 v[150:151], v17 offset:21248
    v_mfma_f32_32x32x16_bf16 v[76:91], v[112:115], v[160:163], v[76:91]
    s_cmp_lg_u32 s36, 1
    s_cbranch_scc1 k1cs_31
    v_mfma_f32_16x16x32_bf16 v[32:35], v[28:31], v[152:155], v[32:35]
    v_mfma_f32_16x16x32_bf16 v[36:39], v[28:31], v[156:159], v[36:39]
    v_mfma_f32_16x16x32_bf16 v[40:43], v[28:31], v[160:163], v[40:43]
k1cs_31:
    v_mfma_f32_32x32x16_bf16 v[92:107], v[116:119], v[116:119], v[92:107]
    s_waitcnt lgkmcnt(0)
    ds_read_b64_tr_b16 v[152:153], v16 offset:12800
    ds_read_b64_tr_b16 v[154:155], v16 offset:13056
    v_mfma_f32_32x32x16_bf16 v[44:59], v[140:143], v[116:119], v[44:59]
    ds_read_b64_tr_b16 v[156:157], v17 offset:23040
    ds_read_b64_tr_b16 v[158:159], v17 offset:23296
    v_mfma_f32_32x32x16_bf16 v[60:75], v[144:147], v[116:119], v[60:75]
    ds_read_b64_tr_b16 v[160:161], v17 offset:24064
    ds_read_b64_tr_b16 v[162:163], v17 offset:24320
    v_mfma_f32_32x32x16_bf16 v[76:91], v[116:119], v[148:151], v[76:91]
    s_cmp_lg_u32 s36, 2
    s_cbranch_scc1 k1cs_32
    v_mfma_f32_16x16x32_bf16 v[32:35], v[28:31], v[140:143], v[32:35]
    v_mfma_f32_16x16x32_bf16 v[36:39], v[28:31], v[144:147], v[36:39]
    v_mfma_f32_16x16x32_bf16 v[40:43], v[28:31], v[148:151], v[40:43]
k1cs_32:
    v_mfma_f32_32x32x16_bf16 v[92:107], v[120:123], v[120:123], v[92:107]
    s_waitcnt lgkmcnt(0)
    v_mfma_f32_32x32x16_bf16 v[44:59], v[152:155], v[120:123], v[44:59]
    v_mfma_f32_32x32x16_bf16 v[60:75], v[156:159], v[120:123], v[60:75]
    v_mfma_f32_32x32x16_bf16 v[76:91], v[120:123], v[160:163], v[76:91]
    s_cmp_lg_u32 s36, 3
    s_cbranch_scc1 k1cs_33
    v_mfma_f32_16x16x32_bf16 v[32:35], v[28:31], v[152:155], v[32:35]
    v_mfma_f32_16x16x32_bf16 v[36:39], v[28:31], v[156:159], v[36:39]
    v_mfma_f32_16x16x32_bf16 v[40:43], v[28:31], v[160:163], v[40:43]
k1cs_33:
    s_lshl_b32 s42, s36, 2
    s_add_u32 s42, s42, 155136
    v_lshl_add_u32 v18, v1, 4, s42
    v_lshlrev_b32 v19, 4, v1
    v_add_u32 v19, 155136, v19
    v_lshlrev_b32 v20, 4, v3
    v_add_u32 v20, 156160, v20
    s_lshl_b32 s42, s36, 9
    s_add_u32 s42, s42, 156672
    v_lshl_add_u32 v21, v1, 2, s42
    v_lshl_add_u32 v22, v3, 2, s42
    v_lshl_add_u32 v23, v2, 4, s42
    s_mov_b64 exec, 0xffff
    ds_write_b32 v18, v32 offset:0
    ds_write_b32 v18, v33 offset:256
    ds_write_b32 v18, v36 offset:512
    ds_write_b32 v18, v37 offset:768
    ds_write_b32 v18, v40 offset:1024
    ds_write_b32 v18, v41 offset:1280
    s_mov_b64 exec, -1
    v_cndmask_b32 v92, v92, v93, s[72:73]
    v_cndmask_b32 v94, v94, v95, s[72:73]
    v_cndmask_b32 v96, v96, v97, s[72:73]
    v_cndmask_b32 v98, v98, v99, s[72:73]
    v_cndmask_b32 v100, v100, v101, s[72:73]
    v_cndmask_b32 v102, v102, v103, s[72:73]
    v_cndmask_b32 v104, v104, v105, s[72:73]
    v_cndmask_b32 v106, v106, v107, s[72:73]
    v_cndmask_b32 v92, v92, v94, s[74:75]
    v_cndmask_b32 v96, v96, v98, s[74:75]
    v_cndmask_b32 v100, v100, v102, s[74:75]
    v_cndmask_b32 v104, v104, v106, s[74:75]
    s_waitcnt lgkmcnt(0)
    s_barrier
    ds_read_b128 v[164:167], v19
    ds_read_b128 v[168:171], v20
    v_cndmask_b32 v92, v92, v96, s[76:77]
    v_cndmask_b32 v100, v100, v104, s[76:77]
    v_cndmask_b32 v92, v92, v100, s[78:79]
    v_cndmask_b32 v94, v56, v44, s[52:53]
    v_mov_b32 v93, v92
    v_mov_b32 v95, v94
    s_nop 1
    v_permlane32_swap_b32 v92, v93
    v_permlane32_swap_b32 v94, v95
    s_nop 1
    v_cndmask_b32 v92, v92, v93, s[80:81]
    v_cndmask_b32 v94, v95, v94, s[52:53]
    v_mul_f32 v94, 0x3b124925, v94
    v_mul_f32 v93, v94, v94
    v_mov_b32 v95, 0x3b124925
    v_fma_f32 v92, v92, v95, -v93
    v_max_f32 v92, 0, v92
    v_add_f32 v92, 0x3727c5ac, v92
    v_rsq_f32 v92, v92
    s_waitcnt lgkmcnt(1)
    v_add_f32 v164, v164, v165
    v_add_f32 v166, v166, v167
    v_mul_f32 v93, v92, v94
    v_add_f32 v164, v164, v166
    v_sub_f32 v93, 0, v93
    ds_write_b32 v21, v164
    ds_write_b32 v22, v92 offset:256
    ds_write_b32 v22, v93 offset:384
    s_waitcnt lgkmcnt(3)
    v_add_f32 v168, v168, v169
    v_add_f32 v170, v170, v171
    v_mul_f32 v96, 0x3e8b97f6, v92
    v_mul_f32 v97, 0x3e8b97f6, v93
    v_add_f32 v98, v168, v170
    s_waitcnt lgkmcnt(0)
    ds_read_b128 v[180:183], v23 offset:128
    ds_read_b128 v[184:187], v23 offset:160
    ds_read_b128 v[188:191], v23 offset:192
    ds_read_b128 v[192:195], v23 offset:224
    ds_read_b128 v[196:199], v23 offset:256
    ds_read_b128 v[200:203], v23 offset:288
    ds_read_b128 v[204:207], v23 offset:320
    ds_read_b128 v[208:211], v23 offset:352
    ds_read_b128 v[212:215], v23 offset:384
    ds_read_b128 v[216:219], v23 offset:416
    ds_read_b128 v[220:223], v23 offset:448
    ds_read_b128 v[224:227], v23 offset:480
    v_bfe_u32 v18, v1, 4, 1
    v_and_b32 v19, 15, v1
    v_lshlrev_b32 v19, 4, v19
    v_lshl_add_u32 v18, v18, 10, v19
    v_lshl_add_u32 v19, v2, 8, v18
    v_lshl_add_u32 v18, v2, 9, v18
    s_lshl_b32 s42, s36, 11
    v_add_u32 v20, s42, v18
    v_add_u32 v21, s42, v19
    v_add_u32 v22, s42, v20
    v_mov_b32 v99, 0x3f803f80
    s_waitcnt lgkmcnt(8)
    ds_read_b128 v[164:167], v23 offset:0
    ds_read_b128 v[168:171], v23 offset:32
    ds_read_b128 v[172:175], v23 offset:64
    ds_read_b128 v[176:179], v23 offset:96
    v_mul_f32 v180, v93, v180
    v_mul_f32 v181, v93, v181
    v_mul_f32 v182, v93, v182
    v_mul_f32 v183, v93, v183
    v_mul_f32 v184, v93, v184
    v_mul_f32 v185, v93, v185
    v_mul_f32 v186, v93, v186
    v_mul_f32 v187, v93, v187
    v_mul_f32 v188, v93, v188
    v_mul_f32 v189, v93, v189
    v_mul_f32 v190, v93, v190
    v_mul_f32 v191, v93, v191
    v_mul_f32 v192, v93, v192
    v_mul_f32 v193, v93, v193
    v_mul_f32 v194, v93, v194
    v_mul_f32 v195, v93, v195
    v_fma_f32 v60, v92, v60, v180
    v_fma_f32 v61, v92, v61, v181
    v_fma_f32 v62, v92, v62, v182
    v_fma_f32 v63, v92, v63, v183
    v_fma_f32 v64, v92, v64, v184
    v_fma_f32 v65, v92, v65, v185
    v_fma_f32 v66, v92, v66, v186
    v_fma_f32 v67, v92, v67, v187
    v_fma_f32 v68, v92, v68, v188
    v_fma_f32 v69, v92, v69, v189
    v_fma_f32 v70, v92, v70, v190
    v_fma_f32 v71, v92, v71, v191
    v_fma_f32 v72, v92, v72, v192
    v_fma_f32 v73, v92, v73, v193
    v_fma_f32 v74, v92, v74, v194
    v_fma_f32 v75, v92, v75, v195
    v_cvt_pk_bf16_f32 v116, v60, v61
    v_cvt_pk_bf16_f32 v117, v62, v63
    v_cvt_pk_bf16_f32 v118, v64, v65
    v_cvt_pk_bf16_f32 v119, v66, v67
    v_cvt_pk_bf16_f32 v120, v68, v69
    v_cvt_pk_bf16_f32 v121, v70, v71
    v_cvt_pk_bf16_f32 v122, v72, v73
    v_cvt_pk_bf16_f32 v123, v74, v75
    v_cndmask_b32 v116, v116, 0, s[54:55]
    v_cndmask_b32 v117, v117, 0, s[54:55]
    v_cndmask_b32 v122, v122, 0, s[56:57]
    v_cndmask_b32 v123, v123, 0, s[56:57]
    buffer_store_dwordx4 v[116:119], v18, s[12:15], s82 offen offset:0 sc1
    buffer_store_dwordx4 v[120:123], v18, s[12:15], s82 offen offset:256 sc1
    ds_write_b128 v20, v[116:119] offset:16384
    ds_write_b128 v20, v[120:123] offset:16640
    s_waitcnt lgkmcnt(6)
    v_mul_f32 v212, v98, v212
    v_mul_f32 v213, v98, v213
    v_mul_f32 v214, v98, v214
    v_mul_f32 v215, v98, v215
    v_mul_f32 v216, v98, v216
    v_mul_f32 v217, v98, v217
    v_mul_f32 v218, v98, v218
    v_mul_f32 v219, v98, v219
    v_mul_f32 v220, v98, v220
    v_mul_f32 v221, v98, v221
    v_mul_f32 v222, v98, v222
    v_mul_f32 v223, v98, v223
    v_mul_f32 v224, v98, v224
    v_mul_f32 v225, v98, v225
    v_mul_f32 v226, v98, v226
    v_mul_f32 v227, v98, v227
    v_fma_f32 v76, v196, v76, v212
    v_fma_f32 v77, v197, v77, v213
    v_fma_f32 v78, v198, v78, v214
    v_fma_f32 v79, v199, v79, v215
    v_fma_f32 v80, v200, v80, v216
    v_fma_f32 v81, v201, v81, v217
    v_fma_f32 v82, v202, v82, v218
    v_fma_f32 v83, v203, v83, v219
    v_fma_f32 v84, v204, v84, v220
    v_fma_f32 v85, v205, v85, v221
    v_fma_f32 v86, v206, v86, v222
    v_fma_f32 v87, v207, v87, v223
    v_fma_f32 v88, v208, v88, v224
    v_fma_f32 v89, v209, v89, v225
    v_fma_f32 v90, v210, v90, v226
    v_fma_f32 v91, v211, v91, v227
    v_cvt_pk_bf16_f32 v124, v76, v77
    v_cvt_pk_bf16_f32 v125, v78, v79
    v_cvt_pk_bf16_f32 v126, v84, v85
    v_cvt_pk_bf16_f32 v127, v86, v87
    v_cvt_pk_bf16_f32 v128, v80, v81
    v_cvt_pk_bf16_f32 v129, v82, v83
    v_cvt_pk_bf16_f32 v130, v88, v89
    v_cvt_pk_bf16_f32 v131, v90, v91
    v_cndmask_b32 v124, v124, v99, s[70:71]
    v_cndmask_b32 v125, v125, v99, s[70:71]
    v_cndmask_b32 v126, v126, v99, s[70:71]
    v_cndmask_b32 v127, v127, v99, s[70:71]
    v_cndmask_b32 v128, v128, v99, s[70:71]
    v_cndmask_b32 v129, v129, v99, s[70:71]
    v_cndmask_b32 v130, v130, v99, s[70:71]
    v_cndmask_b32 v131, v131, v99, s[70:71]
    buffer_store_dwordx4 v[124:127], v19, s[12:15], s83 offen offset:0 sc1
    buffer_store_dwordx4 v[128:131], v19, s[12:15], s83 offen offset:512 sc1
    ds_write_b128 v21, v[124:127] offset:40960
    ds_write_b128 v21, v[128:131] offset:41472
    s_waitcnt lgkmcnt(4)
    v_mul_f32 v164, v97, v164
    v_mul_f32 v165, v97, v165
    v_mul_f32 v166, v97, v166
    v_mul_f32 v167, v97, v167
    v_mul_f32 v168, v97, v168
    v_mul_f32 v169, v97, v169
    v_mul_f32 v170, v97, v170
    v_mul_f32 v171, v97, v171
    v_mul_f32 v172, v97, v172
    v_mul_f32 v173, v97, v173
    v_mul_f32 v174, v97, v174
    v_mul_f32 v175, v97, v175
    v_mul_f32 v176, v97, v176
    v_mul_f32 v177, v97, v177
    v_mul_f32 v178, v97, v178
    v_mul_f32 v179, v97, v179
    v_fma_f32 v44, v96, v44, v164
    v_fma_f32 v45, v96, v45, v165
    v_fma_f32 v46, v96, v46, v166
    v_fma_f32 v47, v96, v47, v167
    v_fma_f32 v48, v96, v48, v168
    v_fma_f32 v49, v96, v49, v169
    v_fma_f32 v50, v96, v50, v170
    v_fma_f32 v51, v96, v51, v171
    v_fma_f32 v52, v96, v52, v172
    v_fma_f32 v53, v96, v53, v173
    v_fma_f32 v54, v96, v54, v174
    v_fma_f32 v55, v96, v55, v175
    v_fma_f32 v56, v96, v56, v176
    v_fma_f32 v57, v96, v57, v177
    v_fma_f32 v58, v96, v58, v178
    v_fma_f32 v59, v96, v59, v179
    v_cvt_pk_bf16_f32 v108, v44, v45
    v_cvt_pk_bf16_f32 v109, v46, v47
    v_cvt_pk_bf16_f32 v110, v48, v49
    v_cvt_pk_bf16_f32 v111, v50, v51
    v_cvt_pk_bf16_f32 v112, v52, v53
    v_cvt_pk_bf16_f32 v113, v54, v55
    v_cvt_pk_bf16_f32 v114, v56, v57
    v_cvt_pk_bf16_f32 v115, v58, v59
    v_cndmask_b32 v108, v108, v99, s[54:55]
    v_cndmask_b32 v109, v109, v99, s[54:55]
    v_cndmask_b32 v114, v114, v99, s[56:57]
    v_cndmask_b32 v115, v115, v99, s[56:57]
    ds_write_b128 v22, v[108:111] offset:24576
    ds_write_b128 v22, v[112:115] offset:24832
    s_waitcnt vmcnt(6)
    s_mov_b32 s42, 0
k1lp_35:
    v_cmp_ne_u32 vcc, -1, v242
    s_cbranch_vccz k1ok_34
    buffer_load_dword v242, v241, s[12:15], s51 offen sc1
    s_add_u32 s42, s42, 1
    s_cmp_lt_u32 s42, 20000
    s_waitcnt vmcnt(0)
    s_cbranch_scc1 k1lp_35
k1ok_34:
    s_barrier
    s_mov_b32 s28, s96
    s_mov_b32 s29, s97
    s_and_b32 s42, s2, 7
    s_lshr_b32 s43, s2, 3
    s_lshr_b32 s44, s42, 1
    s_and_b32 s42, s42, 1
    s_and_b32 s45, s43, 3
    s_lshr_b32 s43, s43, 2
    s_lshl2_add_u32 s41, s44, s45
    s_lshl3_add_u32 s40, s42, s43
    s_lshl2_add_u32 s37, s42, s45
    s_lshl3_add_u32 s38, s44, s43
    s_mul_i32 s39, s44, 7
    s_min_u32 s42, s43, 6
    s_add_u32 s39, s39, s42
    s_mov_b32 s50, s43
    s_mul_i32 s92, s42, 0
    s_lshr_b32 s92, s92, 4
    s_mul_i32 s93, s43, 0
    s_lshr_b32 s93, s93, 2
    v_lshlrev_b32 v2, 4, v1
    s_mul_i32 s48, s36, 28672
    s_add_u32 s48, s48, 49152
    v_mov_b32 v104, -1
    v_mov_b32 v105, -1
    v_mov_b32 v106, -1
    v_mov_b32 v107, -1
    s_lshl_b32 s42, s36, 12
    v_add_u32 v71, s42, v2
    s_lshl_b32 s43, s41, 13
    s_add_u32 s42, s42, s43
    s_mul_i32 s43, s40, 147456
    s_add_u32 s42, s42, s43
    s_lshl1_add_u32 s43, s41, s36
    s_cmp_lt_u32 s43, 4
    s_cselect_b32 s43, 16384, 0
    s_add_u32 s42, s42, s43
    s_add_u32 s95, s42, 2097152
    s_add_u32 s100, s42, 4718592
    s_waitcnt lgkmcnt(0)
    ds_read_b128 v[72:75], v71 offset:24576
    ds_read_b128 v[76:79], v71 offset:25600
    buffer_load_dwordx4 v[112:115], v2, s[12:15], s95 offen offset:0 sc1
    buffer_load_dwordx4 v[116:119], v2, s[12:15], s95 offen offset:1024 sc1
    buffer_load_dwordx4 v[120:123], v2, s[12:15], s95 offen offset:2048 sc1
    buffer_load_dwordx4 v[124:127], v2, s[12:15], s95 offen offset:3072 sc1
    buffer_load_dwordx4 v[184:187], v2, s[12:15], s100 offen offset:0 sc1
    buffer_load_dwordx4 v[188:191], v2, s[12:15], s100 offen offset:1024 sc1
    buffer_load_dwordx4 v[192:195], v2, s[12:15], s100 offen offset:2048 sc1
    buffer_load_dwordx4 v[196:199], v2, s[12:15], s100 offen offset:3072 sc1
    v_lshrrev_b32 v22, 3, v1
    v_lshrrev_b32 v23, 2, v1
    v_and_b32 v23, 4, v23
    v_and_b32 v24, 7, v1
    v_xor_b32 v23, v23, v24
    v_lshlrev_b32 v23, 4, v23
    s_mul_i32 s42, s36, 100352
    s_mul_i32 s43, s37, 112
    s_add_u32 s42, s42, s43
    v_mul_u32_u24 v24, 896, v22
    v_add3_u32 v18, v24, v23, s42
    v_add_u32 v19, 6144, v18
    v_add_u32 v20, 12288, v18
    v_add_u32 v21, 18432, v18
    s_mov_b32 s6, s18
    s_mov_b32 s7, s19
    s_mov_b32 s10, s22
    s_mov_b32 s11, s23
    s_mov_b32 s18, 7340032
    s_mov_b32 s19, 0x00020000
    s_mov_b32 s22, 7340032
    s_mov_b32 s23, 0x00020000
    s_mov_b32 s26, 401408
    s_mov_b32 s27, 0x00020000
    s_mov_b32 s30, 1835008
    s_mov_b32 s31, 0x00020000
    s_mul_i32 s42, s36, 1835008
    s_mul_i32 s43, s39, 128
    s_add_u32 s42, s42, s43
    v_mul_u32_u24 v24, 3584, v22
    v_add3_u32 v14, v24, v23, s42
    v_add_u32 v15, 27648, v14
    v_add_u32 v16, 55296, v14
    v_add_u32 v17, 82944, v14
    v_lshrrev_b32 v3, 5, v1
    v_and_b32 v4, 31, v1
    v_bfe_u32 v22, v1, 2, 2
    v_mad_u32_u24 v23, v3, 4, v22
    v_lshlrev_b32 v23, 7, v23
    v_bfe_u32 v24, v1, 4, 1
    v_lshlrev_b32 v24, 5, v24
    v_and_b32 v25, 3, v1
    v_lshl_add_u32 v24, v25, 3, v24
    v_bfe_u32 v25, v1, 3, 1
    v_lshl_add_u32 v24, v25, 6, v24
    v_add3_u32 v5, v23, v24, s48
    v_xor_b32 v6, 64, v5
    s_lshl_b32 s42, s36, 11
    v_add_u32 v68, s42, v2
    v_add_u32 v69, 24576, v68
    v_lshrrev_b32 v22, 4, v1
    v_and_b32 v23, 15, v1
    v_lshlrev_b32 v24, 4, v23
    v_lshl_add_u32 v70, v22, 9, v24
    v_lshlrev_b32 v22, 2, v22
    v_sub_u32 v22, v23, v22
    v_mov_b32 v23, 0xff800000
    v_cmp_gt_i32 vcc, 0, v22
    s_nop 1
    v_cndmask_b32 v96, v23, 0, vcc
    v_cndmask_b32 v100, 0, v23, vcc
    v_cmp_gt_i32 vcc, 1, v22
    s_nop 1
    v_cndmask_b32 v97, v23, 0, vcc
    v_cndmask_b32 v101, 0, v23, vcc
    v_cmp_gt_i32 vcc, 2, v22
    s_nop 1
    v_cndmask_b32 v98, v23, 0, vcc
    v_cndmask_b32 v102, 0, v23, vcc
    v_cmp_gt_i32 vcc, 3, v22
    s_nop 1
    v_cndmask_b32 v99, v23, 0, vcc
    v_cndmask_b32 v103, 0, v23, vcc
    s_and_b32 s43, s40, 1
    s_cmp_eq_u32 s43, 1
    s_cselect_b64 s[52:53], -1, 0
    s_cselect_b32 s54, 0xffff, 0
    s_mov_b32 s55, 0
    s_mov_b32 s56, 0
    s_cselect_b32 s57, 0, 0xffff0000
    s_mov_b32 s58, 0xc0135761
    s_mov_b32 s59, 0xbdd2d3e8
    s_lshr_b32 s42, s36, 1
    s_lshl_b32 s42, s42, 5
    v_add_u32 v25, s42, v4
    s_lshl_b32 s43, s38, 6
    v_add_u32 v22, s43, v25
    v_lshlrev_b32 v24, 1, v22
    s_and_b32 s42, s36, 1
    s_lshl_b32 s42, s42, 6
    s_mul_i32 s43, s37, 112
    s_add_u32 s42, s42, s43
    v_mul_u32_u24 v22, 896, v22
    v_add_u32 v22, s42, v22
    v_lshl_add_u32 v44, v3, 5, v22
    v_lshl_add_u32 v12, v3, 4, v22
    v_mov_b32 v45, v24
    v_lshlrev_b32 v46, 3, v3
    s_lshl_b32 s42, s38, 13
    s_add_u32 s42, s42, 14680064
    v_lshl_add_u32 v25, v25, 4, s42
    v_lshl_add_u32 v10, v3, 12, v25
    s_lshl_b32 s42, s37, 10
    s_and_b32 s43, s36, 1
    s_lshl3_add_u32 s42, s43, s42
    v_add_u32 v9, s42, v25
    v_mad_u32_u24 v11, v3, 24, v4
    v_lshlrev_b32 v11, 4, v11
    v_lshlrev_b32 v22, 2, v3
    v_sub_u32 v22, v4, v22
    v_mov_b32 v23, 0x3f80
    v_subrev_u32 v24, 0, v22
    v_cmp_gt_u32 vcc, 2, v24
    v_lshlrev_b32 v24, 4, v24
    v_lshlrev_b32 v24, v24, v23
    v_cndmask_b32 v60, 0, v24, vcc
    v_subrev_u32 v24, 2, v22
    v_cmp_gt_u32 vcc, 2, v24
    v_lshlrev_b32 v24, 4, v24
    v_lshlrev_b32 v24, v24, v23
    v_cndmask_b32 v61, 0, v24, vcc
    v_subrev_u32 v24, 8, v22
    v_cmp_gt_u32 vcc, 2, v24
    v_lshlrev_b32 v24, 4, v24
    v_lshlrev_b32 v24, v24, v23
    v_cndmask_b32 v62, 0, v24, vcc
    v_subrev_u32 v24, 10, v22
    v_cmp_gt_u32 vcc, 2, v24
    v_lshlrev_b32 v24, 4, v24
    v_lshlrev_b32 v24, v24, v23
    v_cndmask_b32 v63, 0, v24, vcc
    v_subrev_u32 v24, 16, v22
    v_cmp_gt_u32 vcc, 2, v24
    v_lshlrev_b32 v24, 4, v24
    v_lshlrev_b32 v24, v24, v23
    v_cndmask_b32 v64, 0, v24, vcc
    v_subrev_u32 v24, 18, v22
    v_cmp_gt_u32 vcc, 2, v24
    v_lshlrev_b32 v24, 4, v24
    v_lshlrev_b32 v24, v24, v23
    v_cndmask_b32 v65, 0, v24, vcc
    v_subrev_u32 v24, 24, v22
    v_cmp_gt_u32 vcc, 2, v24
    v_lshlrev_b32 v24, 4, v24
    v_lshlrev_b32 v24, v24, v23
    v_cndmask_b32 v66, 0, v24, vcc
    v_subrev_u32 v24, 26, v22
    v_cmp_gt_u32 vcc, 2, v24
    v_lshlrev_b32 v24, 4, v24
    v_lshlrev_b32 v24, v24, v23
    v_cndmask_b32 v67, 0, v24, vcc
    s_lshl3_add_u32 s94, s38, s36
    s_lshl_b32 s94, s94, 13
    s_add_u32 s94, s94, 7340032
    s_lshl2_add_u32 s43, s41, s36
    s_lshl4_add_u32 s43, s43, s40
    s_mul_i32 s43, s43, 2048
    s_add_u32 s43, s43, 7340032
    buffer_store_dwordx4 v[104:107], v2, s[12:15], s43 offen offset:0 sc1
    buffer_store_dwordx4 v[104:107], v2, s[12:15], s43 offen offset:1024 sc1
    s_lshl2_add_u32 s43, s2, s36
    s_mul_i32 s43, s43, 1792
    s_add_u32 s43, s43, 10485760
    buffer_store_dwordx4 v[104:107], v2, s[12:15], s43 offen offset:0 sc1
    buffer_store_dwordx4 v[104:107], v2, s[12:15], s43 offen offset:768 sc1
    s_lshl2_add_u32 s43, s2, s36
    s_mul_i32 s43, s43, 1568
    s_add_u32 s43, s43, 12582912
    buffer_store_dwordx4 v[104:107], v2, s[12:15], s43 offen offset:0 sc1
    buffer_store_dwordx4 v[104:107], v2, s[12:15], s43 offen offset:544 sc1
    s_lshl2_add_u32 s43, s2, s36
    s_mul_i32 s43, s43, 256
    s_add_u32 s43, s43, 14680064
    s_mov_b64 exec, 0xffff
    buffer_store_dwordx4 v[104:107], v2, s[12:15], s43 offen offset:0 sc1
    s_mov_b64 exec, -1
    s_waitcnt vmcnt(11)
    s_lshl_b32 s42, s41, 1
    s_add_u32 s42, s42, s36
    s_cmp_lt_u32 s42, 4
    s_cbranch_scc0 sequential_preLN__sliding_block__mixer_token_mlp__prompt_kernel_prek
    v_mov_b32 v26, 0xfb80fb80
    v_cndmask_b32 v112, 0, v26, s[54:55]
    v_cndmask_b32 v113, 0, v26, s[54:55]
    v_cndmask_b32 v114, 0, v26, s[56:57]
    v_cndmask_b32 v115, 0, v26, s[56:57]
    v_cndmask_b32 v116, 0, v26, s[54:55]
    v_cndmask_b32 v117, 0, v26, s[54:55]
    v_cndmask_b32 v118, 0, v26, s[56:57]
    v_cndmask_b32 v119, 0, v26, s[56:57]
    v_cndmask_b32 v120, 0, v26, s[54:55]
    v_cndmask_b32 v121, 0, v26, s[54:55]
    v_cndmask_b32 v122, 0, v26, s[56:57]
    v_cndmask_b32 v123, 0, v26, s[56:57]
    v_cndmask_b32 v124, 0, v26, s[54:55]
    v_cndmask_b32 v125, 0, v26, s[54:55]
    v_cndmask_b32 v126, 0, v26, s[56:57]
    v_cndmask_b32 v127, 0, v26, s[56:57]
sequential_preLN__sliding_block__mixer_token_mlp__prompt_kernel_prek:
    v_max3_u32 v26, v115, v119, v123
    v_max_u32 v26, v26, v127
    v_cmp_eq_u32 vcc, -1, v26
    s_cbranch_vccnz sequential_preLN__sliding_block__mixer_token_mlp__prompt_kernel_nbk
sequential_preLN__sliding_block__mixer_token_mlp__prompt_kernel_nrk:
    ds_write_b128 v71, v[112:115] offset:0
    ds_write_b128 v71, v[116:119] offset:1024
    ds_write_b128 v71, v[120:123] offset:2048
    ds_write_b128 v71, v[124:127] offset:3072
    s_waitcnt lgkmcnt(0)
    s_barrier
    ds_read_b128 v[112:115], v68 offset:0
    ds_read_b128 v[116:119], v68 offset:1024
    ds_read_b128 v[120:123], v68 offset:2048
    ds_read_b128 v[124:127], v68 offset:3072
    ds_read_b128 v[128:131], v68 offset:4096
    ds_read_b128 v[132:135], v68 offset:5120
    ds_read_b128 v[136:139], v68 offset:6144
    ds_read_b128 v[140:143], v68 offset:7168
    ds_read_b128 v[144:147], v68 offset:8192
    s_waitcnt lgkmcnt(8)
    v_mfma_f32_16x16x32_bf16 v[208:211], v[112:115], v[72:75], v[96:99]
    s_mov_b32 s47, 0
    s_add_u32 m0, s48, 0
    s_nop 0
    buffer_load_dwordx4 v18, s[24:27], s47 offen offset:0 lds
    ds_read_b128 v[148:151], v68 offset:9216
    s_waitcnt lgkmcnt(8)
    v_mfma_f32_16x16x32_bf16 v[216:219], v[116:119], v[72:75], 0
    v_mfma_f32_16x16x32_bf16 v[220:223], v[116:119], v[76:79], v[96:99]
    buffer_load_dwordx4 v19, s[24:27], s47 offen offset:1024 lds
    buffer_load_dwordx4 v20, s[24:27], s47 offen offset:2048 lds
    ds_read_b128 v[152:155], v68 offset:10240
    s_waitcnt lgkmcnt(8)
    v_mfma_f32_16x16x32_bf16 v[224:227], v[120:123], v[72:75], 0
    v_mfma_f32_16x16x32_bf16 v[228:231], v[120:123], v[76:79], 0
    buffer_load_dwordx4 v21, s[24:27], s47 offen offset:3072 lds
    s_mov_b32 s47, 28672
    s_add_u32 m0, s48, 4096
    s_nop 0
    v_max3_f32 v22, v208, v209, v210
    v_max_f32 v22, v22, v211
    ds_read_b128 v[156:159], v68 offset:11264
    s_waitcnt lgkmcnt(8)
    v_mfma_f32_16x16x32_bf16 v[232:235], v[124:127], v[72:75], 0
    v_mfma_f32_16x16x32_bf16 v[236:239], v[124:127], v[76:79], 0
    buffer_load_dwordx4 v18, s[24:27], s47 offen offset:0 lds
    buffer_load_dwordx4 v19, s[24:27], s47 offen offset:1024 lds
    v_max3_f32 v22, v22, v216, v217
    v_max3_f32 v22, v22, v218, v219
    v_max3_f32 v23, v220, v221, v222
    v_max_f32 v23, v23, v223
    ds_read_b128 v[160:163], v68 offset:12288
    s_waitcnt lgkmcnt(8)
    v_mfma_f32_16x16x32_bf16 v[208:211], v[128:131], v[72:75], 0
    v_mfma_f32_16x16x32_bf16 v[212:215], v[128:131], v[76:79], 0
    buffer_load_dwordx4 v20, s[24:27], s47 offen offset:2048 lds
    buffer_load_dwordx4 v21, s[24:27], s47 offen offset:3072 lds
    v_max3_f32 v22, v22, v224, v225
    v_max3_f32 v22, v22, v226, v227
    v_max3_f32 v23, v23, v228, v229
    v_max3_f32 v23, v23, v230, v231
    ds_read_b128 v[164:167], v68 offset:13312
    s_waitcnt lgkmcnt(8)
    v_mfma_f32_16x16x32_bf16 v[216:219], v[132:135], v[72:75], 0
    v_mfma_f32_16x16x32_bf16 v[220:223], v[132:135], v[76:79], 0
    s_mov_b32 s47, 57344
    s_add_u32 m0, s48, 8192
    s_nop 0
    buffer_load_dwordx4 v18, s[24:27], s47 offen offset:0 lds
    v_max3_f32 v22, v22, v232, v233
    v_max3_f32 v22, v22, v234, v235
    v_max3_f32 v23, v23, v236, v237
    v_max3_f32 v23, v23, v238, v239
    ds_read_b128 v[168:171], v68 offset:14336
    s_waitcnt lgkmcnt(8)
    v_mfma_f32_16x16x32_bf16 v[224:227], v[136:139], v[72:75], 0
    v_mfma_f32_16x16x32_bf16 v[228:231], v[136:139], v[76:79], 0
    buffer_load_dwordx4 v19, s[24:27], s47 offen offset:1024 lds
    buffer_load_dwordx4 v20, s[24:27], s47 offen offset:2048 lds
    v_max3_f32 v22, v22, v208, v209
    v_max3_f32 v22, v22, v210, v211
    v_max3_f32 v23, v23, v212, v213
    v_max3_f32 v23, v23, v214, v215
    ds_read_b128 v[172:175], v68 offset:15360
    s_waitcnt lgkmcnt(8)
    v_mfma_f32_16x16x32_bf16 v[232:235], v[140:143], v[72:75], 0
    v_mfma_f32_16x16x32_bf16 v[236:239], v[140:143], v[76:79], 0
    buffer_load_dwordx4 v21, s[24:27], s47 offen offset:3072 lds
    s_mov_b32 s47, 86016
    s_add_u32 m0, s48, 12288
    s_nop 0
    v_max3_f32 v22, v22, v216, v217
    v_max3_f32 v22, v22, v218, v219
    v_max3_f32 v23, v23, v220, v221
    v_max3_f32 v23, v23, v222, v223
    ds_read_b128 v[176:179], v68 offset:16384
    s_waitcnt lgkmcnt(8)
    v_mfma_f32_16x16x32_bf16 v[208:211], v[144:147], v[72:75], 0
    v_mfma_f32_16x16x32_bf16 v[212:215], v[144:147], v[76:79], 0
    buffer_load_dwordx4 v18, s[24:27], s47 offen offset:0 lds
    buffer_load_dwordx4 v19, s[24:27], s47 offen offset:1024 lds
    v_max3_f32 v22, v22, v224, v225
    v_max3_f32 v22, v22, v226, v227
    v_max3_f32 v23, v23, v228, v229
    v_max3_f32 v23, v23, v230, v231
    ds_read_b128 v[180:183], v68 offset:17408
    s_waitcnt lgkmcnt(8)
    v_mfma_f32_16x16x32_bf16 v[216:219], v[148:151], v[72:75], 0
    v_mfma_f32_16x16x32_bf16 v[220:223], v[148:151], v[76:79], 0
    s_add_u32 s47, s92, 0
    s_and_b32 s47, s47, 15
    s_mul_i32 s47, s47, 114688
    s_add_u32 m0, s48, 16384
    s_nop 0
    buffer_load_dwordx4 v14, s[16:19], s47 offen offset:0 lds
    v_max3_f32 v22, v22, v232, v233
    v_max3_f32 v22, v22, v234, v235
    v_max3_f32 v23, v23, v236, v237
    v_max3_f32 v23, v23, v238, v239
    s_waitcnt lgkmcnt(7)
    v_mfma_f32_16x16x32_bf16 v[224:227], v[152:155], v[72:75], 0
    v_mfma_f32_16x16x32_bf16 v[228:231], v[152:155], v[76:79], 0
    buffer_load_dwordx4 v15, s[16:19], s47 offen offset:1024 lds
    buffer_load_dwordx4 v16, s[16:19], s47 offen offset:2048 lds
    v_max3_f32 v22, v22, v208, v209
    v_max3_f32 v22, v22, v210, v211
    v_max3_f32 v23, v23, v212, v213
    v_max3_f32 v23, v23, v214, v215
    s_waitcnt lgkmcnt(6)
    v_mfma_f32_16x16x32_bf16 v[232:235], v[156:159], v[72:75], 0
    v_mfma_f32_16x16x32_bf16 v[236:239], v[156:159], v[76:79], 0
    buffer_load_dwordx4 v17, s[16:19], s47 offen offset:3072 lds
    s_add_u32 s47, s92, 1
    s_and_b32 s47, s47, 15
    s_mul_i32 s47, s47, 114688
    s_add_u32 m0, s48, 20480
    s_nop 0
    v_max3_f32 v22, v22, v216, v217
    v_max3_f32 v22, v22, v218, v219
    v_max3_f32 v23, v23, v220, v221
    v_max3_f32 v23, v23, v222, v223
    s_waitcnt lgkmcnt(5)
    v_mfma_f32_16x16x32_bf16 v[208:211], v[160:163], v[72:75], 0
    v_mfma_f32_16x16x32_bf16 v[212:215], v[160:163], v[76:79], 0
    buffer_load_dwordx4 v14, s[16:19], s47 offen offset:0 lds
    buffer_load_dwordx4 v15, s[16:19], s47 offen offset:1024 lds
    v_max3_f32 v22, v22, v224, v225
    v_max3_f32 v22, v22, v226, v227
    v_max3_f32 v23, v23, v228, v229
    v_max3_f32 v23, v23, v230, v231
    s_waitcnt vmcnt(27)
    s_lshl_b32 s42, s41, 1
    s_add_u32 s42, s42, s36
    s_cmp_lt_u32 s42, 4
    s_cbranch_scc0 sequential_preLN__sliding_block__mixer_token_mlp__prompt_kernel_prev
    v_mov_b32 v26, 0xfb80fb80
    v_mov_b32 v184, 0
    v_mov_b32 v185, 0
    v_mov_b32 v186, 0
    v_mov_b32 v187, 0
    v_mov_b32 v188, 0
    v_mov_b32 v189, 0
    v_mov_b32 v190, 0
    v_mov_b32 v191, 0
    v_mov_b32 v192, 0
    v_mov_b32 v193, 0
    v_mov_b32 v194, 0
    v_mov_b32 v195, 0
    v_mov_b32 v196, 0
    v_mov_b32 v197, 0
    v_mov_b32 v198, 0
    v_mov_b32 v199, 0
sequential_preLN__sliding_block__mixer_token_mlp__prompt_kernel_prev:
    v_max3_u32 v26, v187, v191, v195
    v_max_u32 v26, v26, v199
    v_cmp_eq_u32 vcc, -1, v26
    s_cbranch_vccnz sequential_preLN__sliding_block__mixer_token_mlp__prompt_kernel_nbv
sequential_preLN__sliding_block__mixer_token_mlp__prompt_kernel_nrv:
    ds_write_b128 v71, v[184:187] offset:24576
    ds_write_b128 v71, v[188:191] offset:25600
    ds_write_b128 v71, v[192:195] offset:26624
    ds_write_b128 v71, v[196:199] offset:27648
    s_waitcnt lgkmcnt(8)
    v_mfma_f32_16x16x32_bf16 v[216:219], v[164:167], v[72:75], 0
    v_mfma_f32_16x16x32_bf16 v[220:223], v[164:167], v[76:79], 0
    buffer_load_dwordx4 v16, s[16:19], s47 offen offset:2048 lds
    buffer_load_dwordx4 v17, s[16:19], s47 offen offset:3072 lds
    v_max3_f32 v22, v22, v232, v233
    v_max3_f32 v22, v22, v234, v235
    v_max3_f32 v23, v23, v236, v237
    v_max3_f32 v23, v23, v238, v239
    s_waitcnt lgkmcnt(7)
    v_mfma_f32_16x16x32_bf16 v[224:227], v[168:171], v[72:75], 0
    v_mfma_f32_16x16x32_bf16 v[228:231], v[168:171], v[76:79], 0
    s_add_u32 s47, s92, 2
    s_and_b32 s47, s47, 15
    s_mul_i32 s47, s47, 114688
    s_add_u32 m0, s48, 24576
    s_nop 0
    buffer_load_dwordx4 v14, s[16:19], s47 offen offset:0 lds
    v_max3_f32 v22, v22, v208, v209
    v_max3_f32 v22, v22, v210, v211
    v_max3_f32 v23, v23, v212, v213
    v_max3_f32 v23, v23, v214, v215
    s_waitcnt lgkmcnt(6)
    v_mfma_f32_16x16x32_bf16 v[232:235], v[172:175], v[72:75], 0
    v_mfma_f32_16x16x32_bf16 v[236:239], v[172:175], v[76:79], 0
    buffer_load_dwordx4 v15, s[16:19], s47 offen offset:1024 lds
    v_max3_f32 v22, v22, v216, v217
    v_max3_f32 v22, v22, v218, v219
    v_max3_f32 v23, v23, v220, v221
    v_max3_f32 v23, v23, v222, v223
    s_waitcnt lgkmcnt(5)
    v_mfma_f32_16x16x32_bf16 v[208:211], v[176:179], v[72:75], v[100:103]
    v_mfma_f32_16x16x32_bf16 v[212:215], v[176:179], v[76:79], 0
    buffer_load_dwordx4 v16, s[16:19], s47 offen offset:2048 lds
    v_max3_f32 v22, v22, v224, v225
    v_max3_f32 v22, v22, v226, v227
    v_max3_f32 v23, v23, v228, v229
    v_max3_f32 v23, v23, v230, v231
    s_waitcnt lgkmcnt(4)
    v_mfma_f32_16x16x32_bf16 v[220:223], v[180:183], v[76:79], v[100:103]
    buffer_load_dwordx4 v17, s[16:19], s47 offen offset:3072 lds
    v_max3_f32 v22, v22, v232, v233
    v_max3_f32 v22, v22, v234, v235
    v_max3_f32 v23, v23, v236, v237
    v_max3_f32 v23, v23, v238, v239
    s_waitcnt lgkmcnt(0)
    s_waitcnt vmcnt(26)
    s_barrier
    s_cmp_lg_u32 s36, 0
    s_cbranch_scc1 fl2_36
    s_mul_i32 s42, s2, 64
    s_add_u32 s42, s42, 15220736
    s_mov_b64 exec, 1
    buffer_store_dword v104, off, s[12:15], s42 sc1
    s_mov_b64 exec, -1
fl2_36:
    ds_read_b128 v[184:187], v69 offset:0
    ds_read_b128 v[188:191], v69 offset:1024
    ds_read_b128 v[192:195], v69 offset:2048
    ds_read_b128 v[196:199], v69 offset:3072
    v_max3_f32 v22, v22, v208, v209
    v_max3_f32 v22, v22, v210, v211
    v_max3_f32 v23, v23, v212, v213
    v_max3_f32 v23, v23, v214, v215
    s_nop 3
    v_max3_f32 v23, v23, v220, v221
    v_max3_f32 v23, v23, v222, v223
    v_mov_b32 v24, v22
    v_mov_b32 v25, v23
    s_nop 0
    v_permlane32_swap_b32 v22, v24
    v_permlane32_swap_b32 v23, v25
    s_nop 0
    v_max_f32 v22, v22, v24
    v_max_f32 v23, v23, v25
    v_mov_b32 v24, v22
    v_mov_b32 v25, v23
    s_nop 0
    v_permlane16_swap_b32 v22, v24
    v_permlane16_swap_b32 v23, v25
    s_nop 0
    v_max_f32 v22, v22, v24
    v_max_f32 v23, v23, v25
    v_sub_f32 v104, 0, v22
    v_sub_f32 v105, 0, v22
    v_sub_f32 v106, 0, v22
    v_sub_f32 v107, 0, v22
    v_sub_f32 v108, 0, v23
    v_sub_f32 v109, 0, v23
    v_sub_f32 v110, 0, v23
    v_sub_f32 v111, 0, v23
    s_nop 0
    v_add_f32 v208, v96, v104
    v_add_f32 v209, v97, v104
    v_add_f32 v210, v98, v104
    v_add_f32 v211, v99, v104
    s_nop 1
    v_mfma_f32_16x16x32_bf16 v[208:211], v[112:115], v[72:75], v[208:211]
    v_mfma_f32_16x16x32_bf16 v[216:219], v[116:119], v[72:75], v[104:107]
    v_add_f32 v220, v96, v108
    v_add_f32 v221, v97, v108
    v_add_f32 v222, v98, v108
    v_add_f32 v223, v99, v108
    s_nop 1
    v_mfma_f32_16x16x32_bf16 v[220:223], v[116:119], v[76:79], v[220:223]
    s_nop 7
    v_exp_f32 v208, v208
    s_lshl_b32 s42, s93, 5
    s_mul_i32 s43, s36, 56
    s_add_u32 s42, s42, s43
    s_add_u32 s42, s42, 0
    v_min_u32 v48, 55, v1
    v_add_u32 v48, s42, v48
    v_subrev_u32 v49, 448, v48
    v_min_u32 v48, v48, v49
    s_and_b32 s42, s37, 3
    s_mul_i32 s42, s42, 1835008
    s_lshl_b32 s43, s38, 7
    s_add_u32 s42, s42, s43
    v_lshlrev_b32 v48, 12, v48
    buffer_load_dword v50, v48, s[20:23], s42 offen
    v_exp_f32 v209, v209
    v_mfma_f32_16x16x32_bf16 v[224:227], v[120:123], v[72:75], v[104:107]
    v_exp_f32 v210, v210
    s_waitcnt vmcnt(23)
    ds_read_b64_tr_b16 a[192:193], v5 offset:0
    v_exp_f32 v211, v211
    v_mfma_f32_16x16x32_bf16 v[228:231], v[120:123], v[76:79], v[108:111]
    v_exp_f32 v216, v216
    ds_read_b64_tr_b16 a[194:195], v5 offset:2048
    v_exp_f32 v217, v217
    v_mfma_f32_16x16x32_bf16 v[232:235], v[124:127], v[72:75], v[104:107]
    v_exp_f32 v218, v218
    ds_read_b64_tr_b16 a[196:197], v6 offset:0
    v_exp_f32 v219, v219
    v_mfma_f32_16x16x32_bf16 v[236:239], v[124:127], v[76:79], v[108:111]
    v_exp_f32 v220, v220
    ds_read_b64_tr_b16 a[198:199], v6 offset:2048
    v_exp_f32 v221, v221
    ds_read_b64_tr_b16 a[200:201], v5 offset:1024
    v_exp_f32 v222, v222
    ds_read_b64_tr_b16 a[202:203], v5 offset:3072
    v_exp_f32 v223, v223
    ds_read_b64_tr_b16 a[204:205], v6 offset:1024
    ds_read_b128 v[200:203], v69 offset:4096
    ds_read_b128 v[204:207], v69 offset:5120
    v_mov_b32 v244, 0
    v_mov_b32 v245, 0
    v_cvt_pk_bf16_f32 v240, v208, v209
    ds_read_b64_tr_b16 a[206:207], v6 offset:3072
    v_cvt_pk_bf16_f32 v241, v210, v211
    s_waitcnt vmcnt(19)
    ds_read_b64_tr_b16 a[208:209], v5 offset:3072
    v_cvt_pk_bf16_f32 v242, v216, v217
    ds_read_b64_tr_b16 a[210:211], v5 offset:5120
    v_cvt_pk_bf16_f32 v243, v218, v219
    v_cvt_pk_bf16_f32 v246, v220, v221
    v_cvt_pk_bf16_f32 v247, v222, v223
    v_exp_f32 v224, v224
    ds_read_b64_tr_b16 a[212:213], v6 offset:3072
    v_exp_f32 v225, v225
    s_waitcnt lgkmcnt(15)
    v_mfma_f32_16x16x32_bf16 v[80:83], v[184:187], v[240:243], 0
    v_exp_f32 v226, v226
    ds_read_b64_tr_b16 a[214:215], v6 offset:5120
    v_exp_f32 v227, v227
    v_mfma_f32_16x16x32_bf16 v[84:87], v[188:191], v[240:243], 0
    v_exp_f32 v228, v228
    ds_read_b64_tr_b16 a[216:217], v5 offset:4096
    v_exp_f32 v229, v229
    v_mfma_f32_16x16x32_bf16 v[88:91], v[184:187], v[244:247], 0
    v_exp_f32 v230, v230
    ds_read_b64_tr_b16 a[218:219], v5 offset:6144
    v_exp_f32 v231, v231
    v_mfma_f32_16x16x32_bf16 v[92:95], v[188:191], v[244:247], 0
    ds_read_b128 v[184:187], v69 offset:6144
    ds_read_b128 v[188:191], v69 offset:7168
    v_exp_f32 v232, v232
    ds_read_b64_tr_b16 a[220:221], v6 offset:4096
    v_exp_f32 v233, v233
    v_mfma_f32_16x16x32_bf16 v[208:211], v[128:131], v[72:75], v[104:107]
    v_exp_f32 v234, v234
    ds_read_b64_tr_b16 a[222:223], v6 offset:6144
    v_exp_f32 v235, v235
    v_mfma_f32_16x16x32_bf16 v[212:215], v[128:131], v[76:79], v[108:111]
    v_exp_f32 v236, v236
    s_waitcnt lgkmcnt(6)
    s_add_u32 s47, s92, 3
    s_and_b32 s47, s47, 15
    s_mul_i32 s47, s47, 114688
    s_add_u32 m0, s48, 0
    s_nop 0
    v_exp_f32 v237, v237
    v_mfma_f32_16x16x32_bf16 v[216:219], v[132:135], v[72:75], v[104:107]
    v_exp_f32 v238, v238
    buffer_load_dwordx4 v14, s[16:19], s47 offen offset:0 lds
    v_exp_f32 v239, v239
    v_mfma_f32_16x16x32_bf16 v[220:223], v[132:135], v[76:79], v[108:111]
    v_cvt_pk_bf16_f32 v248, v224, v225
    buffer_load_dwordx4 v15, s[16:19], s47 offen offset:1024 lds
    v_cvt_pk_bf16_f32 v249, v226, v227
    buffer_load_dwordx4 v16, s[16:19], s47 offen offset:2048 lds
    v_cvt_pk_bf16_f32 v252, v228, v229
    buffer_load_dwordx4 v17, s[16:19], s47 offen offset:3072 lds
    v_cvt_pk_bf16_f32 v253, v230, v231
    v_cvt_pk_bf16_f32 v250, v232, v233
    v_cvt_pk_bf16_f32 v251, v234, v235
    v_cvt_pk_bf16_f32 v254, v236, v237
    v_cvt_pk_bf16_f32 v255, v238, v239
    v_exp_f32 v208, v208
    s_waitcnt vmcnt(19)
    ds_read_b64_tr_b16 a[224:225], v5 offset:7168
    v_exp_f32 v209, v209
    v_mfma_f32_16x16x32_bf16 v[80:83], v[192:195], v[248:251], v[80:83]
    v_exp_f32 v210, v210
    ds_read_b64_tr_b16 a[226:227], v5 offset:9216
    v_exp_f32 v211, v211
    v_mfma_f32_16x16x32_bf16 v[84:87], v[196:199], v[248:251], v[84:87]
    v_exp_f32 v212, v212
    ds_read_b64_tr_b16 a[228:229], v6 offset:7168
    v_exp_f32 v213, v213
    v_mfma_f32_16x16x32_bf16 v[88:91], v[192:195], v[252:255], v[88:91]
    v_exp_f32 v214, v214
    ds_read_b64_tr_b16 a[230:231], v6 offset:9216
    v_exp_f32 v215, v215
    v_mfma_f32_16x16x32_bf16 v[92:95], v[196:199], v[252:255], v[92:95]
    ds_read_b128 v[192:195], v69 offset:8192
    ds_read_b128 v[196:199], v69 offset:9216
    v_exp_f32 v216, v216
    ds_read_b64_tr_b16 a[232:233], v5 offset:8192
    v_exp_f32 v217, v217
    v_mfma_f32_16x16x32_bf16 v[224:227], v[136:139], v[72:75], v[104:107]
    v_exp_f32 v218, v218
    ds_read_b64_tr_b16 a[234:235], v5 offset:10240
    v_exp_f32 v219, v219
    v_mfma_f32_16x16x32_bf16 v[228:231], v[136:139], v[76:79], v[108:111]
    v_exp_f32 v220, v220
    ds_read_b64_tr_b16 a[236:237], v6 offset:8192
    v_exp_f32 v221, v221
    v_mfma_f32_16x16x32_bf16 v[232:235], v[140:143], v[72:75], v[104:107]
    v_exp_f32 v222, v222
    ds_read_b64_tr_b16 a[238:239], v6 offset:10240
    v_exp_f32 v223, v223
    v_mfma_f32_16x16x32_bf16 v[236:239], v[140:143], v[76:79], v[108:111]
    v_cvt_pk_bf16_f32 v240, v208, v209
    s_waitcnt lgkmcnt(6)
    s_add_u32 s47, s92, 4
    s_and_b32 s47, s47, 15
    s_mul_i32 s47, s47, 114688
    s_add_u32 m0, s48, 4096
    s_nop 0
    v_cvt_pk_bf16_f32 v241, v210, v211
    buffer_load_dwordx4 v14, s[16:19], s47 offen offset:0 lds
    v_cvt_pk_bf16_f32 v244, v212, v213
    buffer_load_dwordx4 v15, s[16:19], s47 offen offset:1024 lds
    v_cvt_pk_bf16_f32 v245, v214, v215
    v_cvt_pk_bf16_f32 v242, v216, v217
    v_cvt_pk_bf16_f32 v243, v218, v219
    v_cvt_pk_bf16_f32 v246, v220, v221
    v_cvt_pk_bf16_f32 v247, v222, v223
    v_exp_f32 v224, v224
    buffer_load_dwordx4 v16, s[16:19], s47 offen offset:2048 lds
    v_exp_f32 v225, v225
    v_mfma_f32_16x16x32_bf16 v[80:83], v[200:203], v[240:243], v[80:83]
    v_exp_f32 v226, v226
    buffer_load_dwordx4 v17, s[16:19], s47 offen offset:3072 lds
    v_exp_f32 v227, v227
    v_mfma_f32_16x16x32_bf16 v[84:87], v[204:207], v[240:243], v[84:87]
    v_exp_f32 v228, v228
    s_waitcnt vmcnt(21)
    ds_read_b64_tr_b16 a[240:241], v5 offset:10240
    v_exp_f32 v229, v229
    v_mfma_f32_16x16x32_bf16 v[88:91], v[200:203], v[244:247], v[88:91]
    v_exp_f32 v230, v230
    ds_read_b64_tr_b16 a[242:243], v5 offset:12288
    v_exp_f32 v231, v231
    v_mfma_f32_16x16x32_bf16 v[92:95], v[204:207], v[244:247], v[92:95]
    ds_read_b128 v[200:203], v69 offset:10240
    ds_read_b128 v[204:207], v69 offset:11264
    v_exp_f32 v232, v232
    ds_read_b64_tr_b16 a[244:245], v6 offset:10240
    v_exp_f32 v233, v233
    v_mfma_f32_16x16x32_bf16 v[208:211], v[144:147], v[72:75], v[104:107]
    v_exp_f32 v234, v234
    ds_read_b64_tr_b16 a[246:247], v6 offset:12288
    v_exp_f32 v235, v235
    v_mfma_f32_16x16x32_bf16 v[212:215], v[144:147], v[76:79], v[108:111]
    v_exp_f32 v236, v236
    ds_read_b64_tr_b16 a[248:249], v5 offset:11264
    v_exp_f32 v237, v237
    v_mfma_f32_16x16x32_bf16 v[216:219], v[148:151], v[72:75], v[104:107]
    v_exp_f32 v238, v238
    ds_read_b64_tr_b16 a[250:251], v5 offset:13312
    v_exp_f32 v239, v239
    v_mfma_f32_16x16x32_bf16 v[220:223], v[148:151], v[76:79], v[108:111]
    v_cvt_pk_bf16_f32 v248, v224, v225
    ds_read_b64_tr_b16 a[252:253], v6 offset:11264
    v_cvt_pk_bf16_f32 v249, v226, v227
    ds_read_b64_tr_b16 a[254:255], v6 offset:13312
    v_cvt_pk_bf16_f32 v252, v228, v229
    s_mov_b32 s32, s8
    s_mov_b32 s33, s9
    s_mov_b32 s34, 1835008
    s_mov_b32 s35, 0x00020000
    buffer_load_dwordx4 v[34:37], v44, s[32:35], 0 offen offset:0
    buffer_load_dwordx4 v[38:41], v44, s[32:35], 0 offen offset:16
    v_cvt_pk_bf16_f32 v253, v230, v231
    v_cvt_pk_bf16_f32 v250, v232, v233
    v_cvt_pk_bf16_f32 v251, v234, v235
    v_cvt_pk_bf16_f32 v254, v236, v237
    v_cvt_pk_bf16_f32 v255, v238, v239
    v_exp_f32 v208, v208
    s_waitcnt vmcnt(19)
    ds_read_b64_tr_b16 a[0:1], v5 offset:16384
    v_exp_f32 v209, v209
    v_mfma_f32_16x16x32_bf16 v[80:83], v[184:187], v[248:251], v[80:83]
    v_exp_f32 v210, v210
    ds_read_b64_tr_b16 a[2:3], v5 offset:17408
    v_exp_f32 v211, v211
    v_mfma_f32_16x16x32_bf16 v[84:87], v[188:191], v[248:251], v[84:87]
    v_exp_f32 v212, v212
    ds_read_b64_tr_b16 a[4:5], v6 offset:16384
    v_exp_f32 v213, v213
    v_mfma_f32_16x16x32_bf16 v[88:91], v[184:187], v[252:255], v[88:91]
    v_exp_f32 v214, v214
    ds_read_b64_tr_b16 a[6:7], v6 offset:17408
    v_exp_f32 v215, v215
    v_mfma_f32_16x16x32_bf16 v[92:95], v[188:191], v[252:255], v[92:95]
    ds_read_b128 v[184:187], v69 offset:12288
    ds_read_b128 v[188:191], v69 offset:13312
    v_exp_f32 v216, v216
    ds_read_b64_tr_b16 a[8:9], v5 offset:18432
    v_exp_f32 v217, v217
    v_mfma_f32_16x16x32_bf16 v[224:227], v[152:155], v[72:75], v[104:107]
    v_exp_f32 v218, v218
    ds_read_b64_tr_b16 a[10:11], v5 offset:19456
    v_exp_f32 v219, v219
    v_mfma_f32_16x16x32_bf16 v[228:231], v[152:155], v[76:79], v[108:111]
    v_exp_f32 v220, v220
    ds_read_b64_tr_b16 a[12:13], v6 offset:18432
    v_exp_f32 v221, v221
    v_mfma_f32_16x16x32_bf16 v[232:235], v[156:159], v[72:75], v[104:107]
    v_exp_f32 v222, v222
    ds_read_b64_tr_b16 a[14:15], v6 offset:19456
    v_exp_f32 v223, v223
    v_mfma_f32_16x16x32_bf16 v[236:239], v[156:159], v[76:79], v[108:111]
    v_cvt_pk_bf16_f32 v240, v208, v209
    s_waitcnt lgkmcnt(10)
    s_add_u32 s47, s92, 5
    s_and_b32 s47, s47, 15
    s_mul_i32 s47, s47, 114688
    s_add_u32 m0, s48, 8192
    s_nop 0
    v_cvt_pk_bf16_f32 v241, v210, v211
    buffer_load_dwordx4 v14, s[16:19], s47 offen offset:0 lds
    v_cvt_pk_bf16_f32 v244, v212, v213
    buffer_load_dwordx4 v15, s[16:19], s47 offen offset:1024 lds
    v_cvt_pk_bf16_f32 v245, v214, v215
    v_cvt_pk_bf16_f32 v242, v216, v217
    v_cvt_pk_bf16_f32 v243, v218, v219
    v_cvt_pk_bf16_f32 v246, v220, v221
    v_cvt_pk_bf16_f32 v247, v222, v223
    v_exp_f32 v224, v224
    buffer_load_dwordx4 v16, s[16:19], s47 offen offset:2048 lds
    v_exp_f32 v225, v225
    v_mfma_f32_16x16x32_bf16 v[80:83], v[192:195], v[240:243], v[80:83]
    v_exp_f32 v226, v226
    buffer_load_dwordx4 v17, s[16:19], s47 offen offset:3072 lds
    v_exp_f32 v227, v227
    v_mfma_f32_16x16x32_bf16 v[84:87], v[196:199], v[240:243], v[84:87]
    v_exp_f32 v228, v228
    s_add_u32 s47, s92, 6
    s_and_b32 s47, s47, 15
    s_mul_i32 s47, s47, 114688
    s_add_u32 m0, s48, 12288
    s_nop 0
    v_exp_f32 v229, v229
    v_mfma_f32_16x16x32_bf16 v[88:91], v[192:195], v[244:247], v[88:91]
    v_exp_f32 v230, v230
    buffer_load_dwordx4 v14, s[16:19], s47 offen offset:0 lds
    v_exp_f32 v231, v231
    v_mfma_f32_16x16x32_bf16 v[92:95], v[196:199], v[244:247], v[92:95]
    ds_read_b128 v[192:195], v69 offset:14336
    ds_read_b128 v[196:199], v69 offset:15360
    v_exp_f32 v232, v232
    buffer_load_dwordx4 v15, s[16:19], s47 offen offset:1024 lds
    v_exp_f32 v233, v233
    v_mfma_f32_16x16x32_bf16 v[208:211], v[160:163], v[72:75], v[104:107]
    v_exp_f32 v234, v234
    buffer_load_dwordx4 v16, s[16:19], s47 offen offset:2048 lds
    v_exp_f32 v235, v235
    v_mfma_f32_16x16x32_bf16 v[212:215], v[160:163], v[76:79], v[108:111]
    v_exp_f32 v236, v236
    buffer_load_dwordx4 v17, s[16:19], s47 offen offset:3072 lds
    v_exp_f32 v237, v237
    v_mfma_f32_16x16x32_bf16 v[216:219], v[164:167], v[72:75], v[104:107]
    v_exp_f32 v238, v238
    s_waitcnt vmcnt(23)
    ds_read_b64_tr_b16 a[16:17], v5 offset:20480
    v_exp_f32 v239, v239
    v_mfma_f32_16x16x32_bf16 v[220:223], v[164:167], v[76:79], v[108:111]
    v_cvt_pk_bf16_f32 v248, v224, v225
    ds_read_b64_tr_b16 a[18:19], v5 offset:21504
    v_cvt_pk_bf16_f32 v249, v226, v227
    ds_read_b64_tr_b16 a[20:21], v6 offset:20480
    v_cvt_pk_bf16_f32 v252, v228, v229
    ds_read_b64_tr_b16 a[22:23], v6 offset:21504
    v_cvt_pk_bf16_f32 v253, v230, v231
    v_cvt_pk_bf16_f32 v250, v232, v233
    v_cvt_pk_bf16_f32 v251, v234, v235
    v_cvt_pk_bf16_f32 v254, v236, v237
    v_cvt_pk_bf16_f32 v255, v238, v239
    v_exp_f32 v208, v208
    ds_read_b64_tr_b16 a[24:25], v5 offset:22528
    v_exp_f32 v209, v209
    v_mfma_f32_16x16x32_bf16 v[80:83], v[200:203], v[248:251], v[80:83]
    v_exp_f32 v210, v210
    ds_read_b64_tr_b16 a[26:27], v5 offset:23552
    v_exp_f32 v211, v211
    v_mfma_f32_16x16x32_bf16 v[84:87], v[204:207], v[248:251], v[84:87]
    v_exp_f32 v212, v212
    ds_read_b64_tr_b16 a[28:29], v6 offset:22528
    v_exp_f32 v213, v213
    v_mfma_f32_16x16x32_bf16 v[88:91], v[200:203], v[252:255], v[88:91]
    v_exp_f32 v214, v214
    ds_read_b64_tr_b16 a[30:31], v6 offset:23552
    v_exp_f32 v215, v215
    v_mfma_f32_16x16x32_bf16 v[92:95], v[204:207], v[252:255], v[92:95]
    ds_read_b128 v[200:203], v69 offset:16384
    ds_read_b128 v[204:207], v69 offset:17408
    v_exp_f32 v216, v216
    s_waitcnt lgkmcnt(12)
    s_add_u32 s47, s92, 7
    s_and_b32 s47, s47, 15
    s_mul_i32 s47, s47, 114688
    s_add_u32 m0, s48, 16384
    s_nop 0
    v_exp_f32 v217, v217
    v_mfma_f32_16x16x32_bf16 v[224:227], v[168:171], v[72:75], v[104:107]
    v_exp_f32 v218, v218
    buffer_load_dwordx4 v14, s[16:19], s47 offen offset:0 lds
    v_exp_f32 v219, v219
    v_mfma_f32_16x16x32_bf16 v[228:231], v[168:171], v[76:79], v[108:111]
    v_exp_f32 v220, v220
    buffer_load_dwordx4 v15, s[16:19], s47 offen offset:1024 lds
    v_exp_f32 v221, v221
    v_mfma_f32_16x16x32_bf16 v[232:235], v[172:175], v[72:75], v[104:107]
    v_exp_f32 v222, v222
    buffer_load_dwordx4 v16, s[16:19], s47 offen offset:2048 lds
    v_exp_f32 v223, v223
    v_mfma_f32_16x16x32_bf16 v[236:239], v[172:175], v[76:79], v[108:111]
    v_cvt_pk_bf16_f32 v240, v208, v209
    buffer_load_dwordx4 v17, s[16:19], s47 offen offset:3072 lds
    v_cvt_pk_bf16_f32 v241, v210, v211
    s_waitcnt vmcnt(23)
    ds_read_b64_tr_b16 a[32:33], v5 offset:24576
    v_cvt_pk_bf16_f32 v244, v212, v213
    ds_read_b64_tr_b16 a[34:35], v5 offset:25600
    v_cvt_pk_bf16_f32 v245, v214, v215
    v_cvt_pk_bf16_f32 v242, v216, v217
    v_cvt_pk_bf16_f32 v243, v218, v219
    v_cvt_pk_bf16_f32 v246, v220, v221
    v_cvt_pk_bf16_f32 v247, v222, v223
    v_exp_f32 v224, v224
    ds_read_b64_tr_b16 a[36:37], v6 offset:24576
    v_exp_f32 v225, v225
    v_mfma_f32_16x16x32_bf16 v[80:83], v[184:187], v[240:243], v[80:83]
    v_exp_f32 v226, v226
    ds_read_b64_tr_b16 a[38:39], v6 offset:25600
    v_exp_f32 v227, v227
    v_mfma_f32_16x16x32_bf16 v[84:87], v[188:191], v[240:243], v[84:87]
    v_exp_f32 v228, v228
    ds_read_b64_tr_b16 a[40:41], v5 offset:26624
    v_exp_f32 v229, v229
    v_mfma_f32_16x16x32_bf16 v[88:91], v[184:187], v[244:247], v[88:91]
    v_exp_f32 v230, v230
    ds_read_b64_tr_b16 a[42:43], v5 offset:27648
    v_exp_f32 v231, v231
    v_mfma_f32_16x16x32_bf16 v[92:95], v[188:191], v[244:247], v[92:95]
    v_exp_f32 v232, v232
    ds_read_b64_tr_b16 a[44:45], v6 offset:26624
    v_exp_f32 v233, v233
    v_add_f32 v208, v100, v104
    v_add_f32 v209, v101, v104
    v_add_f32 v210, v102, v104
    v_add_f32 v211, v103, v104
    s_nop 1
    v_mfma_f32_16x16x32_bf16 v[208:211], v[176:179], v[72:75], v[208:211]
    v_exp_f32 v234, v234
    ds_read_b64_tr_b16 a[46:47], v6 offset:27648
    v_exp_f32 v235, v235
    v_mfma_f32_16x16x32_bf16 v[212:215], v[176:179], v[76:79], v[108:111]
    v_exp_f32 v236, v236
    s_waitcnt lgkmcnt(10)
    s_add_u32 s47, s92, 8
    s_and_b32 s47, s47, 15
    s_mul_i32 s47, s47, 114688
    s_add_u32 m0, s48, 20480
    s_nop 0
    v_exp_f32 v237, v237
    v_add_f32 v220, v100, v108
    v_add_f32 v221, v101, v108
    v_add_f32 v222, v102, v108
    v_add_f32 v223, v103, v108
    s_nop 1
    v_mfma_f32_16x16x32_bf16 v[220:223], v[180:183], v[76:79], v[220:223]
    v_exp_f32 v238, v238
    buffer_load_dwordx4 v14, s[16:19], s47 offen offset:0 lds
    v_exp_f32 v239, v239
    buffer_load_dwordx4 v15, s[16:19], s47 offen offset:1024 lds
    v_cvt_pk_bf16_f32 v248, v224, v225
    buffer_load_dwordx4 v16, s[16:19], s47 offen offset:2048 lds
    v_cvt_pk_bf16_f32 v249, v226, v227
    buffer_load_dwordx4 v17, s[16:19], s47 offen offset:3072 lds
    v_cvt_pk_bf16_f32 v252, v228, v229
    v_cvt_pk_bf16_f32 v253, v230, v231
    v_cvt_pk_bf16_f32 v250, v232, v233
    v_cvt_pk_bf16_f32 v251, v234, v235
    v_cvt_pk_bf16_f32 v254, v236, v237
    v_cvt_pk_bf16_f32 v255, v238, v239
    v_exp_f32 v208, v208
    s_mov_b32 s32, s10
    s_mov_b32 s33, s11
    s_mov_b32 s34, 4096
    s_mov_b32 s35, 0x00020000
    buffer_load_ushort v13, v45, s[32:35], 0 offen
    s_mov_b32 s32, s6
    s_mov_b32 s33, s7
    s_mov_b32 s34, 3584
    s_mov_b32 s35, 0x00020000
    s_lshl2_add_u32 s42, s39, s36
    s_lshl_b32 s42, s42, 5
    buffer_load_dwordx2 v[30:31], v46, s[32:35], s42 offen offset:0
    buffer_load_dwordx2 v[32:33], v46, s[32:35], s42 offen offset:16
    v_exp_f32 v209, v209
    v_mfma_f32_16x16x32_bf16 v[80:83], v[192:195], v[248:251], v[80:83]
    v_exp_f32 v210, v210
    s_waitcnt lgkmcnt(0)
    s_add_u32 s47, s92, 9
    s_and_b32 s47, s47, 15
    s_mul_i32 s47, s47, 114688
    s_add_u32 m0, s48, 24576
    s_nop 0
    v_exp_f32 v211, v211
    v_mfma_f32_16x16x32_bf16 v[84:87], v[196:199], v[248:251], v[84:87]
    v_exp_f32 v212, v212
    buffer_load_dwordx4 v14, s[16:19], s47 offen offset:0 lds
    v_exp_f32 v213, v213
    v_mfma_f32_16x16x32_bf16 v[88:91], v[192:195], v[252:255], v[88:91]
    v_exp_f32 v214, v214
    buffer_load_dwordx4 v15, s[16:19], s47 offen offset:1024 lds
    v_exp_f32 v215, v215
    v_mfma_f32_16x16x32_bf16 v[92:95], v[196:199], v[252:255], v[92:95]
    v_exp_f32 v220, v220
    buffer_load_dwordx4 v16, s[16:19], s47 offen offset:2048 lds
    v_exp_f32 v221, v221
    buffer_load_dwordx4 v17, s[16:19], s47 offen offset:3072 lds
    v_exp_f32 v222, v222
    v_exp_f32 v223, v223
    v_mov_b32 v242, 0
    v_mov_b32 v243, 0
    v_cvt_pk_bf16_f32 v240, v208, v209
    v_cvt_pk_bf16_f32 v241, v210, v211
    v_cvt_pk_bf16_f32 v244, v212, v213
    v_cvt_pk_bf16_f32 v245, v214, v215
    v_cvt_pk_bf16_f32 v246, v220, v221
    v_cvt_pk_bf16_f32 v247, v222, v223
    s_nop 1
    v_mfma_f32_16x16x32_bf16 v[80:83], v[200:203], v[240:243], v[80:83]
    v_mfma_f32_16x16x32_bf16 v[84:87], v[204:207], v[240:243], v[84:87]
    v_mfma_f32_16x16x32_bf16 v[88:91], v[200:203], v[244:247], v[88:91]
    v_mfma_f32_16x16x32_bf16 v[92:95], v[204:207], v[244:247], v[92:95]
    s_lshl2_add_u32 s42, s41, s36
    s_lshl4_add_u32 s42, s42, s40
    s_lshl_b32 s42, s42, 11
    s_add_u32 s42, s42, 7340032
    s_nop 3
    v_cndmask_b32 v22, v84, v80, s[52:53]
    v_cndmask_b32 v24, v92, v88, s[52:53]
    v_mov_b32 v23, v22
    v_mov_b32 v25, v24
    s_nop 0
    v_permlane32_swap_b32 v22, v23
    v_permlane32_swap_b32 v24, v25
    s_nop 0
    v_cndmask_b32 v22, v23, v22, s[52:53]
    v_cndmask_b32 v24, v25, v24, s[52:53]
    v_mov_b32 v23, v22
    v_mov_b32 v25, v24
    s_nop 0
    v_permlane16_swap_b32 v22, v23
    v_permlane16_swap_b32 v24, v25
    s_nop 0
    v_cndmask_b32 v22, v23, v22, s[52:53]
    v_cndmask_b32 v24, v25, v24, s[52:53]
    v_rcp_f32 v22, v22
    v_rcp_f32 v24, v24
    v_mul_f32 v80, v80, v22
    v_mul_f32 v81, v81, v22
    v_mul_f32 v82, v82, v22
    v_mul_f32 v83, v83, v22
    v_mul_f32 v84, v84, v22
    v_mul_f32 v85, v85, v22
    v_mul_f32 v86, v86, v22
    v_mul_f32 v87, v87, v22
    v_cvt_pk_bf16_f32 v72, v80, v81
    v_cvt_pk_bf16_f32 v73, v82, v83
    v_cvt_pk_bf16_f32 v74, v84, v85
    v_cvt_pk_bf16_f32 v75, v86, v87
    v_cndmask_b32 v72, v72, 0, s[54:55]
    v_cndmask_b32 v74, v74, 0, s[56:57]
    v_cndmask_b32 v73, v73, 0, s[54:55]
    v_cndmask_b32 v75, v75, 0, s[56:57]
    buffer_store_dwordx4 v[72:75], v70, s[12:15], s42 offen offset:0 sc1
    v_mul_f32 v88, v88, v24
    v_mul_f32 v89, v89, v24
    v_mul_f32 v90, v90, v24
    v_mul_f32 v91, v91, v24
    v_mul_f32 v92, v92, v24
    v_mul_f32 v93, v93, v24
    v_mul_f32 v94, v94, v24
    v_mul_f32 v95, v95, v24
    v_cvt_pk_bf16_f32 v76, v88, v89
    v_cvt_pk_bf16_f32 v77, v90, v91
    v_cvt_pk_bf16_f32 v78, v92, v93
    v_cvt_pk_bf16_f32 v79, v94, v95
    v_cndmask_b32 v76, v76, 0, s[54:55]
    v_cndmask_b32 v78, v78, 0, s[56:57]
    v_cndmask_b32 v77, v77, 0, s[54:55]
    v_cndmask_b32 v79, v79, 0, s[56:57]
    buffer_store_dwordx4 v[76:79], v70, s[12:15], s42 offen offset:256 sc1
    v_lshlrev_b32 v71, 6, v1
    s_mul_i32 s95, s36, 4096
    s_add_u32 s95, s95, 15220736
    buffer_load_dword v70, v71, s[12:15], s95 offen sc1
    v_lshrrev_b32 v22, 3, v1
    v_lshrrev_b32 v23, 2, v1
    v_and_b32 v23, 4, v23
    v_and_b32 v24, 7, v1
    v_xor_b32 v23, v23, v24
    v_lshlrev_b32 v23, 4, v23
    s_mul_i32 s42, s36, 1835008
    s_mul_i32 s43, s38, 128
    s_add_u32 s42, s42, s43
    v_mul_u32_u24 v24, 4096, v22
    v_add3_u32 v18, v24, v23, s42
    v_add_u32 v19, 31744, v18
    v_add_u32 v20, 63488, v18
    v_add_u32 v21, 95232, v18
    s_waitcnt vmcnt(30)
    ds_read_b64_tr_b16 a[48:49], v5 offset:0
    ds_read_b64_tr_b16 a[50:51], v5 offset:1024
    ds_read_b64_tr_b16 a[52:53], v6 offset:0
    ds_read_b64_tr_b16 a[54:55], v6 offset:1024
    ds_read_b64_tr_b16 a[56:57], v5 offset:2048
    ds_read_b64_tr_b16 a[58:59], v5 offset:3072
    ds_read_b64_tr_b16 a[60:61], v6 offset:2048
    ds_read_b64_tr_b16 a[62:63], v6 offset:3072
    s_waitcnt vmcnt(26)
    ds_read_b64_tr_b16 a[64:65], v5 offset:4096
    ds_read_b64_tr_b16 a[66:67], v5 offset:5120
    ds_read_b64_tr_b16 a[68:69], v6 offset:4096
    ds_read_b64_tr_b16 a[70:71], v6 offset:5120
    ds_read_b64_tr_b16 a[72:73], v5 offset:6144
    ds_read_b64_tr_b16 a[74:75], v5 offset:7168
    ds_read_b64_tr_b16 a[76:77], v6 offset:6144
    ds_read_b64_tr_b16 a[78:79], v6 offset:7168
    s_waitcnt lgkmcnt(8)
    s_add_u32 s47, s92, 10
    s_and_b32 s47, s47, 15
    s_mul_i32 s47, s47, 114688
    s_add_u32 m0, s48, 0
    s_nop 0
    buffer_load_dwordx4 v14, s[16:19], s47 offen offset:0 lds
    buffer_load_dwordx4 v15, s[16:19], s47 offen offset:1024 lds
    buffer_load_dwordx4 v16, s[16:19], s47 offen offset:2048 lds
    buffer_load_dwordx4 v17, s[16:19], s47 offen offset:3072 lds
    s_waitcnt vmcnt(24)
    ds_read_b64_tr_b16 a[80:81], v5 offset:8192
    ds_read_b64_tr_b16 a[82:83], v5 offset:9216
    ds_read_b64_tr_b16 a[84:85], v6 offset:8192
    ds_read_b64_tr_b16 a[86:87], v6 offset:9216
    ds_read_b64_tr_b16 a[88:89], v5 offset:10240
    ds_read_b64_tr_b16 a[90:91], v5 offset:11264
    ds_read_b64_tr_b16 a[92:93], v6 offset:10240
    ds_read_b64_tr_b16 a[94:95], v6 offset:11264
    s_waitcnt lgkmcnt(8)
    s_add_u32 s47, s92, 11
    s_and_b32 s47, s47, 15
    s_mul_i32 s47, s47, 114688
    s_add_u32 m0, s48, 4096
    s_nop 0
    buffer_load_dwordx4 v14, s[16:19], s47 offen offset:0 lds
    buffer_load_dwordx4 v15, s[16:19], s47 offen offset:1024 lds
    buffer_load_dwordx4 v16, s[16:19], s47 offen offset:2048 lds
    buffer_load_dwordx4 v17, s[16:19], s47 offen offset:3072 lds
    s_waitcnt vmcnt(24)
    ds_read_b64_tr_b16 a[96:97], v5 offset:12288
    ds_read_b64_tr_b16 a[98:99], v5 offset:13312
    ds_read_b64_tr_b16 a[100:101], v6 offset:12288
    ds_read_b64_tr_b16 a[102:103], v6 offset:13312
    ds_read_b64_tr_b16 a[104:105], v5 offset:14336
    ds_read_b64_tr_b16 a[106:107], v5 offset:15360
    ds_read_b64_tr_b16 a[108:109], v6 offset:14336
    ds_read_b64_tr_b16 a[110:111], v6 offset:15360
    s_waitcnt lgkmcnt(8)
    s_add_u32 s47, s93, 0
    s_sub_u32 s51, s47, 14
    s_min_u32 s47, s47, s51
    s_mul_i32 s47, s47, 131072
    s_add_u32 m0, s48, 8192
    s_nop 0
    buffer_load_dwordx4 v18, s[20:23], s47 offen offset:0 lds
    buffer_load_dwordx4 v19, s[20:23], s47 offen offset:1024 lds
    buffer_load_dwordx4 v20, s[20:23], s47 offen offset:2048 lds
    buffer_load_dwordx4 v21, s[20:23], s47 offen offset:3072 lds
    s_waitcnt vmcnt(24)
    ds_read_b64_tr_b16 a[112:113], v5 offset:16384
    ds_read_b64_tr_b16 a[114:115], v5 offset:17408
    ds_read_b64_tr_b16 a[116:117], v6 offset:16384
    ds_read_b64_tr_b16 a[118:119], v6 offset:17408
    ds_read_b64_tr_b16 a[120:121], v5 offset:18432
    ds_read_b64_tr_b16 a[122:123], v5 offset:19456
    ds_read_b64_tr_b16 a[124:125], v6 offset:18432
    ds_read_b64_tr_b16 a[126:127], v6 offset:19456
    s_waitcnt vmcnt(20)
    ds_read_b64_tr_b16 a[128:129], v5 offset:20480
    ds_read_b64_tr_b16 a[130:131], v5 offset:21504
    ds_read_b64_tr_b16 a[132:133], v6 offset:20480
    ds_read_b64_tr_b16 a[134:135], v6 offset:21504
    ds_read_b64_tr_b16 a[136:137], v5 offset:22528
    ds_read_b64_tr_b16 a[138:139], v5 offset:23552
    ds_read_b64_tr_b16 a[140:141], v6 offset:22528
    ds_read_b64_tr_b16 a[142:143], v6 offset:23552
    s_waitcnt vmcnt(13)
    ds_read_b64_tr_b16 a[144:145], v5 offset:24576
    ds_read_b64_tr_b16 a[146:147], v5 offset:25600
    ds_read_b64_tr_b16 a[148:149], v6 offset:24576
    ds_read_b64_tr_b16 a[150:151], v6 offset:25600
    ds_read_b64_tr_b16 a[152:153], v5 offset:26624
    ds_read_b64_tr_b16 a[154:155], v5 offset:27648
    ds_read_b64_tr_b16 a[156:157], v6 offset:26624
    ds_read_b64_tr_b16 a[158:159], v6 offset:27648
    v_permlane32_swap_b32 v34, v36
    v_permlane32_swap_b32 v38, v40
    v_permlane32_swap_b32 v35, v37
    v_permlane32_swap_b32 v39, v41
    s_waitcnt vmcnt(0)
    s_mov_b32 s49, 0
f2lp_38:
    v_cmp_ne_u32 vcc, -1, v70
    s_cbranch_vccz f2ok_37
    buffer_load_dword v70, v71, s[12:15], s95 offen sc1
    s_add_u32 s49, s49, 1
    s_cmp_lt_u32 s49, 20000
    s_waitcnt vmcnt(0)
    s_cbranch_scc1 f2lp_38
f2ok_37:
    s_barrier
    s_waitcnt lgkmcnt(0)
    s_mov_b32 s49, 0
    s_add_u32 s46, s94, 0
    s_add_u32 s47, s94, 32768
    buffer_load_dwordx4 v[132:135], v2, s[12:15], s46 offen offset:0 sc1
    buffer_load_dwordx4 v[136:139], v2, s[12:15], s47 offen offset:0 sc1
    buffer_load_dwordx4 v[140:143], v2, s[12:15], s46 offen offset:1024 sc1
    buffer_load_dwordx4 v[144:147], v2, s[12:15], s47 offen offset:1024 sc1
    buffer_load_dwordx4 v[148:151], v2, s[12:15], s46 offen offset:2048 sc1
    buffer_load_dwordx4 v[152:155], v2, s[12:15], s47 offen offset:2048 sc1
    buffer_load_dwordx4 v[156:159], v2, s[12:15], s46 offen offset:3072 sc1
    buffer_load_dwordx4 v[160:163], v2, s[12:15], s47 offen offset:3072 sc1
    s_add_u32 s46, s94, 4096
    s_add_u32 s47, s94, 36864
    buffer_load_dwordx4 v[164:167], v2, s[12:15], s46 offen offset:0 sc1
    buffer_load_dwordx4 v[168:171], v2, s[12:15], s47 offen offset:0 sc1
    buffer_load_dwordx4 v[172:175], v2, s[12:15], s46 offen offset:1024 sc1
    buffer_load_dwordx4 v[176:179], v2, s[12:15], s47 offen offset:1024 sc1
    buffer_load_dwordx4 v[180:183], v2, s[12:15], s46 offen offset:2048 sc1
    buffer_load_dwordx4 v[184:187], v2, s[12:15], s47 offen offset:2048 sc1
    buffer_load_dwordx4 v[188:191], v2, s[12:15], s46 offen offset:3072 sc1
    buffer_load_dwordx4 v[192:195], v2, s[12:15], s47 offen offset:3072 sc1
    s_waitcnt vmcnt(14)
    v_max_u32 v22, v135, v139
    v_cmp_eq_u32 vcc, -1, v22
    s_cbranch_vccnz sequential_preLN__sliding_block__mixer_token_mlp__prompt_kernel_os0
sequential_preLN__sliding_block__mixer_token_mlp__prompt_kernel_or0:
    v_mfma_f32_32x32x16_bf16 v[68:83], a[192:195], v[132:135], 0
    v_mfma_f32_32x32x16_bf16 v[84:99], a[196:199], v[132:135], 0
    v_mfma_f32_32x32x16_bf16 v[100:115], a[192:195], v[136:139], 0
    v_mfma_f32_32x32x16_bf16 v[116:131], a[196:199], v[136:139], 0
    s_waitcnt vmcnt(12)
    v_max_u32 v22, v143, v147
    v_cmp_eq_u32 vcc, -1, v22
    s_cbranch_vccnz sequential_preLN__sliding_block__mixer_token_mlp__prompt_kernel_os1
sequential_preLN__sliding_block__mixer_token_mlp__prompt_kernel_or1:
    v_mfma_f32_32x32x16_bf16 v[68:83], a[200:203], v[140:143], v[68:83]
    v_mfma_f32_32x32x16_bf16 v[84:99], a[204:207], v[140:143], v[84:99]
    v_mfma_f32_32x32x16_bf16 v[100:115], a[200:203], v[144:147], v[100:115]
    v_mfma_f32_32x32x16_bf16 v[116:131], a[204:207], v[144:147], v[116:131]
    s_waitcnt vmcnt(10)
    v_max_u32 v22, v151, v155
    v_cmp_eq_u32 vcc, -1, v22
    s_cbranch_vccnz sequential_preLN__sliding_block__mixer_token_mlp__prompt_kernel_os2
sequential_preLN__sliding_block__mixer_token_mlp__prompt_kernel_or2:
    v_mfma_f32_32x32x16_bf16 v[68:83], a[208:211], v[148:151], v[68:83]
    v_mfma_f32_32x32x16_bf16 v[84:99], a[212:215], v[148:151], v[84:99]
    v_mfma_f32_32x32x16_bf16 v[100:115], a[208:211], v[152:155], v[100:115]
    v_mfma_f32_32x32x16_bf16 v[116:131], a[212:215], v[152:155], v[116:131]
    s_waitcnt vmcnt(8)
    v_max_u32 v22, v159, v163
    v_cmp_eq_u32 vcc, -1, v22
    s_cbranch_vccnz sequential_preLN__sliding_block__mixer_token_mlp__prompt_kernel_os3
sequential_preLN__sliding_block__mixer_token_mlp__prompt_kernel_or3:
    v_mfma_f32_32x32x16_bf16 v[68:83], a[216:219], v[156:159], v[68:83]
    v_mfma_f32_32x32x16_bf16 v[84:99], a[220:223], v[156:159], v[84:99]
    v_mfma_f32_32x32x16_bf16 v[100:115], a[216:219], v[160:163], v[100:115]
    v_mfma_f32_32x32x16_bf16 v[116:131], a[220:223], v[160:163], v[116:131]
    s_waitcnt vmcnt(6)
    v_max_u32 v22, v167, v171
    v_cmp_eq_u32 vcc, -1, v22
    s_cbranch_vccnz sequential_preLN__sliding_block__mixer_token_mlp__prompt_kernel_os4
sequential_preLN__sliding_block__mixer_token_mlp__prompt_kernel_or4:
    v_mfma_f32_32x32x16_bf16 v[68:83], a[224:227], v[164:167], v[68:83]
    s_add_u32 s47, s92, 12
    s_and_b32 s47, s47, 15
    s_mul_i32 s47, s47, 114688
    s_add_u32 m0, s48, 12288
    s_nop 0
    buffer_load_dwordx4 v14, s[16:19], s47 offen offset:0 lds
    v_mfma_f32_32x32x16_bf16 v[84:99], a[228:231], v[164:167], v[84:99]
    buffer_load_dwordx4 v15, s[16:19], s47 offen offset:1024 lds
    buffer_load_dwordx4 v16, s[16:19], s47 offen offset:2048 lds
    v_mfma_f32_32x32x16_bf16 v[100:115], a[224:227], v[168:171], v[100:115]
    buffer_load_dwordx4 v17, s[16:19], s47 offen offset:3072 lds
    v_mfma_f32_32x32x16_bf16 v[116:131], a[228:231], v[168:171], v[116:131]
    s_waitcnt vmcnt(8)
    v_max_u32 v22, v175, v179
    v_cmp_eq_u32 vcc, -1, v22
    s_cbranch_vccnz sequential_preLN__sliding_block__mixer_token_mlp__prompt_kernel_os5
sequential_preLN__sliding_block__mixer_token_mlp__prompt_kernel_or5:
    v_mfma_f32_32x32x16_bf16 v[68:83], a[232:235], v[172:175], v[68:83]
    s_add_u32 s47, s92, 13
    s_and_b32 s47, s47, 15
    s_mul_i32 s47, s47, 114688
    s_add_u32 m0, s48, 16384
    s_nop 0
    buffer_load_dwordx4 v14, s[16:19], s47 offen offset:0 lds
    v_mfma_f32_32x32x16_bf16 v[84:99], a[236:239], v[172:175], v[84:99]
    buffer_load_dwordx4 v15, s[16:19], s47 offen offset:1024 lds
    buffer_load_dwordx4 v16, s[16:19], s47 offen offset:2048 lds
    v_mfma_f32_32x32x16_bf16 v[100:115], a[232:235], v[176:179], v[100:115]
    buffer_load_dwordx4 v17, s[16:19], s47 offen offset:3072 lds
    v_mfma_f32_32x32x16_bf16 v[116:131], a[236:239], v[176:179], v[116:131]
    s_waitcnt vmcnt(10)
    v_max_u32 v22, v183, v187
    v_cmp_eq_u32 vcc, -1, v22
    s_cbranch_vccnz sequential_preLN__sliding_block__mixer_token_mlp__prompt_kernel_os6
sequential_preLN__sliding_block__mixer_token_mlp__prompt_kernel_or6:
    v_mfma_f32_32x32x16_bf16 v[68:83], a[240:243], v[180:183], v[68:83]
    s_add_u32 s47, s92, 14
    s_and_b32 s47, s47, 15
    s_mul_i32 s47, s47, 114688
    s_add_u32 m0, s48, 20480
    s_nop 0
    buffer_load_dwordx4 v14, s[16:19], s47 offen offset:0 lds
    v_mfma_f32_32x32x16_bf16 v[84:99], a[244:247], v[180:183], v[84:99]
    buffer_load_dwordx4 v15, s[16:19], s47 offen offset:1024 lds
    buffer_load_dwordx4 v16, s[16:19], s47 offen offset:2048 lds
    v_mfma_f32_32x32x16_bf16 v[100:115], a[240:243], v[184:187], v[100:115]
    buffer_load_dwordx4 v17, s[16:19], s47 offen offset:3072 lds
    v_mfma_f32_32x32x16_bf16 v[116:131], a[244:247], v[184:187], v[116:131]
    s_waitcnt vmcnt(12)
    v_max_u32 v22, v191, v195
    v_cmp_eq_u32 vcc, -1, v22
    s_cbranch_vccnz sequential_preLN__sliding_block__mixer_token_mlp__prompt_kernel_os7
sequential_preLN__sliding_block__mixer_token_mlp__prompt_kernel_or7:
    v_mfma_f32_32x32x16_bf16 v[68:83], a[248:251], v[188:191], v[68:83]
    s_add_u32 s47, s92, 15
    s_and_b32 s47, s47, 15
    s_mul_i32 s47, s47, 114688
    s_add_u32 m0, s48, 24576
    s_nop 0
    buffer_load_dwordx4 v14, s[16:19], s47 offen offset:0 lds
    v_mfma_f32_32x32x16_bf16 v[84:99], a[252:255], v[188:191], v[84:99]
    buffer_load_dwordx4 v15, s[16:19], s47 offen offset:1024 lds
    buffer_load_dwordx4 v16, s[16:19], s47 offen offset:2048 lds
    v_mfma_f32_32x32x16_bf16 v[100:115], a[248:251], v[192:195], v[100:115]
    buffer_load_dwordx4 v17, s[16:19], s47 offen offset:3072 lds
    v_mfma_f32_32x32x16_bf16 v[116:131], a[252:255], v[192:195], v[116:131]
    s_nop 7
    s_nop 0
    s_cmp_eq_u32 s36, 1
    s_cbranch_scc1 sequential_preLN__sliding_block__mixer_token_mlp__prompt_kernel_e31
    s_cmp_eq_u32 s36, 2
    s_cbranch_scc1 sequential_preLN__sliding_block__mixer_token_mlp__prompt_kernel_e32
    s_cmp_eq_u32 s36, 3
    s_cbranch_scc1 sequential_preLN__sliding_block__mixer_token_mlp__prompt_kernel_e33
sequential_preLN__sliding_block__mixer_token_mlp__prompt_kernel_e30:
    ds_write_b128 v2, v[84:87] offset:20480
    ds_write_b128 v2, v[88:91] offset:21504
    ds_write_b128 v2, v[92:95] offset:22528
    ds_write_b128 v2, v[100:103] offset:28672
    ds_write_b128 v2, v[104:107] offset:29696
    ds_write_b128 v2, v[108:111] offset:30720
    ds_write_b128 v2, v[112:115] offset:31744
    ds_write_b128 v2, v[116:119] offset:36864
    ds_write_b128 v2, v[120:123] offset:37888
    ds_write_b128 v2, v[124:127] offset:38912
    v_lshlrev_b32 v180, 16, v34
    v_and_b32 v181, 0xffff0000, v34
    v_lshlrev_b32 v182, 16, v35
    v_and_b32 v183, 0xffff0000, v35
    v_lshlrev_b32 v184, 16, v38
    v_and_b32 v185, 0xffff0000, v38
    v_lshlrev_b32 v186, 16, v39
    v_and_b32 v187, 0xffff0000, v39
    v_lshlrev_b32 v188, 16, v36
    v_and_b32 v189, 0xffff0000, v36
    v_lshlrev_b32 v190, 16, v37
    v_and_b32 v191, 0xffff0000, v37
    v_lshlrev_b32 v192, 16, v40
    v_and_b32 v193, 0xffff0000, v40
    v_lshlrev_b32 v194, 16, v41
    v_and_b32 v195, 0xffff0000, v41
    v_add_f32 v68, v68, v180
    v_add_f32 v69, v69, v181
    v_add_f32 v70, v70, v182
    v_add_f32 v71, v71, v183
    v_add_f32 v72, v72, v184
    v_add_f32 v73, v73, v185
    v_add_f32 v74, v74, v186
    v_add_f32 v75, v75, v187
    v_add_f32 v76, v76, v188
    v_add_f32 v77, v77, v189
    v_add_f32 v78, v78, v190
    v_add_f32 v79, v79, v191
    v_add_f32 v80, v80, v192
    v_add_f32 v81, v81, v193
    v_add_f32 v82, v82, v194
    v_add_f32 v83, v83, v195
    s_waitcnt lgkmcnt(0)
    s_barrier
    ds_read_b128 v[132:135], v2 offset:0
    ds_read_b128 v[136:139], v2 offset:1024
    ds_read_b128 v[140:143], v2 offset:2048
    ds_read_b128 v[144:147], v2 offset:3072
    ds_read_b128 v[148:151], v2 offset:4096
    ds_read_b128 v[152:155], v2 offset:5120
    ds_read_b128 v[156:159], v2 offset:6144
    ds_read_b128 v[160:163], v2 offset:7168
    ds_read_b128 v[164:167], v2 offset:8192
    ds_read_b128 v[168:171], v2 offset:9216
    ds_read_b128 v[172:175], v2 offset:10240
    ds_read_b128 v[176:179], v2 offset:11264
    s_waitcnt lgkmcnt(8)
    v_add_f32 v68, v68, v132
    v_add_f32 v69, v69, v133
    v_add_f32 v70, v70, v134
    v_add_f32 v71, v71, v135
    v_add_f32 v72, v72, v136
    v_add_f32 v73, v73, v137
    v_add_f32 v74, v74, v138
    v_add_f32 v75, v75, v139
    v_add_f32 v76, v76, v140
    v_add_f32 v77, v77, v141
    v_add_f32 v78, v78, v142
    v_add_f32 v79, v79, v143
    v_add_f32 v80, v80, v144
    v_add_f32 v81, v81, v145
    v_add_f32 v82, v82, v146
    v_add_f32 v83, v83, v147
    s_waitcnt lgkmcnt(4)
    v_add_f32 v68, v68, v148
    v_add_f32 v69, v69, v149
    v_add_f32 v70, v70, v150
    v_add_f32 v71, v71, v151
    v_add_f32 v72, v72, v152
    v_add_f32 v73, v73, v153
    v_add_f32 v74, v74, v154
    v_add_f32 v75, v75, v155
    v_add_f32 v76, v76, v156
    v_add_f32 v77, v77, v157
    v_add_f32 v78, v78, v158
    v_add_f32 v79, v79, v159
    v_add_f32 v80, v80, v160
    v_add_f32 v81, v81, v161
    v_add_f32 v82, v82, v162
    v_add_f32 v83, v83, v163
    s_waitcnt lgkmcnt(0)
    v_add_f32 v44, v68, v164
    v_add_f32 v45, v69, v165
    v_add_f32 v46, v70, v166
    v_add_f32 v47, v71, v167
    v_add_f32 v48, v72, v168
    v_add_f32 v49, v73, v169
    v_add_f32 v50, v74, v170
    v_add_f32 v51, v75, v171
    v_add_f32 v52, v76, v172
    v_add_f32 v53, v77, v173
    v_add_f32 v54, v78, v174
    v_add_f32 v55, v79, v175
    v_add_f32 v56, v80, v176
    v_add_f32 v57, v81, v177
    v_add_f32 v58, v82, v178
    v_add_f32 v59, v83, v179
    v_add_f32 v22, v44, v45
    v_mul_f32 v23, v44, v44
    v_add_f32 v24, v46, v47
    v_mul_f32 v25, v45, v45
    v_fmac_f32 v23, v46, v46
    v_fmac_f32 v25, v47, v47
    v_add_f32 v22, v22, v48
    v_fmac_f32 v23, v48, v48
    v_add_f32 v24, v24, v49
    v_fmac_f32 v25, v49, v49
    v_add_f32 v22, v22, v50
    v_fmac_f32 v23, v50, v50
    v_add_f32 v24, v24, v51
    v_fmac_f32 v25, v51, v51
    v_add_f32 v22, v22, v52
    v_fmac_f32 v23, v52, v52
    v_add_f32 v24, v24, v53
    v_fmac_f32 v25, v53, v53
    v_add_f32 v22, v22, v54
    v_fmac_f32 v23, v54, v54
    v_add_f32 v24, v24, v55
    v_fmac_f32 v25, v55, v55
    v_add_f32 v22, v22, v56
    v_fmac_f32 v23, v56, v56
    v_add_f32 v24, v24, v57
    v_fmac_f32 v25, v57, v57
    v_add_f32 v22, v22, v58
    v_fmac_f32 v23, v58, v58
    v_add_f32 v24, v24, v59
    v_fmac_f32 v25, v59, v59
    v_add_f32 v22, v22, v24
    v_add_f32 v23, v23, v25
    v_mov_b32 v24, v22
    v_mov_b32 v25, v23
    s_nop 1
    v_permlane32_swap_b32 v22, v24
    v_permlane32_swap_b32 v23, v25
    s_nop 0
    v_add_f32 v22, v22, v24
    v_add_f32 v23, v23, v25
    s_mov_b32 exec_hi, 0
    buffer_store_dwordx2 v[22:23], v9, s[12:15], 0 offen sc1
    s_mov_b64 exec, -1
    s_branch sequential_preLN__sliding_block__mixer_token_mlp__prompt_kernel_j3
sequential_preLN__sliding_block__mixer_token_mlp__prompt_kernel_e31:
    ds_write_b128 v2, v[100:103] offset:32768
    ds_write_b128 v2, v[104:107] offset:33792
    ds_write_b128 v2, v[108:111] offset:34816
    ds_write_b128 v2, v[112:115] offset:35840
    ds_write_b128 v2, v[116:119] offset:40960
    ds_write_b128 v2, v[120:123] offset:41984
    ds_write_b128 v2, v[124:127] offset:43008
    ds_write_b128 v2, v[68:71] offset:0
    ds_write_b128 v2, v[72:75] offset:1024
    ds_write_b128 v2, v[76:79] offset:2048
    ds_write_b128 v2, v[80:83] offset:3072
    v_lshlrev_b32 v180, 16, v34
    v_and_b32 v181, 0xffff0000, v34
    v_lshlrev_b32 v182, 16, v35
    v_and_b32 v183, 0xffff0000, v35
    v_lshlrev_b32 v184, 16, v38
    v_and_b32 v185, 0xffff0000, v38
    v_lshlrev_b32 v186, 16, v39
    v_and_b32 v187, 0xffff0000, v39
    v_lshlrev_b32 v188, 16, v36
    v_and_b32 v189, 0xffff0000, v36
    v_lshlrev_b32 v190, 16, v37
    v_and_b32 v191, 0xffff0000, v37
    v_add_f32 v84, v84, v180
    v_add_f32 v85, v85, v181
    v_add_f32 v86, v86, v182
    v_add_f32 v87, v87, v183
    v_add_f32 v88, v88, v184
    v_add_f32 v89, v89, v185
    v_add_f32 v90, v90, v186
    v_add_f32 v91, v91, v187
    v_add_f32 v92, v92, v188
    v_add_f32 v93, v93, v189
    v_add_f32 v94, v94, v190
    v_add_f32 v95, v95, v191
    s_waitcnt lgkmcnt(0)
    s_barrier
    ds_read_b128 v[132:135], v2 offset:12288
    ds_read_b128 v[136:139], v2 offset:13312
    ds_read_b128 v[140:143], v2 offset:14336
    ds_read_b128 v[148:151], v2 offset:16384
    ds_read_b128 v[152:155], v2 offset:17408
    ds_read_b128 v[156:159], v2 offset:18432
    ds_read_b128 v[164:167], v2 offset:20480
    ds_read_b128 v[168:171], v2 offset:21504
    ds_read_b128 v[172:175], v2 offset:22528
    s_waitcnt lgkmcnt(6)
    v_add_f32 v84, v84, v132
    v_add_f32 v85, v85, v133
    v_add_f32 v86, v86, v134
    v_add_f32 v87, v87, v135
    v_add_f32 v88, v88, v136
    v_add_f32 v89, v89, v137
    v_add_f32 v90, v90, v138
    v_add_f32 v91, v91, v139
    v_add_f32 v92, v92, v140
    v_add_f32 v93, v93, v141
    v_add_f32 v94, v94, v142
    v_add_f32 v95, v95, v143
    s_waitcnt lgkmcnt(3)
    v_add_f32 v84, v84, v148
    v_add_f32 v85, v85, v149
    v_add_f32 v86, v86, v150
    v_add_f32 v87, v87, v151
    v_add_f32 v88, v88, v152
    v_add_f32 v89, v89, v153
    v_add_f32 v90, v90, v154
    v_add_f32 v91, v91, v155
    v_add_f32 v92, v92, v156
    v_add_f32 v93, v93, v157
    v_add_f32 v94, v94, v158
    v_add_f32 v95, v95, v159
    s_waitcnt lgkmcnt(0)
    v_add_f32 v44, v84, v164
    v_add_f32 v45, v85, v165
    v_add_f32 v46, v86, v166
    v_add_f32 v47, v87, v167
    v_add_f32 v48, v88, v168
    v_add_f32 v49, v89, v169
    v_add_f32 v50, v90, v170
    v_add_f32 v51, v91, v171
    v_add_f32 v52, v92, v172
    v_add_f32 v53, v93, v173
    v_add_f32 v54, v94, v174
    v_add_f32 v55, v95, v175
    v_add_f32 v22, v44, v45
    v_mul_f32 v23, v44, v44
    v_add_f32 v24, v46, v47
    v_mul_f32 v25, v45, v45
    v_fmac_f32 v23, v46, v46
    v_fmac_f32 v25, v47, v47
    v_add_f32 v22, v22, v48
    v_fmac_f32 v23, v48, v48
    v_add_f32 v24, v24, v49
    v_fmac_f32 v25, v49, v49
    v_add_f32 v22, v22, v50
    v_fmac_f32 v23, v50, v50
    v_add_f32 v24, v24, v51
    v_fmac_f32 v25, v51, v51
    v_add_f32 v22, v22, v52
    v_fmac_f32 v23, v52, v52
    v_add_f32 v24, v24, v53
    v_fmac_f32 v25, v53, v53
    v_add_f32 v22, v22, v54
    v_fmac_f32 v23, v54, v54
    v_add_f32 v24, v24, v55
    v_fmac_f32 v25, v55, v55
    v_add_f32 v22, v22, v24
    v_add_f32 v23, v23, v25
    v_mov_b32 v24, v22
    v_mov_b32 v25, v23
    s_nop 1
    v_permlane32_swap_b32 v22, v24
    v_permlane32_swap_b32 v23, v25
    s_nop 0
    v_add_f32 v22, v22, v24
    v_add_f32 v23, v23, v25
    s_mov_b32 exec_hi, 0
    buffer_store_dwordx2 v[22:23], v9, s[12:15], 0 offen sc1
    s_mov_b64 exec, -1
    v_mov_b32 v56, 0
    v_mov_b32 v57, 0
    v_mov_b32 v58, 0
    v_mov_b32 v59, 0
    s_branch sequential_preLN__sliding_block__mixer_token_mlp__prompt_kernel_j3
sequential_preLN__sliding_block__mixer_token_mlp__prompt_kernel_e32:
    ds_write_b128 v2, v[116:119] offset:45056
    ds_write_b128 v2, v[120:123] offset:46080
    ds_write_b128 v2, v[124:127] offset:47104
    ds_write_b128 v2, v[68:71] offset:4096
    ds_write_b128 v2, v[72:75] offset:5120
    ds_write_b128 v2, v[76:79] offset:6144
    ds_write_b128 v2, v[80:83] offset:7168
    ds_write_b128 v2, v[84:87] offset:12288
    ds_write_b128 v2, v[88:91] offset:13312
    ds_write_b128 v2, v[92:95] offset:14336
    v_lshlrev_b32 v180, 16, v34
    v_and_b32 v181, 0xffff0000, v34
    v_lshlrev_b32 v182, 16, v35
    v_and_b32 v183, 0xffff0000, v35
    v_lshlrev_b32 v184, 16, v38
    v_and_b32 v185, 0xffff0000, v38
    v_lshlrev_b32 v186, 16, v39
    v_and_b32 v187, 0xffff0000, v39
    v_lshlrev_b32 v188, 16, v36
    v_and_b32 v189, 0xffff0000, v36
    v_lshlrev_b32 v190, 16, v37
    v_and_b32 v191, 0xffff0000, v37
    v_lshlrev_b32 v192, 16, v40
    v_and_b32 v193, 0xffff0000, v40
    v_lshlrev_b32 v194, 16, v41
    v_and_b32 v195, 0xffff0000, v41
    v_add_f32 v100, v100, v180
    v_add_f32 v101, v101, v181
    v_add_f32 v102, v102, v182
    v_add_f32 v103, v103, v183
    v_add_f32 v104, v104, v184
    v_add_f32 v105, v105, v185
    v_add_f32 v106, v106, v186
    v_add_f32 v107, v107, v187
    v_add_f32 v108, v108, v188
    v_add_f32 v109, v109, v189
    v_add_f32 v110, v110, v190
    v_add_f32 v111, v111, v191
    v_add_f32 v112, v112, v192
    v_add_f32 v113, v113, v193
    v_add_f32 v114, v114, v194
    v_add_f32 v115, v115, v195
    s_waitcnt lgkmcnt(0)
    s_barrier
    ds_read_b128 v[132:135], v2 offset:24576
    ds_read_b128 v[136:139], v2 offset:25600
    ds_read_b128 v[140:143], v2 offset:26624
    ds_read_b128 v[144:147], v2 offset:27648
    ds_read_b128 v[148:151], v2 offset:28672
    ds_read_b128 v[152:155], v2 offset:29696
    ds_read_b128 v[156:159], v2 offset:30720
    ds_read_b128 v[160:163], v2 offset:31744
    ds_read_b128 v[164:167], v2 offset:32768
    ds_read_b128 v[168:171], v2 offset:33792
    ds_read_b128 v[172:175], v2 offset:34816
    ds_read_b128 v[176:179], v2 offset:35840
    s_waitcnt lgkmcnt(8)
    v_add_f32 v100, v100, v132
    v_add_f32 v101, v101, v133
    v_add_f32 v102, v102, v134
    v_add_f32 v103, v103, v135
    v_add_f32 v104, v104, v136
    v_add_f32 v105, v105, v137
    v_add_f32 v106, v106, v138
    v_add_f32 v107, v107, v139
    v_add_f32 v108, v108, v140
    v_add_f32 v109, v109, v141
    v_add_f32 v110, v110, v142
    v_add_f32 v111, v111, v143
    v_add_f32 v112, v112, v144
    v_add_f32 v113, v113, v145
    v_add_f32 v114, v114, v146
    v_add_f32 v115, v115, v147
    s_waitcnt lgkmcnt(4)
    v_add_f32 v100, v100, v148
    v_add_f32 v101, v101, v149
    v_add_f32 v102, v102, v150
    v_add_f32 v103, v103, v151
    v_add_f32 v104, v104, v152
    v_add_f32 v105, v105, v153
    v_add_f32 v106, v106, v154
    v_add_f32 v107, v107, v155
    v_add_f32 v108, v108, v156
    v_add_f32 v109, v109, v157
    v_add_f32 v110, v110, v158
    v_add_f32 v111, v111, v159
    v_add_f32 v112, v112, v160
    v_add_f32 v113, v113, v161
    v_add_f32 v114, v114, v162
    v_add_f32 v115, v115, v163
    s_waitcnt lgkmcnt(0)
    v_add_f32 v44, v100, v164
    v_add_f32 v45, v101, v165
    v_add_f32 v46, v102, v166
    v_add_f32 v47, v103, v167
    v_add_f32 v48, v104, v168
    v_add_f32 v49, v105, v169
    v_add_f32 v50, v106, v170
    v_add_f32 v51, v107, v171
    v_add_f32 v52, v108, v172
    v_add_f32 v53, v109, v173
    v_add_f32 v54, v110, v174
    v_add_f32 v55, v111, v175
    v_add_f32 v56, v112, v176
    v_add_f32 v57, v113, v177
    v_add_f32 v58, v114, v178
    v_add_f32 v59, v115, v179
    v_add_f32 v22, v44, v45
    v_mul_f32 v23, v44, v44
    v_add_f32 v24, v46, v47
    v_mul_f32 v25, v45, v45
    v_fmac_f32 v23, v46, v46
    v_fmac_f32 v25, v47, v47
    v_add_f32 v22, v22, v48
    v_fmac_f32 v23, v48, v48
    v_add_f32 v24, v24, v49
    v_fmac_f32 v25, v49, v49
    v_add_f32 v22, v22, v50
    v_fmac_f32 v23, v50, v50
    v_add_f32 v24, v24, v51
    v_fmac_f32 v25, v51, v51
    v_add_f32 v22, v22, v52
    v_fmac_f32 v23, v52, v52
    v_add_f32 v24, v24, v53
    v_fmac_f32 v25, v53, v53
    v_add_f32 v22, v22, v54
    v_fmac_f32 v23, v54, v54
    v_add_f32 v24, v24, v55
    v_fmac_f32 v25, v55, v55
    v_add_f32 v22, v22, v56
    v_fmac_f32 v23, v56, v56
    v_add_f32 v24, v24, v57
    v_fmac_f32 v25, v57, v57
    v_add_f32 v22, v22, v58
    v_fmac_f32 v23, v58, v58
    v_add_f32 v24, v24, v59
    v_fmac_f32 v25, v59, v59
    v_add_f32 v22, v22, v24
    v_add_f32 v23, v23, v25
    v_mov_b32 v24, v22
    v_mov_b32 v25, v23
    s_nop 1
    v_permlane32_swap_b32 v22, v24
    v_permlane32_swap_b32 v23, v25
    s_nop 0
    v_add_f32 v22, v22, v24
    v_add_f32 v23, v23, v25
    s_mov_b32 exec_hi, 0
    buffer_store_dwordx2 v[22:23], v9, s[12:15], 0 offen sc1
    s_mov_b64 exec, -1
    s_branch sequential_preLN__sliding_block__mixer_token_mlp__prompt_kernel_j3
sequential_preLN__sliding_block__mixer_token_mlp__prompt_kernel_e33:
    ds_write_b128 v2, v[68:71] offset:8192
    ds_write_b128 v2, v[72:75] offset:9216
    ds_write_b128 v2, v[76:79] offset:10240
    ds_write_b128 v2, v[80:83] offset:11264
    ds_write_b128 v2, v[84:87] offset:16384
    ds_write_b128 v2, v[88:91] offset:17408
    ds_write_b128 v2, v[92:95] offset:18432
    ds_write_b128 v2, v[100:103] offset:24576
    ds_write_b128 v2, v[104:107] offset:25600
    ds_write_b128 v2, v[108:111] offset:26624
    ds_write_b128 v2, v[112:115] offset:27648
    v_lshlrev_b32 v180, 16, v34
    v_and_b32 v181, 0xffff0000, v34
    v_lshlrev_b32 v182, 16, v35
    v_and_b32 v183, 0xffff0000, v35
    v_lshlrev_b32 v184, 16, v38
    v_and_b32 v185, 0xffff0000, v38
    v_lshlrev_b32 v186, 16, v39
    v_and_b32 v187, 0xffff0000, v39
    v_lshlrev_b32 v188, 16, v36
    v_and_b32 v189, 0xffff0000, v36
    v_lshlrev_b32 v190, 16, v37
    v_and_b32 v191, 0xffff0000, v37
    v_add_f32 v116, v116, v180
    v_add_f32 v117, v117, v181
    v_add_f32 v118, v118, v182
    v_add_f32 v119, v119, v183
    v_add_f32 v120, v120, v184
    v_add_f32 v121, v121, v185
    v_add_f32 v122, v122, v186
    v_add_f32 v123, v123, v187
    v_add_f32 v124, v124, v188
    v_add_f32 v125, v125, v189
    v_add_f32 v126, v126, v190
    v_add_f32 v127, v127, v191
    s_waitcnt lgkmcnt(0)
    s_barrier
    ds_read_b128 v[132:135], v2 offset:36864
    ds_read_b128 v[136:139], v2 offset:37888
    ds_read_b128 v[140:143], v2 offset:38912
    ds_read_b128 v[148:151], v2 offset:40960
    ds_read_b128 v[152:155], v2 offset:41984
    ds_read_b128 v[156:159], v2 offset:43008
    ds_read_b128 v[164:167], v2 offset:45056
    ds_read_b128 v[168:171], v2 offset:46080
    ds_read_b128 v[172:175], v2 offset:47104
    s_waitcnt lgkmcnt(6)
    v_add_f32 v116, v116, v132
    v_add_f32 v117, v117, v133
    v_add_f32 v118, v118, v134
    v_add_f32 v119, v119, v135
    v_add_f32 v120, v120, v136
    v_add_f32 v121, v121, v137
    v_add_f32 v122, v122, v138
    v_add_f32 v123, v123, v139
    v_add_f32 v124, v124, v140
    v_add_f32 v125, v125, v141
    v_add_f32 v126, v126, v142
    v_add_f32 v127, v127, v143
    s_waitcnt lgkmcnt(3)
    v_add_f32 v116, v116, v148
    v_add_f32 v117, v117, v149
    v_add_f32 v118, v118, v150
    v_add_f32 v119, v119, v151
    v_add_f32 v120, v120, v152
    v_add_f32 v121, v121, v153
    v_add_f32 v122, v122, v154
    v_add_f32 v123, v123, v155
    v_add_f32 v124, v124, v156
    v_add_f32 v125, v125, v157
    v_add_f32 v126, v126, v158
    v_add_f32 v127, v127, v159
    s_waitcnt lgkmcnt(0)
    v_add_f32 v44, v116, v164
    v_add_f32 v45, v117, v165
    v_add_f32 v46, v118, v166
    v_add_f32 v47, v119, v167
    v_add_f32 v48, v120, v168
    v_add_f32 v49, v121, v169
    v_add_f32 v50, v122, v170
    v_add_f32 v51, v123, v171
    v_add_f32 v52, v124, v172
    v_add_f32 v53, v125, v173
    v_add_f32 v54, v126, v174
    v_add_f32 v55, v127, v175
    v_add_f32 v22, v44, v45
    v_mul_f32 v23, v44, v44
    v_add_f32 v24, v46, v47
    v_mul_f32 v25, v45, v45
    v_fmac_f32 v23, v46, v46
    v_fmac_f32 v25, v47, v47
    v_add_f32 v22, v22, v48
    v_fmac_f32 v23, v48, v48
    v_add_f32 v24, v24, v49
    v_fmac_f32 v25, v49, v49
    v_add_f32 v22, v22, v50
    v_fmac_f32 v23, v50, v50
    v_add_f32 v24, v24, v51
    v_fmac_f32 v25, v51, v51
    v_add_f32 v22, v22, v52
    v_fmac_f32 v23, v52, v52
    v_add_f32 v24, v24, v53
    v_fmac_f32 v25, v53, v53
    v_add_f32 v22, v22, v54
    v_fmac_f32 v23, v54, v54
    v_add_f32 v24, v24, v55
    v_fmac_f32 v25, v55, v55
    v_add_f32 v22, v22, v24
    v_add_f32 v23, v23, v25
    v_mov_b32 v24, v22
    v_mov_b32 v25, v23
    s_nop 1
    v_permlane32_swap_b32 v22, v24
    v_permlane32_swap_b32 v23, v25
    s_nop 0
    v_add_f32 v22, v22, v24
    v_add_f32 v23, v23, v25
    s_mov_b32 exec_hi, 0
    buffer_store_dwordx2 v[22:23], v9, s[12:15], 0 offen sc1
    s_mov_b64 exec, -1
    v_mov_b32 v56, 0
    v_mov_b32 v57, 0
    v_mov_b32 v58, 0
    v_mov_b32 v59, 0
    s_branch sequential_preLN__sliding_block__mixer_token_mlp__prompt_kernel_j3
sequential_preLN__sliding_block__mixer_token_mlp__prompt_kernel_j3:
    s_mov_b32 s49, 0
    ds_read_b64_tr_b16 a[160:161], v5 offset:0
    ds_read_b64_tr_b16 a[162:163], v5 offset:1024
    ds_read_b64_tr_b16 a[164:165], v6 offset:0
    ds_read_b64_tr_b16 a[166:167], v6 offset:1024
    ds_read_b64_tr_b16 a[168:169], v5 offset:2048
    ds_read_b64_tr_b16 a[170:171], v5 offset:3072
    ds_read_b64_tr_b16 a[172:173], v6 offset:2048
    ds_read_b64_tr_b16 a[174:175], v6 offset:3072
    ds_read_b64_tr_b16 a[176:177], v5 offset:4096
    ds_read_b64_tr_b16 a[178:179], v5 offset:5120
    ds_read_b64_tr_b16 a[180:181], v6 offset:4096
    ds_read_b64_tr_b16 a[182:183], v6 offset:5120
    ds_read_b64_tr_b16 a[184:185], v5 offset:6144
    ds_read_b64_tr_b16 a[186:187], v5 offset:7168
    ds_read_b64_tr_b16 a[188:189], v6 offset:6144
    ds_read_b64_tr_b16 a[190:191], v6 offset:7168
    s_waitcnt lgkmcnt(8)
    s_add_u32 s47, s93, 1
    s_sub_u32 s51, s47, 14
    s_min_u32 s47, s47, s51
    s_mul_i32 s47, s47, 131072
    s_add_u32 m0, s48, 0
    s_nop 0
    buffer_load_dwordx4 v18, s[20:23], s47 offen offset:0 lds
    buffer_load_dwordx4 v19, s[20:23], s47 offen offset:1024 lds
    buffer_load_dwordx4 v20, s[20:23], s47 offen offset:2048 lds
    buffer_load_dwordx4 v21, s[20:23], s47 offen offset:3072 lds
    s_waitcnt vmcnt(16)
    ds_read_b64_tr_b16 a[192:193], v5 offset:12288
    ds_read_b64_tr_b16 a[194:195], v5 offset:13312
    ds_read_b64_tr_b16 a[196:197], v6 offset:12288
    ds_read_b64_tr_b16 a[198:199], v6 offset:13312
    ds_read_b64_tr_b16 a[200:201], v5 offset:14336
    ds_read_b64_tr_b16 a[202:203], v5 offset:15360
    ds_read_b64_tr_b16 a[204:205], v6 offset:14336
    ds_read_b64_tr_b16 a[206:207], v6 offset:15360
    s_waitcnt lgkmcnt(8)
    s_add_u32 s47, s93, 2
    s_sub_u32 s51, s47, 14
    s_min_u32 s47, s47, s51
    s_mul_i32 s47, s47, 131072
    s_add_u32 m0, s48, 4096
    s_nop 0
    buffer_load_dwordx4 v18, s[20:23], s47 offen offset:0 lds
    buffer_load_dwordx4 v19, s[20:23], s47 offen offset:1024 lds
    buffer_load_dwordx4 v20, s[20:23], s47 offen offset:2048 lds
    buffer_load_dwordx4 v21, s[20:23], s47 offen offset:3072 lds
    s_waitcnt vmcnt(16)
    ds_read_b64_tr_b16 a[208:209], v5 offset:16384
    ds_read_b64_tr_b16 a[210:211], v5 offset:17408
    ds_read_b64_tr_b16 a[212:213], v6 offset:16384
    ds_read_b64_tr_b16 a[214:215], v6 offset:17408
    ds_read_b64_tr_b16 a[216:217], v5 offset:18432
    ds_read_b64_tr_b16 a[218:219], v5 offset:19456
    ds_read_b64_tr_b16 a[220:221], v6 offset:18432
    ds_read_b64_tr_b16 a[222:223], v6 offset:19456
    s_waitcnt lgkmcnt(8)
    s_add_u32 s47, s93, 3
    s_sub_u32 s51, s47, 14
    s_min_u32 s47, s47, s51
    s_mul_i32 s47, s47, 131072
    s_add_u32 m0, s48, 12288
    s_nop 0
    buffer_load_dwordx4 v18, s[20:23], s47 offen offset:0 lds
    buffer_load_dwordx4 v19, s[20:23], s47 offen offset:1024 lds
    buffer_load_dwordx4 v20, s[20:23], s47 offen offset:2048 lds
    buffer_load_dwordx4 v21, s[20:23], s47 offen offset:3072 lds
    s_waitcnt vmcnt(16)
    ds_read_b64_tr_b16 a[224:225], v5 offset:20480
    ds_read_b64_tr_b16 a[226:227], v5 offset:21504
    ds_read_b64_tr_b16 a[228:229], v6 offset:20480
    ds_read_b64_tr_b16 a[230:231], v6 offset:21504
    ds_read_b64_tr_b16 a[232:233], v5 offset:22528
    ds_read_b64_tr_b16 a[234:235], v5 offset:23552
    ds_read_b64_tr_b16 a[236:237], v6 offset:22528
    ds_read_b64_tr_b16 a[238:239], v6 offset:23552
    s_waitcnt vmcnt(12)
    ds_read_b64_tr_b16 a[240:241], v5 offset:24576
    ds_read_b64_tr_b16 a[242:243], v5 offset:25600
    ds_read_b64_tr_b16 a[244:245], v6 offset:24576
    ds_read_b64_tr_b16 a[246:247], v6 offset:25600
    ds_read_b64_tr_b16 a[248:249], v5 offset:26624
    ds_read_b64_tr_b16 a[250:251], v5 offset:27648
    ds_read_b64_tr_b16 a[252:253], v6 offset:26624
    ds_read_b64_tr_b16 a[254:255], v6 offset:27648
    s_lshl2_add_u32 s42, s37, s36
    s_mul_i32 s42, s42, 57344
    s_add_u32 s42, s42, 10485760
    v_add_u32 v7, s42, v2
    v_min_u32 v22, 23, v4
    v_mad_u32_u24 v22, v3, 24, v22
    v_lshl_add_u32 v8, v22, 4, s42
    v_add_u32 v8, 1024, v8
    s_waitcnt vmcnt(0)
sequential_preLN__sliding_block__mixer_token_mlp__prompt_kernel_ps:
    buffer_load_dwordx4 v[132:135], v10, s[12:15], 0 offen offset:0 sc1
    buffer_load_dwordx4 v[136:139], v10, s[12:15], 0 offen offset:1024 sc1
    buffer_load_dwordx4 v[140:143], v10, s[12:15], 0 offen offset:2048 sc1
    buffer_load_dwordx4 v[144:147], v10, s[12:15], 0 offen offset:3072 sc1
    s_add_u32 s49, s49, 1
    s_waitcnt vmcnt(0)
    v_max3_u32 v24, v133, v135, v137
    v_max3_u32 v24, v24, v139, v141
    v_max3_u32 v24, v24, v143, v145
    v_max_u32 v24, v24, v147
    v_cmp_eq_u32 vcc, -1, v24
    s_cbranch_vccz sequential_preLN__sliding_block__mixer_token_mlp__prompt_kernel_os
    s_cmp_lt_u32 s49, 20000
    s_cbranch_scc1 sequential_preLN__sliding_block__mixer_token_mlp__prompt_kernel_ps
sequential_preLN__sliding_block__mixer_token_mlp__prompt_kernel_os:
    v_add_f32 v132, v132, v134
    v_add_f32 v136, v136, v138
    v_add_f32 v140, v140, v142
    v_add_f32 v144, v144, v146
    v_add_f32 v133, v133, v135
    v_add_f32 v137, v137, v139
    v_add_f32 v141, v141, v143
    v_add_f32 v145, v145, v147
    v_add_f32 v132, v132, v136
    v_add_f32 v140, v140, v144
    v_add_f32 v133, v133, v137
    v_add_f32 v141, v141, v145
    v_add_f32 v132, v132, v140
    v_add_f32 v133, v133, v141
    v_mov_b32 v134, v132
    v_mov_b32 v135, v133
    v_mov_b32 v136, 0x3b124925
    v_mov_b32 v137, 0x3727c5ac
    v_permlane32_swap_b32 v132, v134
    v_permlane32_swap_b32 v133, v135
    s_nop 0
    v_add_f32 v132, v132, v134
    v_add_f32 v133, v133, v135
    v_mul_f32 v132, v132, v136
    v_mul_f32 v134, v132, v132
    v_fma_f32 v133, v133, v136, -v134
    v_max_f32 v133, 0, v133
    v_add_f32 v134, v133, v137
    v_rsq_f32 v134, v134
    s_lshl_b32 s42, s37, 5
    v_mul_f32 v135, v134, v134
    v_fma_f32 v135, v135, v133, v137
    v_rsq_f32 v135, v135
    s_add_u32 s42, s42, s38
    v_mul_f32 v134, v134, v135
    v_mul_f32 v132, v132, v134
    v_fma_f32 v164, v44, v134, -v132
    v_fma_f32 v165, v45, v134, -v132
    v_fma_f32 v166, v46, v134, -v132
    v_fma_f32 v167, v47, v134, -v132
    v_fma_f32 v168, v48, v134, -v132
    v_fma_f32 v169, v49, v134, -v132
    v_fma_f32 v170, v50, v134, -v132
    v_fma_f32 v171, v51, v134, -v132
    v_fma_f32 v172, v52, v134, -v132
    v_fma_f32 v173, v53, v134, -v132
    v_fma_f32 v174, v54, v134, -v132
    v_fma_f32 v175, v55, v134, -v132
    v_fma_f32 v176, v56, v134, -v132
    v_fma_f32 v177, v57, v134, -v132
    v_fma_f32 v178, v58, v134, -v132
    v_fma_f32 v179, v59, v134, -v132
    v_cvt_pk_bf16_f32 v236, v164, v165
    v_cvt_pk_bf16_f32 v237, v166, v167
    v_cvt_pk_bf16_f32 v238, v168, v169
    v_cvt_pk_bf16_f32 v239, v170, v171
    v_cvt_pk_bf16_f32 v240, v172, v173
    v_cvt_pk_bf16_f32 v241, v174, v175
    v_cvt_pk_bf16_f32 v242, v176, v177
    v_cvt_pk_bf16_f32 v243, v178, v179
    s_lshr_b32 s43, s36, 1
    s_lshl1_add_u32 s42, s42, s43
    v_mfma_f32_32x32x16_bf16 v[148:163], v[236:239], v[60:63], 0
    v_mfma_f32_32x32x16_bf16 v[148:163], v[240:243], v[64:67], v[148:163]
    s_mul_i32 s42, s42, 3584
    s_add_u32 s42, s42, 10485760
    s_bitcmp1_b32 s36, 0
    s_cselect_b32 s43, 0x00ffffff, -1
    s_cselect_b64 vcc, -1, 0
    v_add_u32 v22, 1024, v11
    s_nop 0
    v_cndmask_b32 v22, v2, v22, vcc
    s_nop 5
    v_cvt_pk_bf16_f32 v132, v148, v149
    v_cvt_pk_bf16_f32 v133, v150, v151
    v_cvt_pk_bf16_f32 v134, v152, v153
    v_cvt_pk_bf16_f32 v135, v154, v155
    v_cvt_pk_bf16_f32 v136, v156, v157
    v_cvt_pk_bf16_f32 v137, v158, v159
    v_cvt_pk_bf16_f32 v138, v160, v161
    v_cvt_pk_bf16_f32 v139, v162, v163
    s_mov_b32 exec_lo, s43
    s_mov_b32 exec_hi, s43
    buffer_store_dwordx4 v[132:135], v22, s[12:15], s42 offen sc1
    buffer_store_dwordx4 v[136:139], v22, s[12:15], s42 offen offset:1792 sc1
    s_mov_b64 exec, -1
    s_waitcnt lgkmcnt(0)
    s_add_u32 s47, s93, 4
    s_sub_u32 s51, s47, 14
    s_min_u32 s47, s47, s51
    s_mul_i32 s47, s47, 131072
    s_add_u32 m0, s48, 16384
    s_nop 0
    buffer_load_dwordx4 v18, s[20:23], s47 offen offset:0 lds
    buffer_load_dwordx4 v19, s[20:23], s47 offen offset:1024 lds
    buffer_load_dwordx4 v20, s[20:23], s47 offen offset:2048 lds
    buffer_load_dwordx4 v21, s[20:23], s47 offen offset:3072 lds
    s_add_u32 s47, s93, 5
    s_sub_u32 s51, s47, 14
    s_min_u32 s47, s47, s51
    s_mul_i32 s47, s47, 131072
    s_add_u32 m0, s48, 20480
    s_nop 0
    buffer_load_dwordx4 v18, s[20:23], s47 offen offset:0 lds
    buffer_load_dwordx4 v19, s[20:23], s47 offen offset:1024 lds
    buffer_load_dwordx4 v20, s[20:23], s47 offen offset:2048 lds
    buffer_load_dwordx4 v21, s[20:23], s47 offen offset:3072 lds
    s_add_u32 s47, s93, 6
    s_sub_u32 s51, s47, 14
    s_min_u32 s47, s47, s51
    s_mul_i32 s47, s47, 131072
    s_add_u32 m0, s48, 24576
    s_nop 0
    buffer_load_dwordx4 v18, s[20:23], s47 offen offset:0 lds
    buffer_load_dwordx4 v19, s[20:23], s47 offen offset:1024 lds
    buffer_load_dwordx4 v20, s[20:23], s47 offen offset:2048 lds
    buffer_load_dwordx4 v21, s[20:23], s47 offen offset:3072 lds
    s_barrier
    s_cmp_eq_u32 s50, 7
    s_cbranch_scc1 sequential_preLN__sliding_block__mixer_token_mlp__prompt_kernel_idle
    s_waitcnt vmcnt(0)
    s_mov_b32 s49, 0
    s_add_u32 s46, s92, 0
    s_and_b32 s46, s46, 15
    s_mul_i32 s46, s46, 3584
    buffer_load_dwordx4 v[132:135], v7, s[12:15], s46 offen offset:0 sc1
    buffer_load_dwordx4 v[136:139], v8, s[12:15], s46 offen offset:0 sc1
    buffer_load_dwordx4 v[140:143], v7, s[12:15], s46 offen offset:1792 sc1
    buffer_load_dwordx4 v[144:147], v8, s[12:15], s46 offen offset:1792 sc1
    s_add_u32 s46, s92, 1
    s_and_b32 s46, s46, 15
    s_mul_i32 s46, s46, 3584
    buffer_load_dwordx4 v[148:151], v7, s[12:15], s46 offen offset:0 sc1
    buffer_load_dwordx4 v[152:155], v8, s[12:15], s46 offen offset:0 sc1
    s_waitcnt vmcnt(4)
    v_max_u32 v22, v135, v139
    v_cmp_eq_u32 vcc, -1, v22
    s_cbranch_vccnz sequential_preLN__sliding_block__mixer_token_mlp__prompt_kernel_g1s0
sequential_preLN__sliding_block__mixer_token_mlp__prompt_kernel_g1r0:
    v_mfma_f32_32x32x16_bf16 v[68:83], a[0:3], v[132:135], 0
    buffer_load_dwordx4 v[156:159], v7, s[12:15], s46 offen offset:1792 sc1
    v_mfma_f32_32x32x16_bf16 v[100:115], a[4:7], v[132:135], 0
    buffer_load_dwordx4 v[160:163], v8, s[12:15], s46 offen offset:1792 sc1
    v_mfma_f32_32x32x16_bf16 v[84:99], a[0:3], v[136:139], 0
    s_add_u32 s46, s92, 2
    s_and_b32 s46, s46, 15
    s_mul_i32 s46, s46, 3584
    buffer_load_dwordx4 v[164:167], v7, s[12:15], s46 offen offset:0 sc1
    v_mfma_f32_32x32x16_bf16 v[116:131], a[4:7], v[136:139], 0
    buffer_load_dwordx4 v[168:171], v8, s[12:15], s46 offen offset:0 sc1
    s_waitcnt vmcnt(6)
    v_max_u32 v22, v143, v147
    v_cmp_eq_u32 vcc, -1, v22
    s_cbranch_vccnz sequential_preLN__sliding_block__mixer_token_mlp__prompt_kernel_g1s1
sequential_preLN__sliding_block__mixer_token_mlp__prompt_kernel_g1r1:
    v_mfma_f32_32x32x16_bf16 v[68:83], a[8:11], v[140:143], v[68:83]
    buffer_load_dwordx4 v[172:175], v7, s[12:15], s46 offen offset:1792 sc1
    v_mfma_f32_32x32x16_bf16 v[100:115], a[12:15], v[140:143], v[100:115]
    buffer_load_dwordx4 v[176:179], v8, s[12:15], s46 offen offset:1792 sc1
    v_mfma_f32_32x32x16_bf16 v[84:99], a[8:11], v[144:147], v[84:99]
    s_add_u32 s46, s92, 3
    s_and_b32 s46, s46, 15
    s_mul_i32 s46, s46, 3584
    buffer_load_dwordx4 v[180:183], v7, s[12:15], s46 offen offset:0 sc1
    v_mfma_f32_32x32x16_bf16 v[116:131], a[12:15], v[144:147], v[116:131]
    buffer_load_dwordx4 v[184:187], v8, s[12:15], s46 offen offset:0 sc1
    s_waitcnt vmcnt(8)
    v_max_u32 v22, v151, v155
    v_cmp_eq_u32 vcc, -1, v22
    s_cbranch_vccnz sequential_preLN__sliding_block__mixer_token_mlp__prompt_kernel_g1s2
sequential_preLN__sliding_block__mixer_token_mlp__prompt_kernel_g1r2:
    v_mfma_f32_32x32x16_bf16 v[68:83], a[16:19], v[148:151], v[68:83]
    buffer_load_dwordx4 v[188:191], v7, s[12:15], s46 offen offset:1792 sc1
    v_mfma_f32_32x32x16_bf16 v[100:115], a[20:23], v[148:151], v[100:115]
    buffer_load_dwordx4 v[192:195], v8, s[12:15], s46 offen offset:1792 sc1
    v_mfma_f32_32x32x16_bf16 v[84:99], a[16:19], v[152:155], v[84:99]
    s_add_u32 s46, s92, 4
    s_and_b32 s46, s46, 15
    s_mul_i32 s46, s46, 3584
    buffer_load_dwordx4 v[196:199], v7, s[12:15], s46 offen offset:0 sc1
    v_mfma_f32_32x32x16_bf16 v[116:131], a[20:23], v[152:155], v[116:131]
    buffer_load_dwordx4 v[200:203], v8, s[12:15], s46 offen offset:0 sc1
    s_waitcnt vmcnt(10)
    v_max_u32 v22, v159, v163
    v_cmp_eq_u32 vcc, -1, v22
    s_cbranch_vccnz sequential_preLN__sliding_block__mixer_token_mlp__prompt_kernel_g1s3
sequential_preLN__sliding_block__mixer_token_mlp__prompt_kernel_g1r3:
    v_mfma_f32_32x32x16_bf16 v[68:83], a[24:27], v[156:159], v[68:83]
    buffer_load_dwordx4 v[204:207], v7, s[12:15], s46 offen offset:1792 sc1
    v_mfma_f32_32x32x16_bf16 v[100:115], a[28:31], v[156:159], v[100:115]
    buffer_load_dwordx4 v[208:211], v8, s[12:15], s46 offen offset:1792 sc1
    v_mfma_f32_32x32x16_bf16 v[84:99], a[24:27], v[160:163], v[84:99]
    s_add_u32 s46, s92, 5
    s_and_b32 s46, s46, 15
    s_mul_i32 s46, s46, 3584
    buffer_load_dwordx4 v[212:215], v7, s[12:15], s46 offen offset:0 sc1
    v_mfma_f32_32x32x16_bf16 v[116:131], a[28:31], v[160:163], v[116:131]
    buffer_load_dwordx4 v[216:219], v8, s[12:15], s46 offen offset:0 sc1
    s_waitcnt vmcnt(12)
    v_max_u32 v22, v167, v171
    v_cmp_eq_u32 vcc, -1, v22
    s_cbranch_vccnz sequential_preLN__sliding_block__mixer_token_mlp__prompt_kernel_g1s4
sequential_preLN__sliding_block__mixer_token_mlp__prompt_kernel_g1r4:
    v_mfma_f32_32x32x16_bf16 v[68:83], a[32:35], v[164:167], v[68:83]
    buffer_load_dwordx4 v[220:223], v7, s[12:15], s46 offen offset:1792 sc1
    v_mfma_f32_32x32x16_bf16 v[100:115], a[36:39], v[164:167], v[100:115]
    buffer_load_dwordx4 v[224:227], v8, s[12:15], s46 offen offset:1792 sc1
    v_mfma_f32_32x32x16_bf16 v[84:99], a[32:35], v[168:171], v[84:99]
    s_add_u32 s46, s92, 6
    s_and_b32 s46, s46, 15
    s_mul_i32 s46, s46, 3584
    buffer_load_dwordx4 v[132:135], v7, s[12:15], s46 offen offset:0 sc1
    v_mfma_f32_32x32x16_bf16 v[116:131], a[36:39], v[168:171], v[116:131]
    buffer_load_dwordx4 v[136:139], v8, s[12:15], s46 offen offset:0 sc1
    s_waitcnt vmcnt(14)
    v_max_u32 v22, v175, v179
    v_cmp_eq_u32 vcc, -1, v22
    s_cbranch_vccnz sequential_preLN__sliding_block__mixer_token_mlp__prompt_kernel_g1s5
sequential_preLN__sliding_block__mixer_token_mlp__prompt_kernel_g1r5:
    v_mfma_f32_32x32x16_bf16 v[68:83], a[40:43], v[172:175], v[68:83]
    buffer_load_dwordx4 v[140:143], v7, s[12:15], s46 offen offset:1792 sc1
    v_mfma_f32_32x32x16_bf16 v[100:115], a[44:47], v[172:175], v[100:115]
    buffer_load_dwordx4 v[144:147], v8, s[12:15], s46 offen offset:1792 sc1
    v_mfma_f32_32x32x16_bf16 v[84:99], a[40:43], v[176:179], v[84:99]
    s_add_u32 s46, s92, 7
    s_and_b32 s46, s46, 15
    s_mul_i32 s46, s46, 3584
    buffer_load_dwordx4 v[148:151], v7, s[12:15], s46 offen offset:0 sc1
    v_mfma_f32_32x32x16_bf16 v[116:131], a[44:47], v[176:179], v[116:131]
    buffer_load_dwordx4 v[152:155], v8, s[12:15], s46 offen offset:0 sc1
    s_waitcnt vmcnt(16)
    v_max_u32 v22, v183, v187
    v_cmp_eq_u32 vcc, -1, v22
    s_cbranch_vccnz sequential_preLN__sliding_block__mixer_token_mlp__prompt_kernel_g1s6
sequential_preLN__sliding_block__mixer_token_mlp__prompt_kernel_g1r6:
    v_mfma_f32_32x32x16_bf16 v[68:83], a[48:51], v[180:183], v[68:83]
    buffer_load_dwordx4 v[156:159], v7, s[12:15], s46 offen offset:1792 sc1
    v_mfma_f32_32x32x16_bf16 v[100:115], a[52:55], v[180:183], v[100:115]
    buffer_load_dwordx4 v[160:163], v8, s[12:15], s46 offen offset:1792 sc1
    v_mfma_f32_32x32x16_bf16 v[84:99], a[48:51], v[184:187], v[84:99]
    s_add_u32 s46, s92, 8
    s_and_b32 s46, s46, 15
    s_mul_i32 s46, s46, 3584
    buffer_load_dwordx4 v[164:167], v7, s[12:15], s46 offen offset:0 sc1
    v_mfma_f32_32x32x16_bf16 v[116:131], a[52:55], v[184:187], v[116:131]
    buffer_load_dwordx4 v[168:171], v8, s[12:15], s46 offen offset:0 sc1
    s_waitcnt vmcnt(18)
    v_max_u32 v22, v191, v195
    v_cmp_eq_u32 vcc, -1, v22
    s_cbranch_vccnz sequential_preLN__sliding_block__mixer_token_mlp__prompt_kernel_g1s7
sequential_preLN__sliding_block__mixer_token_mlp__prompt_kernel_g1r7:
    v_mfma_f32_32x32x16_bf16 v[68:83], a[56:59], v[188:191], v[68:83]
    buffer_load_dwordx4 v[172:175], v7, s[12:15], s46 offen offset:1792 sc1
    v_mfma_f32_32x32x16_bf16 v[100:115], a[60:63], v[188:191], v[100:115]
    buffer_load_dwordx4 v[176:179], v8, s[12:15], s46 offen offset:1792 sc1
    v_mfma_f32_32x32x16_bf16 v[84:99], a[56:59], v[192:195], v[84:99]
    s_add_u32 s46, s92, 9
    s_and_b32 s46, s46, 15
    s_mul_i32 s46, s46, 3584
    buffer_load_dwordx4 v[180:183], v7, s[12:15], s46 offen offset:0 sc1
    v_mfma_f32_32x32x16_bf16 v[116:131], a[60:63], v[192:195], v[116:131]
    buffer_load_dwordx4 v[184:187], v8, s[12:15], s46 offen offset:0 sc1
    s_waitcnt vmcnt(20)
    v_max_u32 v22, v199, v203
    v_cmp_eq_u32 vcc, -1, v22
    s_cbranch_vccnz sequential_preLN__sliding_block__mixer_token_mlp__prompt_kernel_g1s8
sequential_preLN__sliding_block__mixer_token_mlp__prompt_kernel_g1r8:
    v_mfma_f32_32x32x16_bf16 v[68:83], a[64:67], v[196:199], v[68:83]
    buffer_load_dwordx4 v[188:191], v7, s[12:15], s46 offen offset:1792 sc1
    v_mfma_f32_32x32x16_bf16 v[100:115], a[68:71], v[196:199], v[100:115]
    buffer_load_dwordx4 v[192:195], v8, s[12:15], s46 offen offset:1792 sc1
    v_mfma_f32_32x32x16_bf16 v[84:99], a[64:67], v[200:203], v[84:99]
    v_mfma_f32_32x32x16_bf16 v[116:131], a[68:71], v[200:203], v[116:131]
    s_waitcnt vmcnt(20)
    v_max_u32 v22, v207, v211
    v_cmp_eq_u32 vcc, -1, v22
    s_cbranch_vccnz sequential_preLN__sliding_block__mixer_token_mlp__prompt_kernel_g1s9
sequential_preLN__sliding_block__mixer_token_mlp__prompt_kernel_g1r9:
    v_mfma_f32_32x32x16_bf16 v[68:83], a[72:75], v[204:207], v[68:83]
    s_add_u32 s46, s92, 10
    s_and_b32 s46, s46, 15
    s_mul_i32 s46, s46, 3584
    buffer_load_dwordx4 v[196:199], v7, s[12:15], s46 offen offset:0 sc1
    v_mfma_f32_32x32x16_bf16 v[100:115], a[76:79], v[204:207], v[100:115]
    buffer_load_dwordx4 v[200:203], v8, s[12:15], s46 offen offset:0 sc1
    v_mfma_f32_32x32x16_bf16 v[84:99], a[72:75], v[208:211], v[84:99]
    v_mfma_f32_32x32x16_bf16 v[116:131], a[76:79], v[208:211], v[116:131]
    s_waitcnt vmcnt(20)
    v_max_u32 v22, v215, v219
    v_cmp_eq_u32 vcc, -1, v22
    s_cbranch_vccnz sequential_preLN__sliding_block__mixer_token_mlp__prompt_kernel_g1s10
sequential_preLN__sliding_block__mixer_token_mlp__prompt_kernel_g1r10:
    v_mfma_f32_32x32x16_bf16 v[68:83], a[80:83], v[212:215], v[68:83]
    buffer_load_dwordx4 v[204:207], v7, s[12:15], s46 offen offset:1792 sc1
    v_mfma_f32_32x32x16_bf16 v[100:115], a[84:87], v[212:215], v[100:115]
    buffer_load_dwordx4 v[208:211], v8, s[12:15], s46 offen offset:1792 sc1
    v_mfma_f32_32x32x16_bf16 v[84:99], a[80:83], v[216:219], v[84:99]
    v_mfma_f32_32x32x16_bf16 v[116:131], a[84:87], v[216:219], v[116:131]
    s_waitcnt vmcnt(20)
    v_max_u32 v22, v223, v227
    v_cmp_eq_u32 vcc, -1, v22
    s_cbranch_vccnz sequential_preLN__sliding_block__mixer_token_mlp__prompt_kernel_g1s11
sequential_preLN__sliding_block__mixer_token_mlp__prompt_kernel_g1r11:
    v_mfma_f32_32x32x16_bf16 v[68:83], a[88:91], v[220:223], v[68:83]
    s_add_u32 s46, s92, 11
    s_and_b32 s46, s46, 15
    s_mul_i32 s46, s46, 3584
    buffer_load_dwordx4 v[212:215], v7, s[12:15], s46 offen offset:0 sc1
    v_mfma_f32_32x32x16_bf16 v[100:115], a[92:95], v[220:223], v[100:115]
    buffer_load_dwordx4 v[216:219], v8, s[12:15], s46 offen offset:0 sc1
    v_mfma_f32_32x32x16_bf16 v[84:99], a[88:91], v[224:227], v[84:99]
    v_mfma_f32_32x32x16_bf16 v[116:131], a[92:95], v[224:227], v[116:131]
    s_waitcnt vmcnt(20)
    v_max_u32 v22, v135, v139
    v_cmp_eq_u32 vcc, -1, v22
    s_cbranch_vccnz sequential_preLN__sliding_block__mixer_token_mlp__prompt_kernel_g1s12
sequential_preLN__sliding_block__mixer_token_mlp__prompt_kernel_g1r12:
    v_mfma_f32_32x32x16_bf16 v[68:83], a[96:99], v[132:135], v[68:83]
    buffer_load_dwordx4 v[220:223], v7, s[12:15], s46 offen offset:1792 sc1
    buffer_load_dwordx4 v[224:227], v8, s[12:15], s46 offen offset:1792 sc1
    v_mfma_f32_32x32x16_bf16 v[100:115], a[100:103], v[132:135], v[100:115]
    ds_read_b64_tr_b16 a[0:1], v5 offset:8192
    ds_read_b64_tr_b16 a[2:3], v5 offset:9216
    v_mfma_f32_32x32x16_bf16 v[84:99], a[96:99], v[136:139], v[84:99]
    ds_read_b64_tr_b16 a[4:5], v6 offset:8192
    ds_read_b64_tr_b16 a[6:7], v6 offset:9216
    v_mfma_f32_32x32x16_bf16 v[116:131], a[100:103], v[136:139], v[116:131]
    s_waitcnt vmcnt(20)
    v_max_u32 v22, v143, v147
    v_cmp_eq_u32 vcc, -1, v22
    s_cbranch_vccnz sequential_preLN__sliding_block__mixer_token_mlp__prompt_kernel_g1s13
sequential_preLN__sliding_block__mixer_token_mlp__prompt_kernel_g1r13:
    v_mfma_f32_32x32x16_bf16 v[68:83], a[104:107], v[140:143], v[68:83]
    s_add_u32 s46, s92, 12
    s_and_b32 s46, s46, 15
    s_mul_i32 s46, s46, 3584
    buffer_load_dwordx4 v[132:135], v7, s[12:15], s46 offen offset:0 sc1
    buffer_load_dwordx4 v[136:139], v8, s[12:15], s46 offen offset:0 sc1
    v_mfma_f32_32x32x16_bf16 v[100:115], a[108:111], v[140:143], v[100:115]
    ds_read_b64_tr_b16 a[8:9], v5 offset:10240
    ds_read_b64_tr_b16 a[10:11], v5 offset:11264
    v_mfma_f32_32x32x16_bf16 v[84:99], a[104:107], v[144:147], v[84:99]
    ds_read_b64_tr_b16 a[12:13], v6 offset:10240
    ds_read_b64_tr_b16 a[14:15], v6 offset:11264
    v_mfma_f32_32x32x16_bf16 v[116:131], a[108:111], v[144:147], v[116:131]
    s_waitcnt vmcnt(20)
    v_max_u32 v22, v151, v155
    v_cmp_eq_u32 vcc, -1, v22
    s_cbranch_vccnz sequential_preLN__sliding_block__mixer_token_mlp__prompt_kernel_g1s14
sequential_preLN__sliding_block__mixer_token_mlp__prompt_kernel_g1r14:
    v_mfma_f32_32x32x16_bf16 v[68:83], a[112:115], v[148:151], v[68:83]
    buffer_load_dwordx4 v[140:143], v7, s[12:15], s46 offen offset:1792 sc1
    buffer_load_dwordx4 v[144:147], v8, s[12:15], s46 offen offset:1792 sc1
    v_mfma_f32_32x32x16_bf16 v[100:115], a[116:119], v[148:151], v[100:115]
    ds_read_b64_tr_b16 a[16:17], v5 offset:0
    ds_read_b64_tr_b16 a[18:19], v5 offset:1024
    v_mfma_f32_32x32x16_bf16 v[84:99], a[112:115], v[152:155], v[84:99]
    ds_read_b64_tr_b16 a[20:21], v6 offset:0
    ds_read_b64_tr_b16 a[22:23], v6 offset:1024
    v_mfma_f32_32x32x16_bf16 v[116:131], a[116:119], v[152:155], v[116:131]
    s_waitcnt vmcnt(20)
    v_max_u32 v22, v159, v163
    v_cmp_eq_u32 vcc, -1, v22
    s_cbranch_vccnz sequential_preLN__sliding_block__mixer_token_mlp__prompt_kernel_g1s15
sequential_preLN__sliding_block__mixer_token_mlp__prompt_kernel_g1r15:
    v_mfma_f32_32x32x16_bf16 v[68:83], a[120:123], v[156:159], v[68:83]
    s_add_u32 s46, s92, 13
    s_and_b32 s46, s46, 15
    s_mul_i32 s46, s46, 3584
    buffer_load_dwordx4 v[148:151], v7, s[12:15], s46 offen offset:0 sc1
    buffer_load_dwordx4 v[152:155], v8, s[12:15], s46 offen offset:0 sc1
    v_mfma_f32_32x32x16_bf16 v[100:115], a[124:127], v[156:159], v[100:115]
    ds_read_b64_tr_b16 a[24:25], v5 offset:2048
    ds_read_b64_tr_b16 a[26:27], v5 offset:3072
    v_mfma_f32_32x32x16_bf16 v[84:99], a[120:123], v[160:163], v[84:99]
    ds_read_b64_tr_b16 a[28:29], v6 offset:2048
    ds_read_b64_tr_b16 a[30:31], v6 offset:3072
    v_mfma_f32_32x32x16_bf16 v[116:131], a[124:127], v[160:163], v[116:131]
    s_waitcnt vmcnt(20)
    v_max_u32 v22, v167, v171
    v_cmp_eq_u32 vcc, -1, v22
    s_cbranch_vccnz sequential_preLN__sliding_block__mixer_token_mlp__prompt_kernel_g1s16
sequential_preLN__sliding_block__mixer_token_mlp__prompt_kernel_g1r16:
    v_mfma_f32_32x32x16_bf16 v[68:83], a[128:131], v[164:167], v[68:83]
    buffer_load_dwordx4 v[156:159], v7, s[12:15], s46 offen offset:1792 sc1
    buffer_load_dwordx4 v[160:163], v8, s[12:15], s46 offen offset:1792 sc1
    v_mfma_f32_32x32x16_bf16 v[100:115], a[132:135], v[164:167], v[100:115]
    ds_read_b64_tr_b16 a[32:33], v5 offset:4096
    ds_read_b64_tr_b16 a[34:35], v5 offset:5120
    v_mfma_f32_32x32x16_bf16 v[84:99], a[128:131], v[168:171], v[84:99]
    ds_read_b64_tr_b16 a[36:37], v6 offset:4096
    ds_read_b64_tr_b16 a[38:39], v6 offset:5120
    v_mfma_f32_32x32x16_bf16 v[116:131], a[132:135], v[168:171], v[116:131]
    s_waitcnt vmcnt(20)
    v_max_u32 v22, v175, v179
    v_cmp_eq_u32 vcc, -1, v22
    s_cbranch_vccnz sequential_preLN__sliding_block__mixer_token_mlp__prompt_kernel_g1s17
sequential_preLN__sliding_block__mixer_token_mlp__prompt_kernel_g1r17:
    v_mfma_f32_32x32x16_bf16 v[68:83], a[136:139], v[172:175], v[68:83]
    s_add_u32 s46, s92, 14
    s_and_b32 s46, s46, 15
    s_mul_i32 s46, s46, 3584
    buffer_load_dwordx4 v[164:167], v7, s[12:15], s46 offen offset:0 sc1
    buffer_load_dwordx4 v[168:171], v8, s[12:15], s46 offen offset:0 sc1
    v_mfma_f32_32x32x16_bf16 v[100:115], a[140:143], v[172:175], v[100:115]
    ds_read_b64_tr_b16 a[40:41], v5 offset:6144
    ds_read_b64_tr_b16 a[42:43], v5 offset:7168
    v_mfma_f32_32x32x16_bf16 v[84:99], a[136:139], v[176:179], v[84:99]
    ds_read_b64_tr_b16 a[44:45], v6 offset:6144
    ds_read_b64_tr_b16 a[46:47], v6 offset:7168
    v_mfma_f32_32x32x16_bf16 v[116:131], a[140:143], v[176:179], v[116:131]
    s_waitcnt vmcnt(20)
    v_max_u32 v22, v183, v187
    v_cmp_eq_u32 vcc, -1, v22
    s_cbranch_vccnz sequential_preLN__sliding_block__mixer_token_mlp__prompt_kernel_g1s18
sequential_preLN__sliding_block__mixer_token_mlp__prompt_kernel_g1r18:
    v_mfma_f32_32x32x16_bf16 v[68:83], a[144:147], v[180:183], v[68:83]
    buffer_load_dwordx4 v[172:175], v7, s[12:15], s46 offen offset:1792 sc1
    buffer_load_dwordx4 v[176:179], v8, s[12:15], s46 offen offset:1792 sc1
    v_mfma_f32_32x32x16_bf16 v[100:115], a[148:151], v[180:183], v[100:115]
    ds_read_b64_tr_b16 a[48:49], v5 offset:12288
    ds_read_b64_tr_b16 a[50:51], v5 offset:13312
    v_mfma_f32_32x32x16_bf16 v[84:99], a[144:147], v[184:187], v[84:99]
    ds_read_b64_tr_b16 a[52:53], v6 offset:12288
    ds_read_b64_tr_b16 a[54:55], v6 offset:13312
    v_mfma_f32_32x32x16_bf16 v[116:131], a[148:151], v[184:187], v[116:131]
    s_waitcnt vmcnt(20)
    v_max_u32 v22, v191, v195
    v_cmp_eq_u32 vcc, -1, v22
    s_cbranch_vccnz sequential_preLN__sliding_block__mixer_token_mlp__prompt_kernel_g1s19
sequential_preLN__sliding_block__mixer_token_mlp__prompt_kernel_g1r19:
    v_mfma_f32_32x32x16_bf16 v[68:83], a[152:155], v[188:191], v[68:83]
    s_add_u32 s46, s92, 15
    s_and_b32 s46, s46, 15
    s_mul_i32 s46, s46, 3584
    buffer_load_dwordx4 v[180:183], v7, s[12:15], s46 offen offset:0 sc1
    buffer_load_dwordx4 v[184:187], v8, s[12:15], s46 offen offset:0 sc1
    v_mfma_f32_32x32x16_bf16 v[100:115], a[156:159], v[188:191], v[100:115]
    ds_read_b64_tr_b16 a[56:57], v5 offset:14336
    ds_read_b64_tr_b16 a[58:59], v5 offset:15360
    v_mfma_f32_32x32x16_bf16 v[84:99], a[152:155], v[192:195], v[84:99]
    ds_read_b64_tr_b16 a[60:61], v6 offset:14336
    ds_read_b64_tr_b16 a[62:63], v6 offset:15360
    v_mfma_f32_32x32x16_bf16 v[116:131], a[156:159], v[192:195], v[116:131]
    s_waitcnt vmcnt(20)
    v_max_u32 v22, v199, v203
    v_cmp_eq_u32 vcc, -1, v22
    s_cbranch_vccnz sequential_preLN__sliding_block__mixer_token_mlp__prompt_kernel_g1s20
sequential_preLN__sliding_block__mixer_token_mlp__prompt_kernel_g1r20:
    v_mfma_f32_32x32x16_bf16 v[68:83], a[160:163], v[196:199], v[68:83]
    buffer_load_dwordx4 v[188:191], v7, s[12:15], s46 offen offset:1792 sc1
    buffer_load_dwordx4 v[192:195], v8, s[12:15], s46 offen offset:1792 sc1
    v_mfma_f32_32x32x16_bf16 v[100:115], a[164:167], v[196:199], v[100:115]
    ds_read_b64_tr_b16 a[64:65], v5 offset:16384
    ds_read_b64_tr_b16 a[66:67], v5 offset:17408
    v_mfma_f32_32x32x16_bf16 v[84:99], a[160:163], v[200:203], v[84:99]
    ds_read_b64_tr_b16 a[68:69], v6 offset:16384
    ds_read_b64_tr_b16 a[70:71], v6 offset:17408
    v_mfma_f32_32x32x16_bf16 v[116:131], a[164:167], v[200:203], v[116:131]
    s_waitcnt vmcnt(20)
    v_max_u32 v22, v207, v211
    v_cmp_eq_u32 vcc, -1, v22
    s_cbranch_vccnz sequential_preLN__sliding_block__mixer_token_mlp__prompt_kernel_g1s21
sequential_preLN__sliding_block__mixer_token_mlp__prompt_kernel_g1r21:
    v_mfma_f32_32x32x16_bf16 v[68:83], a[168:171], v[204:207], v[68:83]
    ds_read_b64_tr_b16 a[72:73], v5 offset:18432
    ds_read_b64_tr_b16 a[74:75], v5 offset:19456
    ds_read_b64_tr_b16 a[76:77], v6 offset:18432
    v_mfma_f32_32x32x16_bf16 v[100:115], a[172:175], v[204:207], v[100:115]
    ds_read_b64_tr_b16 a[78:79], v6 offset:19456
    s_waitcnt lgkmcnt(15)
    s_add_u32 s47, s93, 7
    s_sub_u32 s51, s47, 14
    s_min_u32 s47, s47, s51
    s_mul_i32 s47, s47, 131072
    s_add_u32 m0, s48, 8192
    s_nop 0
    buffer_load_dwordx4 v18, s[20:23], s47 offen offset:0 lds
    v_mfma_f32_32x32x16_bf16 v[84:99], a[168:171], v[208:211], v[84:99]
    buffer_load_dwordx4 v19, s[20:23], s47 offen offset:1024 lds
    buffer_load_dwordx4 v20, s[20:23], s47 offen offset:2048 lds
    buffer_load_dwordx4 v21, s[20:23], s47 offen offset:3072 lds
    v_mfma_f32_32x32x16_bf16 v[116:131], a[172:175], v[208:211], v[116:131]
    s_waitcnt vmcnt(22)
    v_max_u32 v22, v215, v219
    v_cmp_eq_u32 vcc, -1, v22
    s_cbranch_vccnz sequential_preLN__sliding_block__mixer_token_mlp__prompt_kernel_g1s22
sequential_preLN__sliding_block__mixer_token_mlp__prompt_kernel_g1r22:
    v_mfma_f32_32x32x16_bf16 v[68:83], a[176:179], v[212:215], v[68:83]
    ds_read_b64_tr_b16 a[80:81], v5 offset:20480
    ds_read_b64_tr_b16 a[82:83], v5 offset:21504
    ds_read_b64_tr_b16 a[84:85], v6 offset:20480
    v_mfma_f32_32x32x16_bf16 v[100:115], a[180:183], v[212:215], v[100:115]
    ds_read_b64_tr_b16 a[86:87], v6 offset:21504
    s_add_u32 s47, s93, 8
    s_sub_u32 s51, s47, 14
    s_min_u32 s47, s47, s51
    s_mul_i32 s47, s47, 131072
    s_add_u32 m0, s48, 0
    s_nop 0
    buffer_load_dwordx4 v18, s[20:23], s47 offen offset:0 lds
    v_mfma_f32_32x32x16_bf16 v[84:99], a[176:179], v[216:219], v[84:99]
    buffer_load_dwordx4 v19, s[20:23], s47 offen offset:1024 lds
    buffer_load_dwordx4 v20, s[20:23], s47 offen offset:2048 lds
    buffer_load_dwordx4 v21, s[20:23], s47 offen offset:3072 lds
    v_mfma_f32_32x32x16_bf16 v[116:131], a[180:183], v[216:219], v[116:131]
    s_waitcnt vmcnt(24)
    v_max_u32 v22, v223, v227
    v_cmp_eq_u32 vcc, -1, v22
    s_cbranch_vccnz sequential_preLN__sliding_block__mixer_token_mlp__prompt_kernel_g1s23
sequential_preLN__sliding_block__mixer_token_mlp__prompt_kernel_g1r23:
    v_mfma_f32_32x32x16_bf16 v[68:83], a[184:187], v[220:223], v[68:83]
    ds_read_b64_tr_b16 a[88:89], v5 offset:22528
    ds_read_b64_tr_b16 a[90:91], v5 offset:23552
    ds_read_b64_tr_b16 a[92:93], v6 offset:22528
    v_mfma_f32_32x32x16_bf16 v[100:115], a[188:191], v[220:223], v[100:115]
    ds_read_b64_tr_b16 a[94:95], v6 offset:23552
    s_add_u32 s47, s93, 9
    s_sub_u32 s51, s47, 14
    s_min_u32 s47, s47, s51
    s_mul_i32 s47, s47, 131072
    s_add_u32 m0, s48, 4096
    s_nop 0
    buffer_load_dwordx4 v18, s[20:23], s47 offen offset:0 lds
    v_mfma_f32_32x32x16_bf16 v[84:99], a[184:187], v[224:227], v[84:99]
    buffer_load_dwordx4 v19, s[20:23], s47 offen offset:1024 lds
    buffer_load_dwordx4 v20, s[20:23], s47 offen offset:2048 lds
    buffer_load_dwordx4 v21, s[20:23], s47 offen offset:3072 lds
    v_mfma_f32_32x32x16_bf16 v[116:131], a[188:191], v[224:227], v[116:131]
    s_waitcnt vmcnt(26)
    v_max_u32 v22, v135, v139
    v_cmp_eq_u32 vcc, -1, v22
    s_cbranch_vccnz sequential_preLN__sliding_block__mixer_token_mlp__prompt_kernel_g1s24
sequential_preLN__sliding_block__mixer_token_mlp__prompt_kernel_g1r24:
    v_mfma_f32_32x32x16_bf16 v[68:83], a[192:195], v[132:135], v[68:83]
    ds_read_b64_tr_b16 a[96:97], v5 offset:24576
    ds_read_b64_tr_b16 a[98:99], v5 offset:25600
    ds_read_b64_tr_b16 a[100:101], v6 offset:24576
    v_mfma_f32_32x32x16_bf16 v[100:115], a[196:199], v[132:135], v[100:115]
    ds_read_b64_tr_b16 a[102:103], v6 offset:25600
    s_waitcnt lgkmcnt(15)
    s_add_u32 s47, s93, 10
    s_sub_u32 s51, s47, 14
    s_min_u32 s47, s47, s51
    s_mul_i32 s47, s47, 131072
    s_add_u32 m0, s48, 12288
    s_nop 0
    buffer_load_dwordx4 v18, s[20:23], s47 offen offset:0 lds
    v_mfma_f32_32x32x16_bf16 v[84:99], a[192:195], v[136:139], v[84:99]
    buffer_load_dwordx4 v19, s[20:23], s47 offen offset:1024 lds
    buffer_load_dwordx4 v20, s[20:23], s47 offen offset:2048 lds
    buffer_load_dwordx4 v21, s[20:23], s47 offen offset:3072 lds
    v_mfma_f32_32x32x16_bf16 v[116:131], a[196:199], v[136:139], v[116:131]
    s_waitcnt vmcnt(28)
    v_max_u32 v22, v143, v147
    v_cmp_eq_u32 vcc, -1, v22
    s_cbranch_vccnz sequential_preLN__sliding_block__mixer_token_mlp__prompt_kernel_g1s25
sequential_preLN__sliding_block__mixer_token_mlp__prompt_kernel_g1r25:
    v_mfma_f32_32x32x16_bf16 v[68:83], a[200:203], v[140:143], v[68:83]
    ds_read_b64_tr_b16 a[104:105], v5 offset:26624
    ds_read_b64_tr_b16 a[106:107], v5 offset:27648
    ds_read_b64_tr_b16 a[108:109], v6 offset:26624
    v_mfma_f32_32x32x16_bf16 v[100:115], a[204:207], v[140:143], v[100:115]
    ds_read_b64_tr_b16 a[110:111], v6 offset:27648
    s_waitcnt lgkmcnt(15)
    s_add_u32 s47, s93, 11
    s_sub_u32 s51, s47, 14
    s_min_u32 s47, s47, s51
    s_mul_i32 s47, s47, 131072
    s_add_u32 m0, s48, 16384
    s_nop 0
    buffer_load_dwordx4 v18, s[20:23], s47 offen offset:0 lds
    v_mfma_f32_32x32x16_bf16 v[84:99], a[200:203], v[144:147], v[84:99]
    buffer_load_dwordx4 v19, s[20:23], s47 offen offset:1024 lds
    buffer_load_dwordx4 v20, s[20:23], s47 offen offset:2048 lds
    buffer_load_dwordx4 v21, s[20:23], s47 offen offset:3072 lds
    v_mfma_f32_32x32x16_bf16 v[116:131], a[204:207], v[144:147], v[116:131]
    s_waitcnt vmcnt(30)
    v_max_u32 v22, v151, v155
    v_cmp_eq_u32 vcc, -1, v22
    s_cbranch_vccnz sequential_preLN__sliding_block__mixer_token_mlp__prompt_kernel_g1s26
sequential_preLN__sliding_block__mixer_token_mlp__prompt_kernel_g1r26:
    v_mfma_f32_32x32x16_bf16 v[68:83], a[208:211], v[148:151], v[68:83]
    s_waitcnt lgkmcnt(8)
    s_add_u32 s47, s93, 12
    s_sub_u32 s51, s47, 14
    s_min_u32 s47, s47, s51
    s_mul_i32 s47, s47, 131072
    s_add_u32 m0, s48, 20480
    s_nop 0
    buffer_load_dwordx4 v18, s[20:23], s47 offen offset:0 lds
    v_mfma_f32_32x32x16_bf16 v[100:115], a[212:215], v[148:151], v[100:115]
    buffer_load_dwordx4 v19, s[20:23], s47 offen offset:1024 lds
    buffer_load_dwordx4 v20, s[20:23], s47 offen offset:2048 lds
    v_mfma_f32_32x32x16_bf16 v[84:99], a[208:211], v[152:155], v[84:99]
    buffer_load_dwordx4 v21, s[20:23], s47 offen offset:3072 lds
    v_mfma_f32_32x32x16_bf16 v[116:131], a[212:215], v[152:155], v[116:131]
    s_waitcnt vmcnt(32)
    v_max_u32 v22, v159, v163
    v_cmp_eq_u32 vcc, -1, v22
    s_cbranch_vccnz sequential_preLN__sliding_block__mixer_token_mlp__prompt_kernel_g1s27
sequential_preLN__sliding_block__mixer_token_mlp__prompt_kernel_g1r27:
    v_mfma_f32_32x32x16_bf16 v[68:83], a[216:219], v[156:159], v[68:83]
    s_waitcnt lgkmcnt(0)
    s_add_u32 s47, s93, 13
    s_sub_u32 s51, s47, 14
    s_min_u32 s47, s47, s51
    s_mul_i32 s47, s47, 131072
    s_add_u32 m0, s48, 24576
    s_nop 0
    buffer_load_dwordx4 v18, s[20:23], s47 offen offset:0 lds
    v_mfma_f32_32x32x16_bf16 v[100:115], a[220:223], v[156:159], v[100:115]
    buffer_load_dwordx4 v19, s[20:23], s47 offen offset:1024 lds
    buffer_load_dwordx4 v20, s[20:23], s47 offen offset:2048 lds
    v_mfma_f32_32x32x16_bf16 v[84:99], a[216:219], v[160:163], v[84:99]
    buffer_load_dwordx4 v21, s[20:23], s47 offen offset:3072 lds
    v_mfma_f32_32x32x16_bf16 v[116:131], a[220:223], v[160:163], v[116:131]
    s_waitcnt vmcnt(34)
    v_max_u32 v22, v167, v171
    v_cmp_eq_u32 vcc, -1, v22
    s_cbranch_vccnz sequential_preLN__sliding_block__mixer_token_mlp__prompt_kernel_g1s28
sequential_preLN__sliding_block__mixer_token_mlp__prompt_kernel_g1r28:
    v_mfma_f32_32x32x16_bf16 v[68:83], a[224:227], v[164:167], v[68:83]
    v_mfma_f32_32x32x16_bf16 v[100:115], a[228:231], v[164:167], v[100:115]
    v_mfma_f32_32x32x16_bf16 v[84:99], a[224:227], v[168:171], v[84:99]
    v_mfma_f32_32x32x16_bf16 v[116:131], a[228:231], v[168:171], v[116:131]
    s_waitcnt vmcnt(32)
    v_max_u32 v22, v175, v179
    v_cmp_eq_u32 vcc, -1, v22
    s_cbranch_vccnz sequential_preLN__sliding_block__mixer_token_mlp__prompt_kernel_g1s29
sequential_preLN__sliding_block__mixer_token_mlp__prompt_kernel_g1r29:
    v_mfma_f32_32x32x16_bf16 v[68:83], a[232:235], v[172:175], v[68:83]
    v_mfma_f32_32x32x16_bf16 v[100:115], a[236:239], v[172:175], v[100:115]
    v_mfma_f32_32x32x16_bf16 v[84:99], a[232:235], v[176:179], v[84:99]
    v_mfma_f32_32x32x16_bf16 v[116:131], a[236:239], v[176:179], v[116:131]
    s_waitcnt vmcnt(30)
    v_max_u32 v22, v183, v187
    v_cmp_eq_u32 vcc, -1, v22
    s_cbranch_vccnz sequential_preLN__sliding_block__mixer_token_mlp__prompt_kernel_g1s30
sequential_preLN__sliding_block__mixer_token_mlp__prompt_kernel_g1r30:
    v_mfma_f32_32x32x16_bf16 v[68:83], a[240:243], v[180:183], v[68:83]
    v_mfma_f32_32x32x16_bf16 v[100:115], a[244:247], v[180:183], v[100:115]
    v_mfma_f32_32x32x16_bf16 v[84:99], a[240:243], v[184:187], v[84:99]
    v_mfma_f32_32x32x16_bf16 v[116:131], a[244:247], v[184:187], v[116:131]
    s_waitcnt vmcnt(28)
    v_max_u32 v22, v191, v195
    v_cmp_eq_u32 vcc, -1, v22
    s_cbranch_vccnz sequential_preLN__sliding_block__mixer_token_mlp__prompt_kernel_g1s31
sequential_preLN__sliding_block__mixer_token_mlp__prompt_kernel_g1r31:
    v_mfma_f32_32x32x16_bf16 v[68:83], a[248:251], v[188:191], v[68:83]
    v_mfma_f32_32x32x16_bf16 v[100:115], a[252:255], v[188:191], v[100:115]
    v_mfma_f32_32x32x16_bf16 v[84:99], a[248:251], v[192:195], v[84:99]
    v_mfma_f32_32x32x16_bf16 v[116:131], a[252:255], v[192:195], v[116:131]
    s_cmp_eq_u32 s36, 1
    s_cbranch_scc1 sequential_preLN__sliding_block__mixer_token_mlp__prompt_kernel_e41
    s_cmp_eq_u32 s36, 2
    s_cbranch_scc1 sequential_preLN__sliding_block__mixer_token_mlp__prompt_kernel_e42
    s_cmp_eq_u32 s36, 3
    s_cbranch_scc1 sequential_preLN__sliding_block__mixer_token_mlp__prompt_kernel_e43
sequential_preLN__sliding_block__mixer_token_mlp__prompt_kernel_e40:
    s_nop 7
    ds_write_b128 v2, v[76:79] offset:20480
    ds_write_b128 v2, v[80:83] offset:21504
    ds_write_b128 v2, v[92:95] offset:22528
    ds_write_b128 v2, v[96:99] offset:23552
    ds_write_b128 v2, v[100:103] offset:28672
    ds_write_b128 v2, v[104:107] offset:29696
    ds_write_b128 v2, v[116:119] offset:30720
    ds_write_b128 v2, v[120:123] offset:31744
    ds_write_b128 v2, v[108:111] offset:36864
    ds_write_b128 v2, v[112:115] offset:37888
    ds_write_b128 v2, v[124:127] offset:38912
    ds_write_b128 v2, v[128:131] offset:39936
    v_lshlrev_b32 v180, 16, v30
    v_and_b32 v181, 0xffff0000, v30
    v_lshlrev_b32 v182, 16, v31
    v_and_b32 v183, 0xffff0000, v31
    v_lshlrev_b32 v184, 16, v32
    v_and_b32 v185, 0xffff0000, v32
    v_lshlrev_b32 v186, 16, v33
    v_and_b32 v187, 0xffff0000, v33
    v_add_f32 v68, v68, v180
    v_add_f32 v69, v69, v181
    v_add_f32 v70, v70, v182
    v_add_f32 v71, v71, v183
    v_add_f32 v72, v72, v184
    v_add_f32 v73, v73, v185
    v_add_f32 v74, v74, v186
    v_add_f32 v75, v75, v187
    v_add_f32 v84, v84, v180
    v_add_f32 v85, v85, v181
    v_add_f32 v86, v86, v182
    v_add_f32 v87, v87, v183
    v_add_f32 v88, v88, v184
    v_add_f32 v89, v89, v185
    v_add_f32 v90, v90, v186
    v_add_f32 v91, v91, v187
    s_waitcnt lgkmcnt(0)
    s_barrier
    ds_read_b128 v[132:135], v2 offset:0
    ds_read_b128 v[136:139], v2 offset:1024
    ds_read_b128 v[140:143], v2 offset:2048
    ds_read_b128 v[144:147], v2 offset:3072
    ds_read_b128 v[148:151], v2 offset:4096
    ds_read_b128 v[152:155], v2 offset:5120
    ds_read_b128 v[156:159], v2 offset:6144
    ds_read_b128 v[160:163], v2 offset:7168
    ds_read_b128 v[164:167], v2 offset:8192
    ds_read_b128 v[168:171], v2 offset:9216
    ds_read_b128 v[172:175], v2 offset:10240
    ds_read_b128 v[176:179], v2 offset:11264
    s_waitcnt lgkmcnt(8)
    v_add_f32 v68, v68, v132
    v_add_f32 v69, v69, v133
    v_add_f32 v70, v70, v134
    v_add_f32 v71, v71, v135
    v_add_f32 v72, v72, v136
    v_add_f32 v73, v73, v137
    v_add_f32 v74, v74, v138
    v_add_f32 v75, v75, v139
    v_add_f32 v84, v84, v140
    v_add_f32 v85, v85, v141
    v_add_f32 v86, v86, v142
    v_add_f32 v87, v87, v143
    v_add_f32 v88, v88, v144
    v_add_f32 v89, v89, v145
    v_add_f32 v90, v90, v146
    v_add_f32 v91, v91, v147
    s_waitcnt lgkmcnt(4)
    v_add_f32 v68, v68, v148
    v_add_f32 v69, v69, v149
    v_add_f32 v70, v70, v150
    v_add_f32 v71, v71, v151
    v_add_f32 v72, v72, v152
    v_add_f32 v73, v73, v153
    v_add_f32 v74, v74, v154
    v_add_f32 v75, v75, v155
    v_add_f32 v84, v84, v156
    v_add_f32 v85, v85, v157
    v_add_f32 v86, v86, v158
    v_add_f32 v87, v87, v159
    v_add_f32 v88, v88, v160
    v_add_f32 v89, v89, v161
    v_add_f32 v90, v90, v162
    v_add_f32 v91, v91, v163
    s_waitcnt lgkmcnt(0)
    v_add_f32 v196, v68, v164
    v_add_f32 v197, v69, v165
    v_add_f32 v198, v70, v166
    v_add_f32 v199, v71, v167
    v_add_f32 v200, v72, v168
    v_add_f32 v201, v73, v169
    v_add_f32 v202, v74, v170
    v_add_f32 v203, v75, v171
    v_add_f32 v204, v84, v172
    v_add_f32 v205, v85, v173
    v_add_f32 v206, v86, v174
    v_add_f32 v207, v87, v175
    v_add_f32 v208, v88, v176
    v_add_f32 v209, v89, v177
    v_add_f32 v210, v90, v178
    v_add_f32 v211, v91, v179
    s_branch sequential_preLN__sliding_block__mixer_token_mlp__prompt_kernel_j4
sequential_preLN__sliding_block__mixer_token_mlp__prompt_kernel_e41:
    s_nop 7
    ds_write_b128 v2, v[100:103] offset:32768
    ds_write_b128 v2, v[104:107] offset:33792
    ds_write_b128 v2, v[116:119] offset:34816
    ds_write_b128 v2, v[120:123] offset:35840
    ds_write_b128 v2, v[108:111] offset:40960
    ds_write_b128 v2, v[112:115] offset:41984
    ds_write_b128 v2, v[124:127] offset:43008
    ds_write_b128 v2, v[128:131] offset:44032
    ds_write_b128 v2, v[68:71] offset:0
    ds_write_b128 v2, v[72:75] offset:1024
    ds_write_b128 v2, v[84:87] offset:2048
    ds_write_b128 v2, v[88:91] offset:3072
    v_lshlrev_b32 v180, 16, v30
    v_and_b32 v181, 0xffff0000, v30
    v_lshlrev_b32 v182, 16, v31
    v_and_b32 v183, 0xffff0000, v31
    v_lshlrev_b32 v184, 16, v32
    v_and_b32 v185, 0xffff0000, v32
    v_lshlrev_b32 v186, 16, v33
    v_and_b32 v187, 0xffff0000, v33
    v_add_f32 v76, v76, v180
    v_add_f32 v77, v77, v181
    v_add_f32 v78, v78, v182
    v_add_f32 v79, v79, v183
    v_add_f32 v80, v80, v184
    v_add_f32 v81, v81, v185
    v_add_f32 v82, v82, v186
    v_add_f32 v83, v83, v187
    v_add_f32 v92, v92, v180
    v_add_f32 v93, v93, v181
    v_add_f32 v94, v94, v182
    v_add_f32 v95, v95, v183
    v_add_f32 v96, v96, v184
    v_add_f32 v97, v97, v185
    v_add_f32 v98, v98, v186
    v_add_f32 v99, v99, v187
    s_waitcnt lgkmcnt(0)
    s_barrier
    ds_read_b128 v[132:135], v2 offset:12288
    ds_read_b128 v[136:139], v2 offset:13312
    ds_read_b128 v[140:143], v2 offset:14336
    ds_read_b128 v[144:147], v2 offset:15360
    ds_read_b128 v[148:151], v2 offset:16384
    ds_read_b128 v[152:155], v2 offset:17408
    ds_read_b128 v[156:159], v2 offset:18432
    ds_read_b128 v[160:163], v2 offset:19456
    ds_read_b128 v[164:167], v2 offset:20480
    ds_read_b128 v[168:171], v2 offset:21504
    ds_read_b128 v[172:175], v2 offset:22528
    ds_read_b128 v[176:179], v2 offset:23552
    s_waitcnt lgkmcnt(8)
    v_add_f32 v76, v76, v132
    v_add_f32 v77, v77, v133
    v_add_f32 v78, v78, v134
    v_add_f32 v79, v79, v135
    v_add_f32 v80, v80, v136
    v_add_f32 v81, v81, v137
    v_add_f32 v82, v82, v138
    v_add_f32 v83, v83, v139
    v_add_f32 v92, v92, v140
    v_add_f32 v93, v93, v141
    v_add_f32 v94, v94, v142
    v_add_f32 v95, v95, v143
    v_add_f32 v96, v96, v144
    v_add_f32 v97, v97, v145
    v_add_f32 v98, v98, v146
    v_add_f32 v99, v99, v147
    s_waitcnt lgkmcnt(4)
    v_add_f32 v76, v76, v148
    v_add_f32 v77, v77, v149
    v_add_f32 v78, v78, v150
    v_add_f32 v79, v79, v151
    v_add_f32 v80, v80, v152
    v_add_f32 v81, v81, v153
    v_add_f32 v82, v82, v154
    v_add_f32 v83, v83, v155
    v_add_f32 v92, v92, v156
    v_add_f32 v93, v93, v157
    v_add_f32 v94, v94, v158
    v_add_f32 v95, v95, v159
    v_add_f32 v96, v96, v160
    v_add_f32 v97, v97, v161
    v_add_f32 v98, v98, v162
    v_add_f32 v99, v99, v163
    s_waitcnt lgkmcnt(0)
    v_add_f32 v196, v76, v164
    v_add_f32 v197, v77, v165
    v_add_f32 v198, v78, v166
    v_add_f32 v199, v79, v167
    v_add_f32 v200, v80, v168
    v_add_f32 v201, v81, v169
    v_add_f32 v202, v82, v170
    v_add_f32 v203, v83, v171
    v_add_f32 v204, v92, v172
    v_add_f32 v205, v93, v173
    v_add_f32 v206, v94, v174
    v_add_f32 v207, v95, v175
    v_add_f32 v208, v96, v176
    v_add_f32 v209, v97, v177
    v_add_f32 v210, v98, v178
    v_add_f32 v211, v99, v179
    s_branch sequential_preLN__sliding_block__mixer_token_mlp__prompt_kernel_j4
sequential_preLN__sliding_block__mixer_token_mlp__prompt_kernel_e42:
    s_nop 7
    ds_write_b128 v2, v[108:111] offset:45056
    ds_write_b128 v2, v[112:115] offset:46080
    ds_write_b128 v2, v[124:127] offset:47104
    ds_write_b128 v2, v[128:131] offset:48128
    ds_write_b128 v2, v[68:71] offset:4096
    ds_write_b128 v2, v[72:75] offset:5120
    ds_write_b128 v2, v[84:87] offset:6144
    ds_write_b128 v2, v[88:91] offset:7168
    ds_write_b128 v2, v[76:79] offset:12288
    ds_write_b128 v2, v[80:83] offset:13312
    ds_write_b128 v2, v[92:95] offset:14336
    ds_write_b128 v2, v[96:99] offset:15360
    v_lshlrev_b32 v180, 16, v30
    v_and_b32 v181, 0xffff0000, v30
    v_lshlrev_b32 v182, 16, v31
    v_and_b32 v183, 0xffff0000, v31
    v_lshlrev_b32 v184, 16, v32
    v_and_b32 v185, 0xffff0000, v32
    v_lshlrev_b32 v186, 16, v33
    v_and_b32 v187, 0xffff0000, v33
    v_add_f32 v100, v100, v180
    v_add_f32 v101, v101, v181
    v_add_f32 v102, v102, v182
    v_add_f32 v103, v103, v183
    v_add_f32 v104, v104, v184
    v_add_f32 v105, v105, v185
    v_add_f32 v106, v106, v186
    v_add_f32 v107, v107, v187
    v_add_f32 v116, v116, v180
    v_add_f32 v117, v117, v181
    v_add_f32 v118, v118, v182
    v_add_f32 v119, v119, v183
    v_add_f32 v120, v120, v184
    v_add_f32 v121, v121, v185
    v_add_f32 v122, v122, v186
    v_add_f32 v123, v123, v187
    s_waitcnt lgkmcnt(0)
    s_barrier
    ds_read_b128 v[132:135], v2 offset:24576
    ds_read_b128 v[136:139], v2 offset:25600
    ds_read_b128 v[140:143], v2 offset:26624
    ds_read_b128 v[144:147], v2 offset:27648
    ds_read_b128 v[148:151], v2 offset:28672
    ds_read_b128 v[152:155], v2 offset:29696
    ds_read_b128 v[156:159], v2 offset:30720
    ds_read_b128 v[160:163], v2 offset:31744
    ds_read_b128 v[164:167], v2 offset:32768
    ds_read_b128 v[168:171], v2 offset:33792
    ds_read_b128 v[172:175], v2 offset:34816
    ds_read_b128 v[176:179], v2 offset:35840
    s_waitcnt lgkmcnt(8)
    v_add_f32 v100, v100, v132
    v_add_f32 v101, v101, v133
    v_add_f32 v102, v102, v134
    v_add_f32 v103, v103, v135
    v_add_f32 v104, v104, v136
    v_add_f32 v105, v105, v137
    v_add_f32 v106, v106, v138
    v_add_f32 v107, v107, v139
    v_add_f32 v116, v116, v140
    v_add_f32 v117, v117, v141
    v_add_f32 v118, v118, v142
    v_add_f32 v119, v119, v143
    v_add_f32 v120, v120, v144
    v_add_f32 v121, v121, v145
    v_add_f32 v122, v122, v146
    v_add_f32 v123, v123, v147
    s_waitcnt lgkmcnt(4)
    v_add_f32 v100, v100, v148
    v_add_f32 v101, v101, v149
    v_add_f32 v102, v102, v150
    v_add_f32 v103, v103, v151
    v_add_f32 v104, v104, v152
    v_add_f32 v105, v105, v153
    v_add_f32 v106, v106, v154
    v_add_f32 v107, v107, v155
    v_add_f32 v116, v116, v156
    v_add_f32 v117, v117, v157
    v_add_f32 v118, v118, v158
    v_add_f32 v119, v119, v159
    v_add_f32 v120, v120, v160
    v_add_f32 v121, v121, v161
    v_add_f32 v122, v122, v162
    v_add_f32 v123, v123, v163
    s_waitcnt lgkmcnt(0)
    v_add_f32 v196, v100, v164
    v_add_f32 v197, v101, v165
    v_add_f32 v198, v102, v166
    v_add_f32 v199, v103, v167
    v_add_f32 v200, v104, v168
    v_add_f32 v201, v105, v169
    v_add_f32 v202, v106, v170
    v_add_f32 v203, v107, v171
    v_add_f32 v204, v116, v172
    v_add_f32 v205, v117, v173
    v_add_f32 v206, v118, v174
    v_add_f32 v207, v119, v175
    v_add_f32 v208, v120, v176
    v_add_f32 v209, v121, v177
    v_add_f32 v210, v122, v178
    v_add_f32 v211, v123, v179
    s_branch sequential_preLN__sliding_block__mixer_token_mlp__prompt_kernel_j4
sequential_preLN__sliding_block__mixer_token_mlp__prompt_kernel_e43:
    s_nop 7
    ds_write_b128 v2, v[68:71] offset:8192
    ds_write_b128 v2, v[72:75] offset:9216
    ds_write_b128 v2, v[84:87] offset:10240
    ds_write_b128 v2, v[88:91] offset:11264
    ds_write_b128 v2, v[76:79] offset:16384
    ds_write_b128 v2, v[80:83] offset:17408
    ds_write_b128 v2, v[92:95] offset:18432
    ds_write_b128 v2, v[96:99] offset:19456
    ds_write_b128 v2, v[100:103] offset:24576
    ds_write_b128 v2, v[104:107] offset:25600
    ds_write_b128 v2, v[116:119] offset:26624
    ds_write_b128 v2, v[120:123] offset:27648
    v_lshlrev_b32 v180, 16, v30
    v_and_b32 v181, 0xffff0000, v30
    v_lshlrev_b32 v182, 16, v31
    v_and_b32 v183, 0xffff0000, v31
    v_lshlrev_b32 v184, 16, v32
    v_and_b32 v185, 0xffff0000, v32
    v_lshlrev_b32 v186, 16, v33
    v_and_b32 v187, 0xffff0000, v33
    v_add_f32 v108, v108, v180
    v_add_f32 v109, v109, v181
    v_add_f32 v110, v110, v182
    v_add_f32 v111, v111, v183
    v_add_f32 v112, v112, v184
    v_add_f32 v113, v113, v185
    v_add_f32 v114, v114, v186
    v_add_f32 v115, v115, v187
    v_add_f32 v124, v124, v180
    v_add_f32 v125, v125, v181
    v_add_f32 v126, v126, v182
    v_add_f32 v127, v127, v183
    v_add_f32 v128, v128, v184
    v_add_f32 v129, v129, v185
    v_add_f32 v130, v130, v186
    v_add_f32 v131, v131, v187
    s_waitcnt lgkmcnt(0)
    s_barrier
    ds_read_b128 v[132:135], v2 offset:36864
    ds_read_b128 v[136:139], v2 offset:37888
    ds_read_b128 v[140:143], v2 offset:38912
    ds_read_b128 v[144:147], v2 offset:39936
    ds_read_b128 v[148:151], v2 offset:40960
    ds_read_b128 v[152:155], v2 offset:41984
    ds_read_b128 v[156:159], v2 offset:43008
    ds_read_b128 v[160:163], v2 offset:44032
    ds_read_b128 v[164:167], v2 offset:45056
    ds_read_b128 v[168:171], v2 offset:46080
    ds_read_b128 v[172:175], v2 offset:47104
    ds_read_b128 v[176:179], v2 offset:48128
    s_waitcnt lgkmcnt(8)
    v_add_f32 v108, v108, v132
    v_add_f32 v109, v109, v133
    v_add_f32 v110, v110, v134
    v_add_f32 v111, v111, v135
    v_add_f32 v112, v112, v136
    v_add_f32 v113, v113, v137
    v_add_f32 v114, v114, v138
    v_add_f32 v115, v115, v139
    v_add_f32 v124, v124, v140
    v_add_f32 v125, v125, v141
    v_add_f32 v126, v126, v142
    v_add_f32 v127, v127, v143
    v_add_f32 v128, v128, v144
    v_add_f32 v129, v129, v145
    v_add_f32 v130, v130, v146
    v_add_f32 v131, v131, v147
    s_waitcnt lgkmcnt(4)
    v_add_f32 v108, v108, v148
    v_add_f32 v109, v109, v149
    v_add_f32 v110, v110, v150
    v_add_f32 v111, v111, v151
    v_add_f32 v112, v112, v152
    v_add_f32 v113, v113, v153
    v_add_f32 v114, v114, v154
    v_add_f32 v115, v115, v155
    v_add_f32 v124, v124, v156
    v_add_f32 v125, v125, v157
    v_add_f32 v126, v126, v158
    v_add_f32 v127, v127, v159
    v_add_f32 v128, v128, v160
    v_add_f32 v129, v129, v161
    v_add_f32 v130, v130, v162
    v_add_f32 v131, v131, v163
    s_waitcnt lgkmcnt(0)
    v_add_f32 v196, v108, v164
    v_add_f32 v197, v109, v165
    v_add_f32 v198, v110, v166
    v_add_f32 v199, v111, v167
    v_add_f32 v200, v112, v168
    v_add_f32 v201, v113, v169
    v_add_f32 v202, v114, v170
    v_add_f32 v203, v115, v171
    v_add_f32 v204, v124, v172
    v_add_f32 v205, v125, v173
    v_add_f32 v206, v126, v174
    v_add_f32 v207, v127, v175
    v_add_f32 v208, v128, v176
    v_add_f32 v209, v129, v177
    v_add_f32 v210, v130, v178
    v_add_f32 v211, v131, v179
sequential_preLN__sliding_block__mixer_token_mlp__prompt_kernel_j4:
    v_mov_b32 v22, s58
    v_mul_f32 v132, v196, v196
    v_mul_f32 v133, v197, v197
    v_mul_f32 v134, v198, v198
    v_mul_f32 v135, v199, v199
    v_mul_f32 v136, v200, v200
    v_mul_f32 v137, v201, v201
    v_mul_f32 v138, v202, v202
    v_mul_f32 v139, v203, v203
    v_mul_f32 v140, v204, v204
    v_mul_f32 v141, v205, v205
    v_mul_f32 v142, v206, v206
    v_mul_f32 v143, v207, v207
    v_mul_f32 v144, v208, v208
    v_mul_f32 v145, v209, v209
    v_mul_f32 v146, v210, v210
    v_mul_f32 v147, v211, v211
    v_fma_f32 v132, v132, s59, v22
    v_fma_f32 v133, v133, s59, v22
    v_fma_f32 v134, v134, s59, v22
    v_fma_f32 v135, v135, s59, v22
    v_fma_f32 v136, v136, s59, v22
    v_fma_f32 v137, v137, s59, v22
    v_fma_f32 v138, v138, s59, v22
    v_fma_f32 v139, v139, s59, v22
    v_fma_f32 v140, v140, s59, v22
    v_fma_f32 v141, v141, s59, v22
    v_fma_f32 v142, v142, s59, v22
    v_fma_f32 v143, v143, s59, v22
    v_fma_f32 v144, v144, s59, v22
    v_fma_f32 v145, v145, s59, v22
    v_fma_f32 v146, v146, s59, v22
    v_fma_f32 v147, v147, s59, v22
    v_mul_f32 v132, v132, v196
    v_mul_f32 v133, v133, v197
    v_mul_f32 v134, v134, v198
    v_mul_f32 v135, v135, v199
    v_mul_f32 v136, v136, v200
    v_mul_f32 v137, v137, v201
    v_mul_f32 v138, v138, v202
    v_mul_f32 v139, v139, v203
    v_mul_f32 v140, v140, v204
    v_mul_f32 v141, v141, v205
    v_mul_f32 v142, v142, v206
    v_mul_f32 v143, v143, v207
    v_mul_f32 v144, v144, v208
    v_mul_f32 v145, v145, v209
    v_mul_f32 v146, v146, v210
    v_mul_f32 v147, v147, v211
    v_exp_f32 v132, v132
    v_exp_f32 v133, v133
    v_exp_f32 v134, v134
    v_exp_f32 v135, v135
    v_exp_f32 v136, v136
    v_exp_f32 v137, v137
    v_exp_f32 v138, v138
    v_exp_f32 v139, v139
    v_exp_f32 v140, v140
    v_exp_f32 v141, v141
    v_exp_f32 v142, v142
    v_exp_f32 v143, v143
    v_exp_f32 v144, v144
    v_exp_f32 v145, v145
    v_exp_f32 v146, v146
    v_exp_f32 v147, v147
    v_add_f32 v132, 1.0, v132
    v_add_f32 v133, 1.0, v133
    v_add_f32 v134, 1.0, v134
    v_add_f32 v135, 1.0, v135
    v_add_f32 v136, 1.0, v136
    v_add_f32 v137, 1.0, v137
    v_add_f32 v138, 1.0, v138
    v_add_f32 v139, 1.0, v139
    v_add_f32 v140, 1.0, v140
    v_add_f32 v141, 1.0, v141
    v_add_f32 v142, 1.0, v142
    v_add_f32 v143, 1.0, v143
    v_add_f32 v144, 1.0, v144
    v_add_f32 v145, 1.0, v145
    v_add_f32 v146, 1.0, v146
    v_add_f32 v147, 1.0, v147
    v_rcp_f32 v132, v132
    v_rcp_f32 v133, v133
    v_rcp_f32 v134, v134
    v_rcp_f32 v135, v135
    v_rcp_f32 v136, v136
    v_rcp_f32 v137, v137
    v_rcp_f32 v138, v138
    v_rcp_f32 v139, v139
    v_rcp_f32 v140, v140
    v_rcp_f32 v141, v141
    v_rcp_f32 v142, v142
    v_rcp_f32 v143, v143
    v_rcp_f32 v144, v144
    v_rcp_f32 v145, v145
    v_rcp_f32 v146, v146
    v_rcp_f32 v147, v147
    s_mul_i32 s42, s37, 28
    s_add_u32 s42, s42, s39
    s_lshl2_add_u32 s42, s42, s36
    s_mul_i32 s42, s42, 1792
    s_add_u32 s42, s42, 12582912
    v_mul_f32 v196, v196, v132
    v_mul_f32 v197, v197, v133
    v_mul_f32 v198, v198, v134
    v_mul_f32 v199, v199, v135
    v_mul_f32 v200, v200, v136
    v_mul_f32 v201, v201, v137
    v_mul_f32 v202, v202, v138
    v_mul_f32 v203, v203, v139
    v_mul_f32 v204, v204, v140
    v_mul_f32 v205, v205, v141
    v_mul_f32 v206, v206, v142
    v_mul_f32 v207, v207, v143
    v_mul_f32 v208, v208, v144
    v_mul_f32 v209, v209, v145
    v_mul_f32 v210, v210, v146
    v_mul_f32 v211, v211, v147
    v_cvt_pk_bf16_f32 v228, v196, v197
    v_cvt_pk_bf16_f32 v229, v198, v199
    v_cvt_pk_bf16_f32 v230, v200, v201
    v_cvt_pk_bf16_f32 v231, v202, v203
    v_cvt_pk_bf16_f32 v232, v204, v205
    v_cvt_pk_bf16_f32 v233, v206, v207
    v_cvt_pk_bf16_f32 v234, v208, v209
    v_cvt_pk_bf16_f32 v235, v210, v211
    buffer_store_dwordx4 v[228:231], v2, s[12:15], s42 offen sc1
    s_mov_b32 exec_lo, 0x00ffffff
    s_mov_b32 exec_hi, 0x00ffffff
    buffer_store_dwordx4 v[232:235], v11, s[12:15], s42 offen offset:1024 sc1
    s_mov_b64 exec, -1
sequential_preLN__sliding_block__mixer_token_mlp__prompt_kernel_j5:
    s_lshl2_add_u32 s42, s37, s36
    s_mul_i32 s42, s42, 50176
    s_add_u32 s42, s42, 12582912
    v_add_u32 v7, s42, v2
    v_min_u32 v22, 23, v4
    v_mad_u32_u24 v22, v3, 24, v22
    v_lshl_add_u32 v8, v22, 4, s42
    v_add_u32 v8, 1024, v8
    s_barrier
    s_waitcnt vmcnt(0)
    s_waitcnt vmcnt(0)
    s_mov_b32 s49, 0
    s_add_u32 s46, s93, 0
    s_sub_u32 s51, s46, 14
    s_min_u32 s46, s46, s51
    s_mul_i32 s46, s46, 3584
    buffer_load_dwordx4 v[132:135], v7, s[12:15], s46 offen offset:0 sc1
    buffer_load_dwordx4 v[136:139], v8, s[12:15], s46 offen offset:0 sc1
    buffer_load_dwordx4 v[140:143], v7, s[12:15], s46 offen offset:1792 sc1
    buffer_load_dwordx4 v[144:147], v8, s[12:15], s46 offen offset:1792 sc1
    s_add_u32 s46, s93, 1
    s_sub_u32 s51, s46, 14
    s_min_u32 s46, s46, s51
    s_mul_i32 s46, s46, 3584
    buffer_load_dwordx4 v[148:151], v7, s[12:15], s46 offen offset:0 sc1
    buffer_load_dwordx4 v[152:155], v8, s[12:15], s46 offen offset:0 sc1
    s_waitcnt vmcnt(4)
    v_max_u32 v22, v135, v139
    v_cmp_eq_u32 vcc, -1, v22
    s_cbranch_vccnz sequential_preLN__sliding_block__mixer_token_mlp__prompt_kernel_g2s0
sequential_preLN__sliding_block__mixer_token_mlp__prompt_kernel_g2r0:
    v_mfma_f32_32x32x16_bf16 v[68:83], v[132:135], a[0:3], 0
    buffer_load_dwordx4 v[156:159], v7, s[12:15], s46 offen offset:1792 sc1
    buffer_load_dwordx4 v[160:163], v8, s[12:15], s46 offen offset:1792 sc1
    v_mfma_f32_32x32x16_bf16 v[100:115], v[132:135], a[4:7], 0
    s_add_u32 s46, s93, 2
    s_sub_u32 s51, s46, 14
    s_min_u32 s46, s46, s51
    s_mul_i32 s46, s46, 3584
    buffer_load_dwordx4 v[164:167], v7, s[12:15], s46 offen offset:0 sc1
    buffer_load_dwordx4 v[168:171], v8, s[12:15], s46 offen offset:0 sc1
    v_mfma_f32_32x32x16_bf16 v[84:99], v[136:139], a[0:3], 0
    ds_read_b64_tr_b16 a[112:113], v5 offset:8192
    ds_read_b64_tr_b16 a[114:115], v5 offset:9216
    v_mfma_f32_32x32x16_bf16 v[116:131], v[136:139], a[4:7], 0
    ds_read_b64_tr_b16 a[116:117], v6 offset:8192
    ds_read_b64_tr_b16 a[118:119], v6 offset:9216
    s_waitcnt vmcnt(6)
    v_max_u32 v22, v143, v147
    v_cmp_eq_u32 vcc, -1, v22
    s_cbranch_vccnz sequential_preLN__sliding_block__mixer_token_mlp__prompt_kernel_g2s1
sequential_preLN__sliding_block__mixer_token_mlp__prompt_kernel_g2r1:
    v_mfma_f32_32x32x16_bf16 v[68:83], v[140:143], a[8:11], v[68:83]
    buffer_load_dwordx4 v[172:175], v7, s[12:15], s46 offen offset:1792 sc1
    buffer_load_dwordx4 v[176:179], v8, s[12:15], s46 offen offset:1792 sc1
    v_mfma_f32_32x32x16_bf16 v[100:115], v[140:143], a[12:15], v[100:115]
    s_add_u32 s46, s93, 3
    s_sub_u32 s51, s46, 14
    s_min_u32 s46, s46, s51
    s_mul_i32 s46, s46, 3584
    buffer_load_dwordx4 v[180:183], v7, s[12:15], s46 offen offset:0 sc1
    buffer_load_dwordx4 v[184:187], v8, s[12:15], s46 offen offset:0 sc1
    v_mfma_f32_32x32x16_bf16 v[84:99], v[144:147], a[8:11], v[84:99]
    ds_read_b64_tr_b16 a[120:121], v5 offset:10240
    ds_read_b64_tr_b16 a[122:123], v5 offset:11264
    v_mfma_f32_32x32x16_bf16 v[116:131], v[144:147], a[12:15], v[116:131]
    ds_read_b64_tr_b16 a[124:125], v6 offset:10240
    ds_read_b64_tr_b16 a[126:127], v6 offset:11264
    s_waitcnt vmcnt(8)
    v_max_u32 v22, v151, v155
    v_cmp_eq_u32 vcc, -1, v22
    s_cbranch_vccnz sequential_preLN__sliding_block__mixer_token_mlp__prompt_kernel_g2s2
sequential_preLN__sliding_block__mixer_token_mlp__prompt_kernel_g2r2:
    v_mfma_f32_32x32x16_bf16 v[68:83], v[148:151], a[16:19], v[68:83]
    buffer_load_dwordx4 v[188:191], v7, s[12:15], s46 offen offset:1792 sc1
    buffer_load_dwordx4 v[192:195], v8, s[12:15], s46 offen offset:1792 sc1
    v_mfma_f32_32x32x16_bf16 v[100:115], v[148:151], a[20:23], v[100:115]
    s_add_u32 s46, s93, 4
    s_sub_u32 s51, s46, 14
    s_min_u32 s46, s46, s51
    s_mul_i32 s46, s46, 3584
    buffer_load_dwordx4 v[196:199], v7, s[12:15], s46 offen offset:0 sc1
    buffer_load_dwordx4 v[200:203], v8, s[12:15], s46 offen offset:0 sc1
    v_mfma_f32_32x32x16_bf16 v[84:99], v[152:155], a[16:19], v[84:99]
    ds_read_b64_tr_b16 a[128:129], v5 offset:0
    ds_read_b64_tr_b16 a[130:131], v5 offset:1024
    v_mfma_f32_32x32x16_bf16 v[116:131], v[152:155], a[20:23], v[116:131]
    ds_read_b64_tr_b16 a[132:133], v6 offset:0
    ds_read_b64_tr_b16 a[134:135], v6 offset:1024
    s_waitcnt vmcnt(10)
    v_max_u32 v22, v159, v163
    v_cmp_eq_u32 vcc, -1, v22
    s_cbranch_vccnz sequential_preLN__sliding_block__mixer_token_mlp__prompt_kernel_g2s3
sequential_preLN__sliding_block__mixer_token_mlp__prompt_kernel_g2r3:
    v_mfma_f32_32x32x16_bf16 v[68:83], v[156:159], a[24:27], v[68:83]
    buffer_load_dwordx4 v[204:207], v7, s[12:15], s46 offen offset:1792 sc1
    buffer_load_dwordx4 v[208:211], v8, s[12:15], s46 offen offset:1792 sc1
    v_mfma_f32_32x32x16_bf16 v[100:115], v[156:159], a[28:31], v[100:115]
    s_add_u32 s46, s93, 5
    s_sub_u32 s51, s46, 14
    s_min_u32 s46, s46, s51
    s_mul_i32 s46, s46, 3584
    buffer_load_dwordx4 v[212:215], v7, s[12:15], s46 offen offset:0 sc1
    buffer_load_dwordx4 v[216:219], v8, s[12:15], s46 offen offset:0 sc1
    v_mfma_f32_32x32x16_bf16 v[84:99], v[160:163], a[24:27], v[84:99]
    ds_read_b64_tr_b16 a[136:137], v5 offset:2048
    ds_read_b64_tr_b16 a[138:139], v5 offset:3072
    v_mfma_f32_32x32x16_bf16 v[116:131], v[160:163], a[28:31], v[116:131]
    ds_read_b64_tr_b16 a[140:141], v6 offset:2048
    ds_read_b64_tr_b16 a[142:143], v6 offset:3072
    s_waitcnt vmcnt(12)
    v_max_u32 v22, v167, v171
    v_cmp_eq_u32 vcc, -1, v22
    s_cbranch_vccnz sequential_preLN__sliding_block__mixer_token_mlp__prompt_kernel_g2s4
sequential_preLN__sliding_block__mixer_token_mlp__prompt_kernel_g2r4:
    v_mfma_f32_32x32x16_bf16 v[68:83], v[164:167], a[32:35], v[68:83]
    buffer_load_dwordx4 v[220:223], v7, s[12:15], s46 offen offset:1792 sc1
    buffer_load_dwordx4 v[224:227], v8, s[12:15], s46 offen offset:1792 sc1
    v_mfma_f32_32x32x16_bf16 v[100:115], v[164:167], a[36:39], v[100:115]
    s_add_u32 s46, s93, 6
    s_sub_u32 s51, s46, 14
    s_min_u32 s46, s46, s51
    s_mul_i32 s46, s46, 3584
    buffer_load_dwordx4 v[132:135], v7, s[12:15], s46 offen offset:0 sc1
    buffer_load_dwordx4 v[136:139], v8, s[12:15], s46 offen offset:0 sc1
    v_mfma_f32_32x32x16_bf16 v[84:99], v[168:171], a[32:35], v[84:99]
    ds_read_b64_tr_b16 a[144:145], v5 offset:4096
    ds_read_b64_tr_b16 a[146:147], v5 offset:5120
    v_mfma_f32_32x32x16_bf16 v[116:131], v[168:171], a[36:39], v[116:131]
    ds_read_b64_tr_b16 a[148:149], v6 offset:4096
    ds_read_b64_tr_b16 a[150:151], v6 offset:5120
    s_waitcnt vmcnt(14)
    v_max_u32 v22, v175, v179
    v_cmp_eq_u32 vcc, -1, v22
    s_cbranch_vccnz sequential_preLN__sliding_block__mixer_token_mlp__prompt_kernel_g2s5
sequential_preLN__sliding_block__mixer_token_mlp__prompt_kernel_g2r5:
    v_mfma_f32_32x32x16_bf16 v[68:83], v[172:175], a[40:43], v[68:83]
    buffer_load_dwordx4 v[140:143], v7, s[12:15], s46 offen offset:1792 sc1
    buffer_load_dwordx4 v[144:147], v8, s[12:15], s46 offen offset:1792 sc1
    v_mfma_f32_32x32x16_bf16 v[100:115], v[172:175], a[44:47], v[100:115]
    s_add_u32 s46, s93, 7
    s_sub_u32 s51, s46, 14
    s_min_u32 s46, s46, s51
    s_mul_i32 s46, s46, 3584
    buffer_load_dwordx4 v[148:151], v7, s[12:15], s46 offen offset:0 sc1
    buffer_load_dwordx4 v[152:155], v8, s[12:15], s46 offen offset:0 sc1
    v_mfma_f32_32x32x16_bf16 v[84:99], v[176:179], a[40:43], v[84:99]
    ds_read_b64_tr_b16 a[152:153], v5 offset:6144
    ds_read_b64_tr_b16 a[154:155], v5 offset:7168
    v_mfma_f32_32x32x16_bf16 v[116:131], v[176:179], a[44:47], v[116:131]
    ds_read_b64_tr_b16 a[156:157], v6 offset:6144
    ds_read_b64_tr_b16 a[158:159], v6 offset:7168
    s_waitcnt vmcnt(16)
    v_max_u32 v22, v183, v187
    v_cmp_eq_u32 vcc, -1, v22
    s_cbranch_vccnz sequential_preLN__sliding_block__mixer_token_mlp__prompt_kernel_g2s6
sequential_preLN__sliding_block__mixer_token_mlp__prompt_kernel_g2r6:
    v_mfma_f32_32x32x16_bf16 v[68:83], v[180:183], a[48:51], v[68:83]
    buffer_load_dwordx4 v[156:159], v7, s[12:15], s46 offen offset:1792 sc1
    buffer_load_dwordx4 v[160:163], v8, s[12:15], s46 offen offset:1792 sc1
    v_mfma_f32_32x32x16_bf16 v[100:115], v[180:183], a[52:55], v[100:115]
    s_add_u32 s46, s93, 8
    s_sub_u32 s51, s46, 14
    s_min_u32 s46, s46, s51
    s_mul_i32 s46, s46, 3584
    buffer_load_dwordx4 v[164:167], v7, s[12:15], s46 offen offset:0 sc1
    buffer_load_dwordx4 v[168:171], v8, s[12:15], s46 offen offset:0 sc1
    v_mfma_f32_32x32x16_bf16 v[84:99], v[184:187], a[48:51], v[84:99]
    ds_read_b64_tr_b16 a[160:161], v5 offset:12288
    ds_read_b64_tr_b16 a[162:163], v5 offset:13312
    v_mfma_f32_32x32x16_bf16 v[116:131], v[184:187], a[52:55], v[116:131]
    ds_read_b64_tr_b16 a[164:165], v6 offset:12288
    ds_read_b64_tr_b16 a[166:167], v6 offset:13312
    s_waitcnt vmcnt(18)
    v_max_u32 v22, v191, v195
    v_cmp_eq_u32 vcc, -1, v22
    s_cbranch_vccnz sequential_preLN__sliding_block__mixer_token_mlp__prompt_kernel_g2s7
sequential_preLN__sliding_block__mixer_token_mlp__prompt_kernel_g2r7:
    v_mfma_f32_32x32x16_bf16 v[68:83], v[188:191], a[56:59], v[68:83]
    buffer_load_dwordx4 v[172:175], v7, s[12:15], s46 offen offset:1792 sc1
    buffer_load_dwordx4 v[176:179], v8, s[12:15], s46 offen offset:1792 sc1
    v_mfma_f32_32x32x16_bf16 v[100:115], v[188:191], a[60:63], v[100:115]
    s_add_u32 s46, s93, 9
    s_sub_u32 s51, s46, 14
    s_min_u32 s46, s46, s51
    s_mul_i32 s46, s46, 3584
    buffer_load_dwordx4 v[180:183], v7, s[12:15], s46 offen offset:0 sc1
    buffer_load_dwordx4 v[184:187], v8, s[12:15], s46 offen offset:0 sc1
    v_mfma_f32_32x32x16_bf16 v[84:99], v[192:195], a[56:59], v[84:99]
    ds_read_b64_tr_b16 a[168:169], v5 offset:14336
    ds_read_b64_tr_b16 a[170:171], v5 offset:15360
    v_mfma_f32_32x32x16_bf16 v[116:131], v[192:195], a[60:63], v[116:131]
    ds_read_b64_tr_b16 a[172:173], v6 offset:14336
    ds_read_b64_tr_b16 a[174:175], v6 offset:15360
    s_waitcnt vmcnt(20)
    v_max_u32 v22, v199, v203
    v_cmp_eq_u32 vcc, -1, v22
    s_cbranch_vccnz sequential_preLN__sliding_block__mixer_token_mlp__prompt_kernel_g2s8
sequential_preLN__sliding_block__mixer_token_mlp__prompt_kernel_g2r8:
    v_mfma_f32_32x32x16_bf16 v[68:83], v[196:199], a[64:67], v[68:83]
    buffer_load_dwordx4 v[188:191], v7, s[12:15], s46 offen offset:1792 sc1
    buffer_load_dwordx4 v[192:195], v8, s[12:15], s46 offen offset:1792 sc1
    v_mfma_f32_32x32x16_bf16 v[100:115], v[196:199], a[68:71], v[100:115]
    ds_read_b64_tr_b16 a[176:177], v5 offset:16384
    ds_read_b64_tr_b16 a[178:179], v5 offset:17408
    v_mfma_f32_32x32x16_bf16 v[84:99], v[200:203], a[64:67], v[84:99]
    ds_read_b64_tr_b16 a[180:181], v6 offset:16384
    ds_read_b64_tr_b16 a[182:183], v6 offset:17408
    v_mfma_f32_32x32x16_bf16 v[116:131], v[200:203], a[68:71], v[116:131]
    s_waitcnt vmcnt(20)
    v_max_u32 v22, v207, v211
    v_cmp_eq_u32 vcc, -1, v22
    s_cbranch_vccnz sequential_preLN__sliding_block__mixer_token_mlp__prompt_kernel_g2s9
sequential_preLN__sliding_block__mixer_token_mlp__prompt_kernel_g2r9:
    v_mfma_f32_32x32x16_bf16 v[68:83], v[204:207], a[72:75], v[68:83]
    s_add_u32 s46, s93, 10
    s_sub_u32 s51, s46, 14
    s_min_u32 s46, s46, s51
    s_mul_i32 s46, s46, 3584
    buffer_load_dwordx4 v[196:199], v7, s[12:15], s46 offen offset:0 sc1
    buffer_load_dwordx4 v[200:203], v8, s[12:15], s46 offen offset:0 sc1
    v_mfma_f32_32x32x16_bf16 v[100:115], v[204:207], a[76:79], v[100:115]
    ds_read_b64_tr_b16 a[184:185], v5 offset:18432
    ds_read_b64_tr_b16 a[186:187], v5 offset:19456
    v_mfma_f32_32x32x16_bf16 v[84:99], v[208:211], a[72:75], v[84:99]
    ds_read_b64_tr_b16 a[188:189], v6 offset:18432
    ds_read_b64_tr_b16 a[190:191], v6 offset:19456
    v_mfma_f32_32x32x16_bf16 v[116:131], v[208:211], a[76:79], v[116:131]
    s_waitcnt vmcnt(20)
    v_max_u32 v22, v215, v219
    v_cmp_eq_u32 vcc, -1, v22
    s_cbranch_vccnz sequential_preLN__sliding_block__mixer_token_mlp__prompt_kernel_g2s10
sequential_preLN__sliding_block__mixer_token_mlp__prompt_kernel_g2r10:
    v_mfma_f32_32x32x16_bf16 v[68:83], v[212:215], a[80:83], v[68:83]
    buffer_load_dwordx4 v[204:207], v7, s[12:15], s46 offen offset:1792 sc1
    buffer_load_dwordx4 v[208:211], v8, s[12:15], s46 offen offset:1792 sc1
    v_mfma_f32_32x32x16_bf16 v[100:115], v[212:215], a[84:87], v[100:115]
    ds_read_b64_tr_b16 a[192:193], v5 offset:20480
    ds_read_b64_tr_b16 a[194:195], v5 offset:21504
    v_mfma_f32_32x32x16_bf16 v[84:99], v[216:219], a[80:83], v[84:99]
    ds_read_b64_tr_b16 a[196:197], v6 offset:20480
    ds_read_b64_tr_b16 a[198:199], v6 offset:21504
    v_mfma_f32_32x32x16_bf16 v[116:131], v[216:219], a[84:87], v[116:131]
    s_waitcnt vmcnt(20)
    v_max_u32 v22, v223, v227
    v_cmp_eq_u32 vcc, -1, v22
    s_cbranch_vccnz sequential_preLN__sliding_block__mixer_token_mlp__prompt_kernel_g2s11
sequential_preLN__sliding_block__mixer_token_mlp__prompt_kernel_g2r11:
    v_mfma_f32_32x32x16_bf16 v[68:83], v[220:223], a[88:91], v[68:83]
    s_add_u32 s46, s93, 11
    s_sub_u32 s51, s46, 14
    s_min_u32 s46, s46, s51
    s_mul_i32 s46, s46, 3584
    buffer_load_dwordx4 v[212:215], v7, s[12:15], s46 offen offset:0 sc1
    buffer_load_dwordx4 v[216:219], v8, s[12:15], s46 offen offset:0 sc1
    v_mfma_f32_32x32x16_bf16 v[100:115], v[220:223], a[92:95], v[100:115]
    ds_read_b64_tr_b16 a[200:201], v5 offset:22528
    ds_read_b64_tr_b16 a[202:203], v5 offset:23552
    v_mfma_f32_32x32x16_bf16 v[84:99], v[224:227], a[88:91], v[84:99]
    ds_read_b64_tr_b16 a[204:205], v6 offset:22528
    ds_read_b64_tr_b16 a[206:207], v6 offset:23552
    v_mfma_f32_32x32x16_bf16 v[116:131], v[224:227], a[92:95], v[116:131]
    s_waitcnt vmcnt(20)
    v_max_u32 v22, v135, v139
    v_cmp_eq_u32 vcc, -1, v22
    s_cbranch_vccnz sequential_preLN__sliding_block__mixer_token_mlp__prompt_kernel_g2s12
sequential_preLN__sliding_block__mixer_token_mlp__prompt_kernel_g2r12:
    v_mfma_f32_32x32x16_bf16 v[68:83], v[132:135], a[96:99], v[68:83]
    buffer_load_dwordx4 v[220:223], v7, s[12:15], s46 offen offset:1792 sc1
    buffer_load_dwordx4 v[224:227], v8, s[12:15], s46 offen offset:1792 sc1
    v_mfma_f32_32x32x16_bf16 v[100:115], v[132:135], a[100:103], v[100:115]
    ds_read_b64_tr_b16 a[208:209], v5 offset:24576
    ds_read_b64_tr_b16 a[210:211], v5 offset:25600
    v_mfma_f32_32x32x16_bf16 v[84:99], v[136:139], a[96:99], v[84:99]
    ds_read_b64_tr_b16 a[212:213], v6 offset:24576
    ds_read_b64_tr_b16 a[214:215], v6 offset:25600
    v_mfma_f32_32x32x16_bf16 v[116:131], v[136:139], a[100:103], v[116:131]
    s_waitcnt vmcnt(20)
    v_max_u32 v22, v143, v147
    v_cmp_eq_u32 vcc, -1, v22
    s_cbranch_vccnz sequential_preLN__sliding_block__mixer_token_mlp__prompt_kernel_g2s13
sequential_preLN__sliding_block__mixer_token_mlp__prompt_kernel_g2r13:
    v_mfma_f32_32x32x16_bf16 v[68:83], v[140:143], a[104:107], v[68:83]
    s_add_u32 s46, s93, 12
    s_sub_u32 s51, s46, 14
    s_min_u32 s46, s46, s51
    s_mul_i32 s46, s46, 3584
    buffer_load_dwordx4 v[132:135], v7, s[12:15], s46 offen offset:0 sc1
    buffer_load_dwordx4 v[136:139], v8, s[12:15], s46 offen offset:0 sc1
    v_mfma_f32_32x32x16_bf16 v[100:115], v[140:143], a[108:111], v[100:115]
    ds_read_b64_tr_b16 a[216:217], v5 offset:26624
    ds_read_b64_tr_b16 a[218:219], v5 offset:27648
    v_mfma_f32_32x32x16_bf16 v[84:99], v[144:147], a[104:107], v[84:99]
    ds_read_b64_tr_b16 a[220:221], v6 offset:26624
    ds_read_b64_tr_b16 a[222:223], v6 offset:27648
    v_mfma_f32_32x32x16_bf16 v[116:131], v[144:147], a[108:111], v[116:131]
    s_waitcnt lgkmcnt(0)
    s_waitcnt vmcnt(20)
    v_max_u32 v22, v151, v155
    v_cmp_eq_u32 vcc, -1, v22
    s_cbranch_vccnz sequential_preLN__sliding_block__mixer_token_mlp__prompt_kernel_g2s14
sequential_preLN__sliding_block__mixer_token_mlp__prompt_kernel_g2r14:
    v_mfma_f32_32x32x16_bf16 v[68:83], v[148:151], a[112:115], v[68:83]
    buffer_load_dwordx4 v[140:143], v7, s[12:15], s46 offen offset:1792 sc1
    v_mfma_f32_32x32x16_bf16 v[100:115], v[148:151], a[116:119], v[100:115]
    buffer_load_dwordx4 v[144:147], v8, s[12:15], s46 offen offset:1792 sc1
    v_mfma_f32_32x32x16_bf16 v[84:99], v[152:155], a[112:115], v[84:99]
    v_mfma_f32_32x32x16_bf16 v[116:131], v[152:155], a[116:119], v[116:131]
    s_waitcnt vmcnt(20)
    v_max_u32 v22, v159, v163
    v_cmp_eq_u32 vcc, -1, v22
    s_cbranch_vccnz sequential_preLN__sliding_block__mixer_token_mlp__prompt_kernel_g2s15
sequential_preLN__sliding_block__mixer_token_mlp__prompt_kernel_g2r15:
    v_mfma_f32_32x32x16_bf16 v[68:83], v[156:159], a[120:123], v[68:83]
    s_add_u32 s46, s93, 13
    s_sub_u32 s51, s46, 14
    s_min_u32 s46, s46, s51
    s_mul_i32 s46, s46, 3584
    buffer_load_dwordx4 v[148:151], v7, s[12:15], s46 offen offset:0 sc1
    v_mfma_f32_32x32x16_bf16 v[100:115], v[156:159], a[124:127], v[100:115]
    buffer_load_dwordx4 v[152:155], v8, s[12:15], s46 offen offset:0 sc1
    v_mfma_f32_32x32x16_bf16 v[84:99], v[160:163], a[120:123], v[84:99]
    v_mfma_f32_32x32x16_bf16 v[116:131], v[160:163], a[124:127], v[116:131]
    s_waitcnt vmcnt(20)
    v_max_u32 v22, v167, v171
    v_cmp_eq_u32 vcc, -1, v22
    s_cbranch_vccnz sequential_preLN__sliding_block__mixer_token_mlp__prompt_kernel_g2s16
sequential_preLN__sliding_block__mixer_token_mlp__prompt_kernel_g2r16:
    v_mfma_f32_32x32x16_bf16 v[68:83], v[164:167], a[128:131], v[68:83]
    buffer_load_dwordx4 v[156:159], v7, s[12:15], s46 offen offset:1792 sc1
    v_mfma_f32_32x32x16_bf16 v[100:115], v[164:167], a[132:135], v[100:115]
    buffer_load_dwordx4 v[160:163], v8, s[12:15], s46 offen offset:1792 sc1
    v_mfma_f32_32x32x16_bf16 v[84:99], v[168:171], a[128:131], v[84:99]
    v_mfma_f32_32x32x16_bf16 v[116:131], v[168:171], a[132:135], v[116:131]
    s_waitcnt vmcnt(20)
    v_max_u32 v22, v175, v179
    v_cmp_eq_u32 vcc, -1, v22
    s_cbranch_vccnz sequential_preLN__sliding_block__mixer_token_mlp__prompt_kernel_g2s17
sequential_preLN__sliding_block__mixer_token_mlp__prompt_kernel_g2r17:
    v_mfma_f32_32x32x16_bf16 v[68:83], v[172:175], a[136:139], v[68:83]
    v_mfma_f32_32x32x16_bf16 v[100:115], v[172:175], a[140:143], v[100:115]
    v_mfma_f32_32x32x16_bf16 v[84:99], v[176:179], a[136:139], v[84:99]
    v_mfma_f32_32x32x16_bf16 v[116:131], v[176:179], a[140:143], v[116:131]
    s_waitcnt vmcnt(18)
    v_max_u32 v22, v183, v187
    v_cmp_eq_u32 vcc, -1, v22
    s_cbranch_vccnz sequential_preLN__sliding_block__mixer_token_mlp__prompt_kernel_g2s18
sequential_preLN__sliding_block__mixer_token_mlp__prompt_kernel_g2r18:
    v_mfma_f32_32x32x16_bf16 v[68:83], v[180:183], a[144:147], v[68:83]
    v_mfma_f32_32x32x16_bf16 v[100:115], v[180:183], a[148:151], v[100:115]
    v_mfma_f32_32x32x16_bf16 v[84:99], v[184:187], a[144:147], v[84:99]
    v_mfma_f32_32x32x16_bf16 v[116:131], v[184:187], a[148:151], v[116:131]
    s_waitcnt vmcnt(16)
    v_max_u32 v22, v191, v195
    v_cmp_eq_u32 vcc, -1, v22
    s_cbranch_vccnz sequential_preLN__sliding_block__mixer_token_mlp__prompt_kernel_g2s19
sequential_preLN__sliding_block__mixer_token_mlp__prompt_kernel_g2r19:
    v_mfma_f32_32x32x16_bf16 v[68:83], v[188:191], a[152:155], v[68:83]
    v_mfma_f32_32x32x16_bf16 v[100:115], v[188:191], a[156:159], v[100:115]
    v_mfma_f32_32x32x16_bf16 v[84:99], v[192:195], a[152:155], v[84:99]
    v_mfma_f32_32x32x16_bf16 v[116:131], v[192:195], a[156:159], v[116:131]
    s_waitcnt vmcnt(14)
    v_max_u32 v22, v199, v203
    v_cmp_eq_u32 vcc, -1, v22
    s_cbranch_vccnz sequential_preLN__sliding_block__mixer_token_mlp__prompt_kernel_g2s20
sequential_preLN__sliding_block__mixer_token_mlp__prompt_kernel_g2r20:
    v_mfma_f32_32x32x16_bf16 v[68:83], v[196:199], a[160:163], v[68:83]
    v_mfma_f32_32x32x16_bf16 v[100:115], v[196:199], a[164:167], v[100:115]
    v_mfma_f32_32x32x16_bf16 v[84:99], v[200:203], a[160:163], v[84:99]
    v_mfma_f32_32x32x16_bf16 v[116:131], v[200:203], a[164:167], v[116:131]
    s_waitcnt vmcnt(12)
    v_max_u32 v22, v207, v211
    v_cmp_eq_u32 vcc, -1, v22
    s_cbranch_vccnz sequential_preLN__sliding_block__mixer_token_mlp__prompt_kernel_g2s21
sequential_preLN__sliding_block__mixer_token_mlp__prompt_kernel_g2r21:
    v_mfma_f32_32x32x16_bf16 v[68:83], v[204:207], a[168:171], v[68:83]
    v_mfma_f32_32x32x16_bf16 v[100:115], v[204:207], a[172:175], v[100:115]
    v_mfma_f32_32x32x16_bf16 v[84:99], v[208:211], a[168:171], v[84:99]
    v_mfma_f32_32x32x16_bf16 v[116:131], v[208:211], a[172:175], v[116:131]
    s_waitcnt vmcnt(10)
    v_max_u32 v22, v215, v219
    v_cmp_eq_u32 vcc, -1, v22
    s_cbranch_vccnz sequential_preLN__sliding_block__mixer_token_mlp__prompt_kernel_g2s22
sequential_preLN__sliding_block__mixer_token_mlp__prompt_kernel_g2r22:
    v_mfma_f32_32x32x16_bf16 v[68:83], v[212:215], a[176:179], v[68:83]
    v_mfma_f32_32x32x16_bf16 v[100:115], v[212:215], a[180:183], v[100:115]
    v_mfma_f32_32x32x16_bf16 v[84:99], v[216:219], a[176:179], v[84:99]
    v_mfma_f32_32x32x16_bf16 v[116:131], v[216:219], a[180:183], v[116:131]
    s_waitcnt vmcnt(8)
    v_max_u32 v22, v223, v227
    v_cmp_eq_u32 vcc, -1, v22
    s_cbranch_vccnz sequential_preLN__sliding_block__mixer_token_mlp__prompt_kernel_g2s23
sequential_preLN__sliding_block__mixer_token_mlp__prompt_kernel_g2r23:
    v_mfma_f32_32x32x16_bf16 v[68:83], v[220:223], a[184:187], v[68:83]
    v_mfma_f32_32x32x16_bf16 v[100:115], v[220:223], a[188:191], v[100:115]
    v_mfma_f32_32x32x16_bf16 v[84:99], v[224:227], a[184:187], v[84:99]
    v_mfma_f32_32x32x16_bf16 v[116:131], v[224:227], a[188:191], v[116:131]
    s_waitcnt vmcnt(6)
    v_max_u32 v22, v135, v139
    v_cmp_eq_u32 vcc, -1, v22
    s_cbranch_vccnz sequential_preLN__sliding_block__mixer_token_mlp__prompt_kernel_g2s24
sequential_preLN__sliding_block__mixer_token_mlp__prompt_kernel_g2r24:
    v_mfma_f32_32x32x16_bf16 v[68:83], v[132:135], a[192:195], v[68:83]
    v_mfma_f32_32x32x16_bf16 v[100:115], v[132:135], a[196:199], v[100:115]
    v_mfma_f32_32x32x16_bf16 v[84:99], v[136:139], a[192:195], v[84:99]
    v_mfma_f32_32x32x16_bf16 v[116:131], v[136:139], a[196:199], v[116:131]
    s_waitcnt vmcnt(4)
    v_max_u32 v22, v143, v147
    v_cmp_eq_u32 vcc, -1, v22
    s_cbranch_vccnz sequential_preLN__sliding_block__mixer_token_mlp__prompt_kernel_g2s25
sequential_preLN__sliding_block__mixer_token_mlp__prompt_kernel_g2r25:
    v_mfma_f32_32x32x16_bf16 v[68:83], v[140:143], a[200:203], v[68:83]
    v_mfma_f32_32x32x16_bf16 v[100:115], v[140:143], a[204:207], v[100:115]
    v_mfma_f32_32x32x16_bf16 v[84:99], v[144:147], a[200:203], v[84:99]
    v_mfma_f32_32x32x16_bf16 v[116:131], v[144:147], a[204:207], v[116:131]
    s_waitcnt vmcnt(2)
    v_max_u32 v22, v151, v155
    v_cmp_eq_u32 vcc, -1, v22
    s_cbranch_vccnz sequential_preLN__sliding_block__mixer_token_mlp__prompt_kernel_g2s26
sequential_preLN__sliding_block__mixer_token_mlp__prompt_kernel_g2r26:
    v_mfma_f32_32x32x16_bf16 v[68:83], v[148:151], a[208:211], v[68:83]
    v_mfma_f32_32x32x16_bf16 v[100:115], v[148:151], a[212:215], v[100:115]
    v_mfma_f32_32x32x16_bf16 v[84:99], v[152:155], a[208:211], v[84:99]
    v_mfma_f32_32x32x16_bf16 v[116:131], v[152:155], a[212:215], v[116:131]
    s_waitcnt vmcnt(0)
    v_max_u32 v22, v159, v163
    v_cmp_eq_u32 vcc, -1, v22
    s_cbranch_vccnz sequential_preLN__sliding_block__mixer_token_mlp__prompt_kernel_g2s27
sequential_preLN__sliding_block__mixer_token_mlp__prompt_kernel_g2r27:
    v_mfma_f32_32x32x16_bf16 v[68:83], v[156:159], a[216:219], v[68:83]
    v_mfma_f32_32x32x16_bf16 v[100:115], v[156:159], a[220:223], v[100:115]
    v_mfma_f32_32x32x16_bf16 v[84:99], v[160:163], a[216:219], v[84:99]
    v_mfma_f32_32x32x16_bf16 v[116:131], v[160:163], a[220:223], v[116:131]
    s_cmp_eq_u32 s36, 1
    s_cbranch_scc1 sequential_preLN__sliding_block__mixer_token_mlp__prompt_kernel_e51
    s_cmp_eq_u32 s36, 2
    s_cbranch_scc1 sequential_preLN__sliding_block__mixer_token_mlp__prompt_kernel_e52
    s_cmp_eq_u32 s36, 3
    s_cbranch_scc1 sequential_preLN__sliding_block__mixer_token_mlp__prompt_kernel_e53
sequential_preLN__sliding_block__mixer_token_mlp__prompt_kernel_e50:
    s_nop 7
    ds_write_b128 v2, v[84:87] offset:20480
    ds_write_b128 v2, v[88:91] offset:21504
    ds_write_b128 v2, v[92:95] offset:22528
    ds_write_b128 v2, v[100:103] offset:28672
    ds_write_b128 v2, v[104:107] offset:29696
    ds_write_b128 v2, v[108:111] offset:30720
    ds_write_b128 v2, v[112:115] offset:31744
    ds_write_b128 v2, v[116:119] offset:36864
    ds_write_b128 v2, v[120:123] offset:37888
    ds_write_b128 v2, v[124:127] offset:38912
    v_lshlrev_b32 v13, 16, v13
    v_add_f32 v44, v44, v13
    v_add_f32 v45, v45, v13
    v_add_f32 v46, v46, v13
    v_add_f32 v47, v47, v13
    v_add_f32 v48, v48, v13
    v_add_f32 v49, v49, v13
    v_add_f32 v50, v50, v13
    v_add_f32 v51, v51, v13
    v_add_f32 v52, v52, v13
    v_add_f32 v53, v53, v13
    v_add_f32 v54, v54, v13
    v_add_f32 v55, v55, v13
    v_add_f32 v56, v56, v13
    v_add_f32 v57, v57, v13
    v_add_f32 v58, v58, v13
    v_add_f32 v59, v59, v13
    v_add_f32 v68, v68, v44
    v_add_f32 v69, v69, v45
    v_add_f32 v70, v70, v46
    v_add_f32 v71, v71, v47
    v_add_f32 v72, v72, v48
    v_add_f32 v73, v73, v49
    v_add_f32 v74, v74, v50
    v_add_f32 v75, v75, v51
    v_add_f32 v76, v76, v52
    v_add_f32 v77, v77, v53
    v_add_f32 v78, v78, v54
    v_add_f32 v79, v79, v55
    v_add_f32 v80, v80, v56
    v_add_f32 v81, v81, v57
    v_add_f32 v82, v82, v58
    v_add_f32 v83, v83, v59
    s_waitcnt lgkmcnt(0)
    s_barrier
    ds_read_b128 v[132:135], v2 offset:0
    ds_read_b128 v[136:139], v2 offset:1024
    ds_read_b128 v[140:143], v2 offset:2048
    ds_read_b128 v[144:147], v2 offset:3072
    ds_read_b128 v[148:151], v2 offset:4096
    ds_read_b128 v[152:155], v2 offset:5120
    ds_read_b128 v[156:159], v2 offset:6144
    ds_read_b128 v[160:163], v2 offset:7168
    ds_read_b128 v[164:167], v2 offset:8192
    ds_read_b128 v[168:171], v2 offset:9216
    ds_read_b128 v[172:175], v2 offset:10240
    ds_read_b128 v[176:179], v2 offset:11264
    s_waitcnt lgkmcnt(8)
    v_add_f32 v68, v68, v132
    v_add_f32 v69, v69, v133
    v_add_f32 v70, v70, v134
    v_add_f32 v71, v71, v135
    v_add_f32 v72, v72, v136
    v_add_f32 v73, v73, v137
    v_add_f32 v74, v74, v138
    v_add_f32 v75, v75, v139
    v_add_f32 v76, v76, v140
    v_add_f32 v77, v77, v141
    v_add_f32 v78, v78, v142
    v_add_f32 v79, v79, v143
    v_add_f32 v80, v80, v144
    v_add_f32 v81, v81, v145
    v_add_f32 v82, v82, v146
    v_add_f32 v83, v83, v147
    s_waitcnt lgkmcnt(4)
    v_add_f32 v68, v68, v148
    v_add_f32 v69, v69, v149
    v_add_f32 v70, v70, v150
    v_add_f32 v71, v71, v151
    v_add_f32 v72, v72, v152
    v_add_f32 v73, v73, v153
    v_add_f32 v74, v74, v154
    v_add_f32 v75, v75, v155
    v_add_f32 v76, v76, v156
    v_add_f32 v77, v77, v157
    v_add_f32 v78, v78, v158
    v_add_f32 v79, v79, v159
    v_add_f32 v80, v80, v160
    v_add_f32 v81, v81, v161
    v_add_f32 v82, v82, v162
    v_add_f32 v83, v83, v163
    s_waitcnt lgkmcnt(0)
    v_add_f32 v44, v68, v164
    v_add_f32 v45, v69, v165
    v_add_f32 v46, v70, v166
    v_add_f32 v47, v71, v167
    v_add_f32 v48, v72, v168
    v_add_f32 v49, v73, v169
    v_add_f32 v50, v74, v170
    v_add_f32 v51, v75, v171
    v_add_f32 v52, v76, v172
    v_add_f32 v53, v77, v173
    v_add_f32 v54, v78, v174
    v_add_f32 v55, v79, v175
    v_add_f32 v56, v80, v176
    v_add_f32 v57, v81, v177
    v_add_f32 v58, v82, v178
    v_add_f32 v59, v83, v179
    v_cvt_pk_bf16_f32 v228, v44, v45
    v_cvt_pk_bf16_f32 v229, v46, v47
    v_cvt_pk_bf16_f32 v230, v48, v49
    v_cvt_pk_bf16_f32 v231, v50, v51
    v_cvt_pk_bf16_f32 v232, v52, v53
    v_cvt_pk_bf16_f32 v233, v54, v55
    v_cvt_pk_bf16_f32 v234, v56, v57
    v_cvt_pk_bf16_f32 v235, v58, v59
    s_nop 1
    v_permlane32_swap_b32 v228, v230
    v_permlane32_swap_b32 v229, v231
    v_permlane32_swap_b32 v232, v234
    v_permlane32_swap_b32 v233, v235
    buffer_store_dwordx4 v[228:231], v12, s[28:31], 0 offen
    buffer_store_dwordx4 v[232:235], v12, s[28:31], 0 offen offset:32
    s_endpgm
sequential_preLN__sliding_block__mixer_token_mlp__prompt_kernel_e51:
    s_nop 7
    ds_write_b128 v2, v[100:103] offset:32768
    ds_write_b128 v2, v[104:107] offset:33792
    ds_write_b128 v2, v[108:111] offset:34816
    ds_write_b128 v2, v[112:115] offset:35840
    ds_write_b128 v2, v[116:119] offset:40960
    ds_write_b128 v2, v[120:123] offset:41984
    ds_write_b128 v2, v[124:127] offset:43008
    ds_write_b128 v2, v[68:71] offset:0
    ds_write_b128 v2, v[72:75] offset:1024
    ds_write_b128 v2, v[76:79] offset:2048
    ds_write_b128 v2, v[80:83] offset:3072
    v_lshlrev_b32 v13, 16, v13
    v_add_f32 v44, v44, v13
    v_add_f32 v45, v45, v13
    v_add_f32 v46, v46, v13
    v_add_f32 v47, v47, v13
    v_add_f32 v48, v48, v13
    v_add_f32 v49, v49, v13
    v_add_f32 v50, v50, v13
    v_add_f32 v51, v51, v13
    v_add_f32 v52, v52, v13
    v_add_f32 v53, v53, v13
    v_add_f32 v54, v54, v13
    v_add_f32 v55, v55, v13
    v_add_f32 v84, v84, v44
    v_add_f32 v85, v85, v45
    v_add_f32 v86, v86, v46
    v_add_f32 v87, v87, v47
    v_add_f32 v88, v88, v48
    v_add_f32 v89, v89, v49
    v_add_f32 v90, v90, v50
    v_add_f32 v91, v91, v51
    v_add_f32 v92, v92, v52
    v_add_f32 v93, v93, v53
    v_add_f32 v94, v94, v54
    v_add_f32 v95, v95, v55
    s_waitcnt lgkmcnt(0)
    s_barrier
    ds_read_b128 v[132:135], v2 offset:12288
    ds_read_b128 v[136:139], v2 offset:13312
    ds_read_b128 v[140:143], v2 offset:14336
    ds_read_b128 v[148:151], v2 offset:16384
    ds_read_b128 v[152:155], v2 offset:17408
    ds_read_b128 v[156:159], v2 offset:18432
    ds_read_b128 v[164:167], v2 offset:20480
    ds_read_b128 v[168:171], v2 offset:21504
    ds_read_b128 v[172:175], v2 offset:22528
    s_waitcnt lgkmcnt(6)
    v_add_f32 v84, v84, v132
    v_add_f32 v85, v85, v133
    v_add_f32 v86, v86, v134
    v_add_f32 v87, v87, v135
    v_add_f32 v88, v88, v136
    v_add_f32 v89, v89, v137
    v_add_f32 v90, v90, v138
    v_add_f32 v91, v91, v139
    v_add_f32 v92, v92, v140
    v_add_f32 v93, v93, v141
    v_add_f32 v94, v94, v142
    v_add_f32 v95, v95, v143
    s_waitcnt lgkmcnt(3)
    v_add_f32 v84, v84, v148
    v_add_f32 v85, v85, v149
    v_add_f32 v86, v86, v150
    v_add_f32 v87, v87, v151
    v_add_f32 v88, v88, v152
    v_add_f32 v89, v89, v153
    v_add_f32 v90, v90, v154
    v_add_f32 v91, v91, v155
    v_add_f32 v92, v92, v156
    v_add_f32 v93, v93, v157
    v_add_f32 v94, v94, v158
    v_add_f32 v95, v95, v159
    s_waitcnt lgkmcnt(0)
    v_add_f32 v44, v84, v164
    v_add_f32 v45, v85, v165
    v_add_f32 v46, v86, v166
    v_add_f32 v47, v87, v167
    v_add_f32 v48, v88, v168
    v_add_f32 v49, v89, v169
    v_add_f32 v50, v90, v170
    v_add_f32 v51, v91, v171
    v_add_f32 v52, v92, v172
    v_add_f32 v53, v93, v173
    v_add_f32 v54, v94, v174
    v_add_f32 v55, v95, v175
    v_cvt_pk_bf16_f32 v228, v44, v45
    v_cvt_pk_bf16_f32 v229, v46, v47
    v_cvt_pk_bf16_f32 v230, v48, v49
    v_cvt_pk_bf16_f32 v231, v50, v51
    v_cvt_pk_bf16_f32 v232, v52, v53
    v_cvt_pk_bf16_f32 v233, v54, v55
    s_nop 1
    v_permlane32_swap_b32 v228, v230
    v_permlane32_swap_b32 v229, v231
    v_permlane32_swap_b32 v232, v234
    v_permlane32_swap_b32 v233, v235
    buffer_store_dwordx4 v[228:231], v12, s[28:31], 0 offen
    s_mov_b32 exec_hi, 0
    buffer_store_dwordx4 v[232:235], v12, s[28:31], 0 offen offset:32
    s_endpgm
sequential_preLN__sliding_block__mixer_token_mlp__prompt_kernel_e52:
    s_nop 7
    ds_write_b128 v2, v[116:119] offset:45056
    ds_write_b128 v2, v[120:123] offset:46080
    ds_write_b128 v2, v[124:127] offset:47104
    ds_write_b128 v2, v[68:71] offset:4096
    ds_write_b128 v2, v[72:75] offset:5120
    ds_write_b128 v2, v[76:79] offset:6144
    ds_write_b128 v2, v[80:83] offset:7168
    ds_write_b128 v2, v[84:87] offset:12288
    ds_write_b128 v2, v[88:91] offset:13312
    ds_write_b128 v2, v[92:95] offset:14336
    v_lshlrev_b32 v13, 16, v13
    v_add_f32 v44, v44, v13
    v_add_f32 v45, v45, v13
    v_add_f32 v46, v46, v13
    v_add_f32 v47, v47, v13
    v_add_f32 v48, v48, v13
    v_add_f32 v49, v49, v13
    v_add_f32 v50, v50, v13
    v_add_f32 v51, v51, v13
    v_add_f32 v52, v52, v13
    v_add_f32 v53, v53, v13
    v_add_f32 v54, v54, v13
    v_add_f32 v55, v55, v13
    v_add_f32 v56, v56, v13
    v_add_f32 v57, v57, v13
    v_add_f32 v58, v58, v13
    v_add_f32 v59, v59, v13
    v_add_f32 v100, v100, v44
    v_add_f32 v101, v101, v45
    v_add_f32 v102, v102, v46
    v_add_f32 v103, v103, v47
    v_add_f32 v104, v104, v48
    v_add_f32 v105, v105, v49
    v_add_f32 v106, v106, v50
    v_add_f32 v107, v107, v51
    v_add_f32 v108, v108, v52
    v_add_f32 v109, v109, v53
    v_add_f32 v110, v110, v54
    v_add_f32 v111, v111, v55
    v_add_f32 v112, v112, v56
    v_add_f32 v113, v113, v57
    v_add_f32 v114, v114, v58
    v_add_f32 v115, v115, v59
    s_waitcnt lgkmcnt(0)
    s_barrier
    ds_read_b128 v[132:135], v2 offset:24576
    ds_read_b128 v[136:139], v2 offset:25600
    ds_read_b128 v[140:143], v2 offset:26624
    ds_read_b128 v[144:147], v2 offset:27648
    ds_read_b128 v[148:151], v2 offset:28672
    ds_read_b128 v[152:155], v2 offset:29696
    ds_read_b128 v[156:159], v2 offset:30720
    ds_read_b128 v[160:163], v2 offset:31744
    ds_read_b128 v[164:167], v2 offset:32768
    ds_read_b128 v[168:171], v2 offset:33792
    ds_read_b128 v[172:175], v2 offset:34816
    ds_read_b128 v[176:179], v2 offset:35840
    s_waitcnt lgkmcnt(8)
    v_add_f32 v100, v100, v132
    v_add_f32 v101, v101, v133
    v_add_f32 v102, v102, v134
    v_add_f32 v103, v103, v135
    v_add_f32 v104, v104, v136
    v_add_f32 v105, v105, v137
    v_add_f32 v106, v106, v138
    v_add_f32 v107, v107, v139
    v_add_f32 v108, v108, v140
    v_add_f32 v109, v109, v141
    v_add_f32 v110, v110, v142
    v_add_f32 v111, v111, v143
    v_add_f32 v112, v112, v144
    v_add_f32 v113, v113, v145
    v_add_f32 v114, v114, v146
    v_add_f32 v115, v115, v147
    s_waitcnt lgkmcnt(4)
    v_add_f32 v100, v100, v148
    v_add_f32 v101, v101, v149
    v_add_f32 v102, v102, v150
    v_add_f32 v103, v103, v151
    v_add_f32 v104, v104, v152
    v_add_f32 v105, v105, v153
    v_add_f32 v106, v106, v154
    v_add_f32 v107, v107, v155
    v_add_f32 v108, v108, v156
    v_add_f32 v109, v109, v157
    v_add_f32 v110, v110, v158
    v_add_f32 v111, v111, v159
    v_add_f32 v112, v112, v160
    v_add_f32 v113, v113, v161
    v_add_f32 v114, v114, v162
    v_add_f32 v115, v115, v163
    s_waitcnt lgkmcnt(0)
    v_add_f32 v44, v100, v164
    v_add_f32 v45, v101, v165
    v_add_f32 v46, v102, v166
    v_add_f32 v47, v103, v167
    v_add_f32 v48, v104, v168
    v_add_f32 v49, v105, v169
    v_add_f32 v50, v106, v170
    v_add_f32 v51, v107, v171
    v_add_f32 v52, v108, v172
    v_add_f32 v53, v109, v173
    v_add_f32 v54, v110, v174
    v_add_f32 v55, v111, v175
    v_add_f32 v56, v112, v176
    v_add_f32 v57, v113, v177
    v_add_f32 v58, v114, v178
    v_add_f32 v59, v115, v179
    v_cvt_pk_bf16_f32 v228, v44, v45
    v_cvt_pk_bf16_f32 v229, v46, v47
    v_cvt_pk_bf16_f32 v230, v48, v49
    v_cvt_pk_bf16_f32 v231, v50, v51
    v_cvt_pk_bf16_f32 v232, v52, v53
    v_cvt_pk_bf16_f32 v233, v54, v55
    v_cvt_pk_bf16_f32 v234, v56, v57
    v_cvt_pk_bf16_f32 v235, v58, v59
    s_nop 1
    v_permlane32_swap_b32 v228, v230
    v_permlane32_swap_b32 v229, v231
    v_permlane32_swap_b32 v232, v234
    v_permlane32_swap_b32 v233, v235
    buffer_store_dwordx4 v[228:231], v12, s[28:31], 0 offen
    buffer_store_dwordx4 v[232:235], v12, s[28:31], 0 offen offset:32
    s_endpgm
sequential_preLN__sliding_block__mixer_token_mlp__prompt_kernel_e53:
    s_nop 7
    ds_write_b128 v2, v[68:71] offset:8192
    ds_write_b128 v2, v[72:75] offset:9216
    ds_write_b128 v2, v[76:79] offset:10240
    ds_write_b128 v2, v[80:83] offset:11264
    ds_write_b128 v2, v[84:87] offset:16384
    ds_write_b128 v2, v[88:91] offset:17408
    ds_write_b128 v2, v[92:95] offset:18432
    ds_write_b128 v2, v[100:103] offset:24576
    ds_write_b128 v2, v[104:107] offset:25600
    ds_write_b128 v2, v[108:111] offset:26624
    ds_write_b128 v2, v[112:115] offset:27648
    v_lshlrev_b32 v13, 16, v13
    v_add_f32 v44, v44, v13
    v_add_f32 v45, v45, v13
    v_add_f32 v46, v46, v13
    v_add_f32 v47, v47, v13
    v_add_f32 v48, v48, v13
    v_add_f32 v49, v49, v13
    v_add_f32 v50, v50, v13
    v_add_f32 v51, v51, v13
    v_add_f32 v52, v52, v13
    v_add_f32 v53, v53, v13
    v_add_f32 v54, v54, v13
    v_add_f32 v55, v55, v13
    v_add_f32 v116, v116, v44
    v_add_f32 v117, v117, v45
    v_add_f32 v118, v118, v46
    v_add_f32 v119, v119, v47
    v_add_f32 v120, v120, v48
    v_add_f32 v121, v121, v49
    v_add_f32 v122, v122, v50
    v_add_f32 v123, v123, v51
    v_add_f32 v124, v124, v52
    v_add_f32 v125, v125, v53
    v_add_f32 v126, v126, v54
    v_add_f32 v127, v127, v55
    s_waitcnt lgkmcnt(0)
    s_barrier
    ds_read_b128 v[132:135], v2 offset:36864
    ds_read_b128 v[136:139], v2 offset:37888
    ds_read_b128 v[140:143], v2 offset:38912
    ds_read_b128 v[148:151], v2 offset:40960
    ds_read_b128 v[152:155], v2 offset:41984
    ds_read_b128 v[156:159], v2 offset:43008
    ds_read_b128 v[164:167], v2 offset:45056
    ds_read_b128 v[168:171], v2 offset:46080
    ds_read_b128 v[172:175], v2 offset:47104
    s_waitcnt lgkmcnt(6)
    v_add_f32 v116, v116, v132
    v_add_f32 v117, v117, v133
    v_add_f32 v118, v118, v134
    v_add_f32 v119, v119, v135
    v_add_f32 v120, v120, v136
    v_add_f32 v121, v121, v137
    v_add_f32 v122, v122, v138
    v_add_f32 v123, v123, v139
    v_add_f32 v124, v124, v140
    v_add_f32 v125, v125, v141
    v_add_f32 v126, v126, v142
    v_add_f32 v127, v127, v143
    s_waitcnt lgkmcnt(3)
    v_add_f32 v116, v116, v148
    v_add_f32 v117, v117, v149
    v_add_f32 v118, v118, v150
    v_add_f32 v119, v119, v151
    v_add_f32 v120, v120, v152
    v_add_f32 v121, v121, v153
    v_add_f32 v122, v122, v154
    v_add_f32 v123, v123, v155
    v_add_f32 v124, v124, v156
    v_add_f32 v125, v125, v157
    v_add_f32 v126, v126, v158
    v_add_f32 v127, v127, v159
    s_waitcnt lgkmcnt(0)
    v_add_f32 v44, v116, v164
    v_add_f32 v45, v117, v165
    v_add_f32 v46, v118, v166
    v_add_f32 v47, v119, v167
    v_add_f32 v48, v120, v168
    v_add_f32 v49, v121, v169
    v_add_f32 v50, v122, v170
    v_add_f32 v51, v123, v171
    v_add_f32 v52, v124, v172
    v_add_f32 v53, v125, v173
    v_add_f32 v54, v126, v174
    v_add_f32 v55, v127, v175
    v_cvt_pk_bf16_f32 v228, v44, v45
    v_cvt_pk_bf16_f32 v229, v46, v47
    v_cvt_pk_bf16_f32 v230, v48, v49
    v_cvt_pk_bf16_f32 v231, v50, v51
    v_cvt_pk_bf16_f32 v232, v52, v53
    v_cvt_pk_bf16_f32 v233, v54, v55
    s_nop 1
    v_permlane32_swap_b32 v228, v230
    v_permlane32_swap_b32 v229, v231
    v_permlane32_swap_b32 v232, v234
    v_permlane32_swap_b32 v233, v235
    buffer_store_dwordx4 v[228:231], v12, s[28:31], 0 offen
    s_mov_b32 exec_hi, 0
    buffer_store_dwordx4 v[232:235], v12, s[28:31], 0 offen offset:32
    s_endpgm
sequential_preLN__sliding_block__mixer_token_mlp__prompt_kernel_idle:
    s_waitcnt vmcnt(0)
    s_and_b32 s42, s37, 3
    s_mul_i32 s42, s42, 448
    s_mul_i32 s43, s36, 28
    s_add_u32 s42, s42, s43
    s_lshr_b32 s43, s37, 2
    s_mul_i32 s43, s43, 112
    s_add_u32 s42, s42, s43
    s_add_u32 s42, s42, 224
    s_lshl_b32 s42, s42, 2
    s_lshr_b32 s43, s38, 3
    s_add_u32 s42, s42, s43
    s_lshl_b32 s42, s42, 10
    v_lshrrev_b32 v22, 3, v1
    v_lshlrev_b32 v22, 12, v22
    v_and_b32 v23, 7, v1
    v_lshl_add_u32 v22, v23, 7, v22
    s_add_u32 s43, s42, 0
    buffer_load_dword v132, v22, s[20:23], s43 offen
    s_add_u32 s43, s42, 32768
    buffer_load_dword v133, v22, s[20:23], s43 offen
    s_add_u32 s43, s42, 65536
    buffer_load_dword v134, v22, s[20:23], s43 offen
    s_add_u32 s43, s42, 81920
    buffer_load_dword v135, v22, s[20:23], s43 offen
    ds_read_b64_tr_b16 a[0:1], v5 offset:8192
    ds_read_b64_tr_b16 a[2:3], v5 offset:9216
    ds_read_b64_tr_b16 a[4:5], v6 offset:8192
    ds_read_b64_tr_b16 a[6:7], v6 offset:9216
    ds_read_b64_tr_b16 a[8:9], v5 offset:10240
    ds_read_b64_tr_b16 a[10:11], v5 offset:11264
    ds_read_b64_tr_b16 a[12:13], v6 offset:10240
    ds_read_b64_tr_b16 a[14:15], v6 offset:11264
    ds_read_b64_tr_b16 a[16:17], v5 offset:0
    ds_read_b64_tr_b16 a[18:19], v5 offset:1024
    ds_read_b64_tr_b16 a[20:21], v6 offset:0
    ds_read_b64_tr_b16 a[22:23], v6 offset:1024
    ds_read_b64_tr_b16 a[24:25], v5 offset:2048
    ds_read_b64_tr_b16 a[26:27], v5 offset:3072
    ds_read_b64_tr_b16 a[28:29], v6 offset:2048
    ds_read_b64_tr_b16 a[30:31], v6 offset:3072
    ds_read_b64_tr_b16 a[32:33], v5 offset:4096
    ds_read_b64_tr_b16 a[34:35], v5 offset:5120
    ds_read_b64_tr_b16 a[36:37], v6 offset:4096
    ds_read_b64_tr_b16 a[38:39], v6 offset:5120
    ds_read_b64_tr_b16 a[40:41], v5 offset:6144
    ds_read_b64_tr_b16 a[42:43], v5 offset:7168
    ds_read_b64_tr_b16 a[44:45], v6 offset:6144
    ds_read_b64_tr_b16 a[46:47], v6 offset:7168
    ds_read_b64_tr_b16 a[48:49], v5 offset:12288
    ds_read_b64_tr_b16 a[50:51], v5 offset:13312
    ds_read_b64_tr_b16 a[52:53], v6 offset:12288
    ds_read_b64_tr_b16 a[54:55], v6 offset:13312
    ds_read_b64_tr_b16 a[56:57], v5 offset:14336
    ds_read_b64_tr_b16 a[58:59], v5 offset:15360
    ds_read_b64_tr_b16 a[60:61], v6 offset:14336
    ds_read_b64_tr_b16 a[62:63], v6 offset:15360
    ds_read_b64_tr_b16 a[64:65], v5 offset:16384
    ds_read_b64_tr_b16 a[66:67], v5 offset:17408
    ds_read_b64_tr_b16 a[68:69], v6 offset:16384
    ds_read_b64_tr_b16 a[70:71], v6 offset:17408
    ds_read_b64_tr_b16 a[72:73], v5 offset:18432
    ds_read_b64_tr_b16 a[74:75], v5 offset:19456
    ds_read_b64_tr_b16 a[76:77], v6 offset:18432
    ds_read_b64_tr_b16 a[78:79], v6 offset:19456
    ds_read_b64_tr_b16 a[80:81], v5 offset:20480
    ds_read_b64_tr_b16 a[82:83], v5 offset:21504
    ds_read_b64_tr_b16 a[84:85], v6 offset:20480
    ds_read_b64_tr_b16 a[86:87], v6 offset:21504
    ds_read_b64_tr_b16 a[88:89], v5 offset:22528
    ds_read_b64_tr_b16 a[90:91], v5 offset:23552
    ds_read_b64_tr_b16 a[92:93], v6 offset:22528
    ds_read_b64_tr_b16 a[94:95], v6 offset:23552
    ds_read_b64_tr_b16 a[96:97], v5 offset:24576
    ds_read_b64_tr_b16 a[98:99], v5 offset:25600
    ds_read_b64_tr_b16 a[100:101], v6 offset:24576
    ds_read_b64_tr_b16 a[102:103], v6 offset:25600
    ds_read_b64_tr_b16 a[104:105], v5 offset:26624
    ds_read_b64_tr_b16 a[106:107], v5 offset:27648
    ds_read_b64_tr_b16 a[108:109], v6 offset:26624
    ds_read_b64_tr_b16 a[110:111], v6 offset:27648
    s_waitcnt lgkmcnt(15)
    s_add_u32 s47, s93, 7
    s_sub_u32 s51, s47, 14
    s_min_u32 s47, s47, s51
    s_mul_i32 s47, s47, 131072
    s_add_u32 m0, s48, 8192
    s_nop 0
    buffer_load_dwordx4 v18, s[20:23], s47 offen offset:0 lds
    buffer_load_dwordx4 v19, s[20:23], s47 offen offset:1024 lds
    buffer_load_dwordx4 v20, s[20:23], s47 offen offset:2048 lds
    buffer_load_dwordx4 v21, s[20:23], s47 offen offset:3072 lds
    s_add_u32 s47, s93, 8
    s_sub_u32 s51, s47, 14
    s_min_u32 s47, s47, s51
    s_mul_i32 s47, s47, 131072
    s_add_u32 m0, s48, 0
    s_nop 0
    buffer_load_dwordx4 v18, s[20:23], s47 offen offset:0 lds
    buffer_load_dwordx4 v19, s[20:23], s47 offen offset:1024 lds
    buffer_load_dwordx4 v20, s[20:23], s47 offen offset:2048 lds
    buffer_load_dwordx4 v21, s[20:23], s47 offen offset:3072 lds
    s_add_u32 s47, s93, 9
    s_sub_u32 s51, s47, 14
    s_min_u32 s47, s47, s51
    s_mul_i32 s47, s47, 131072
    s_add_u32 m0, s48, 4096
    s_nop 0
    buffer_load_dwordx4 v18, s[20:23], s47 offen offset:0 lds
    buffer_load_dwordx4 v19, s[20:23], s47 offen offset:1024 lds
    buffer_load_dwordx4 v20, s[20:23], s47 offen offset:2048 lds
    buffer_load_dwordx4 v21, s[20:23], s47 offen offset:3072 lds
    s_add_u32 s47, s93, 10
    s_sub_u32 s51, s47, 14
    s_min_u32 s47, s47, s51
    s_mul_i32 s47, s47, 131072
    s_add_u32 m0, s48, 12288
    s_nop 0
    buffer_load_dwordx4 v18, s[20:23], s47 offen offset:0 lds
    buffer_load_dwordx4 v19, s[20:23], s47 offen offset:1024 lds
    buffer_load_dwordx4 v20, s[20:23], s47 offen offset:2048 lds
    buffer_load_dwordx4 v21, s[20:23], s47 offen offset:3072 lds
    s_add_u32 s47, s93, 11
    s_sub_u32 s51, s47, 14
    s_min_u32 s47, s47, s51
    s_mul_i32 s47, s47, 131072
    s_add_u32 m0, s48, 16384
    s_nop 0
    buffer_load_dwordx4 v18, s[20:23], s47 offen offset:0 lds
    buffer_load_dwordx4 v19, s[20:23], s47 offen offset:1024 lds
    buffer_load_dwordx4 v20, s[20:23], s47 offen offset:2048 lds
    buffer_load_dwordx4 v21, s[20:23], s47 offen offset:3072 lds
    s_waitcnt lgkmcnt(8)
    s_add_u32 s47, s93, 12
    s_sub_u32 s51, s47, 14
    s_min_u32 s47, s47, s51
    s_mul_i32 s47, s47, 131072
    s_add_u32 m0, s48, 20480
    s_nop 0
    buffer_load_dwordx4 v18, s[20:23], s47 offen offset:0 lds
    buffer_load_dwordx4 v19, s[20:23], s47 offen offset:1024 lds
    buffer_load_dwordx4 v20, s[20:23], s47 offen offset:2048 lds
    buffer_load_dwordx4 v21, s[20:23], s47 offen offset:3072 lds
    s_waitcnt lgkmcnt(0)
    s_add_u32 s47, s93, 13
    s_sub_u32 s51, s47, 14
    s_min_u32 s47, s47, s51
    s_mul_i32 s47, s47, 131072
    s_add_u32 m0, s48, 24576
    s_nop 0
    buffer_load_dwordx4 v18, s[20:23], s47 offen offset:0 lds
    buffer_load_dwordx4 v19, s[20:23], s47 offen offset:1024 lds
    buffer_load_dwordx4 v20, s[20:23], s47 offen offset:2048 lds
    buffer_load_dwordx4 v21, s[20:23], s47 offen offset:3072 lds
    s_branch sequential_preLN__sliding_block__mixer_token_mlp__prompt_kernel_j5
sequential_preLN__sliding_block__mixer_token_mlp__prompt_kernel_os0:
    s_add_u32 s42, s94, 0
    s_add_u32 s43, s94, 32768
    buffer_load_dwordx4 v[132:135], v2, s[12:15], s42 offen offset:0 sc1
    buffer_load_dwordx4 v[136:139], v2, s[12:15], s43 offen offset:0 sc1
    buffer_load_dwordx4 v[140:143], v2, s[12:15], s42 offen offset:1024 sc1
    buffer_load_dwordx4 v[144:147], v2, s[12:15], s43 offen offset:1024 sc1
    buffer_load_dwordx4 v[148:151], v2, s[12:15], s42 offen offset:2048 sc1
    buffer_load_dwordx4 v[152:155], v2, s[12:15], s43 offen offset:2048 sc1
    buffer_load_dwordx4 v[156:159], v2, s[12:15], s42 offen offset:3072 sc1
    buffer_load_dwordx4 v[160:163], v2, s[12:15], s43 offen offset:3072 sc1
    s_add_u32 s42, s94, 4096
    s_add_u32 s43, s94, 36864
    buffer_load_dwordx4 v[164:167], v2, s[12:15], s42 offen offset:0 sc1
    buffer_load_dwordx4 v[168:171], v2, s[12:15], s43 offen offset:0 sc1
    buffer_load_dwordx4 v[172:175], v2, s[12:15], s42 offen offset:1024 sc1
    buffer_load_dwordx4 v[176:179], v2, s[12:15], s43 offen offset:1024 sc1
    buffer_load_dwordx4 v[180:183], v2, s[12:15], s42 offen offset:2048 sc1
    buffer_load_dwordx4 v[184:187], v2, s[12:15], s43 offen offset:2048 sc1
    buffer_load_dwordx4 v[188:191], v2, s[12:15], s42 offen offset:3072 sc1
    buffer_load_dwordx4 v[192:195], v2, s[12:15], s43 offen offset:3072 sc1
    s_add_u32 s49, s49, 1
    s_cmp_ge_u32 s49, 20000
    s_waitcnt vmcnt(0)
    s_cbranch_scc1 sequential_preLN__sliding_block__mixer_token_mlp__prompt_kernel_or0
    v_max_u32 v22, v135, v139
    v_cmp_eq_u32 vcc, -1, v22
    s_cbranch_vccnz sequential_preLN__sliding_block__mixer_token_mlp__prompt_kernel_os0
    s_branch sequential_preLN__sliding_block__mixer_token_mlp__prompt_kernel_or0
sequential_preLN__sliding_block__mixer_token_mlp__prompt_kernel_os1:
    s_add_u32 s42, s94, 0
    s_add_u32 s43, s94, 32768
    buffer_load_dwordx4 v[140:143], v2, s[12:15], s42 offen offset:1024 sc1
    buffer_load_dwordx4 v[144:147], v2, s[12:15], s43 offen offset:1024 sc1
    buffer_load_dwordx4 v[148:151], v2, s[12:15], s42 offen offset:2048 sc1
    buffer_load_dwordx4 v[152:155], v2, s[12:15], s43 offen offset:2048 sc1
    buffer_load_dwordx4 v[156:159], v2, s[12:15], s42 offen offset:3072 sc1
    buffer_load_dwordx4 v[160:163], v2, s[12:15], s43 offen offset:3072 sc1
    s_add_u32 s42, s94, 4096
    s_add_u32 s43, s94, 36864
    buffer_load_dwordx4 v[164:167], v2, s[12:15], s42 offen offset:0 sc1
    buffer_load_dwordx4 v[168:171], v2, s[12:15], s43 offen offset:0 sc1
    buffer_load_dwordx4 v[172:175], v2, s[12:15], s42 offen offset:1024 sc1
    buffer_load_dwordx4 v[176:179], v2, s[12:15], s43 offen offset:1024 sc1
    buffer_load_dwordx4 v[180:183], v2, s[12:15], s42 offen offset:2048 sc1
    buffer_load_dwordx4 v[184:187], v2, s[12:15], s43 offen offset:2048 sc1
    buffer_load_dwordx4 v[188:191], v2, s[12:15], s42 offen offset:3072 sc1
    buffer_load_dwordx4 v[192:195], v2, s[12:15], s43 offen offset:3072 sc1
    s_add_u32 s49, s49, 1
    s_cmp_ge_u32 s49, 20000
    s_waitcnt vmcnt(0)
    s_cbranch_scc1 sequential_preLN__sliding_block__mixer_token_mlp__prompt_kernel_or1
    v_max_u32 v22, v143, v147
    v_cmp_eq_u32 vcc, -1, v22
    s_cbranch_vccnz sequential_preLN__sliding_block__mixer_token_mlp__prompt_kernel_os1
    s_branch sequential_preLN__sliding_block__mixer_token_mlp__prompt_kernel_or1
sequential_preLN__sliding_block__mixer_token_mlp__prompt_kernel_os2:
    s_add_u32 s42, s94, 0
    s_add_u32 s43, s94, 32768
    buffer_load_dwordx4 v[148:151], v2, s[12:15], s42 offen offset:2048 sc1
    buffer_load_dwordx4 v[152:155], v2, s[12:15], s43 offen offset:2048 sc1
    buffer_load_dwordx4 v[156:159], v2, s[12:15], s42 offen offset:3072 sc1
    buffer_load_dwordx4 v[160:163], v2, s[12:15], s43 offen offset:3072 sc1
    s_add_u32 s42, s94, 4096
    s_add_u32 s43, s94, 36864
    buffer_load_dwordx4 v[164:167], v2, s[12:15], s42 offen offset:0 sc1
    buffer_load_dwordx4 v[168:171], v2, s[12:15], s43 offen offset:0 sc1
    buffer_load_dwordx4 v[172:175], v2, s[12:15], s42 offen offset:1024 sc1
    buffer_load_dwordx4 v[176:179], v2, s[12:15], s43 offen offset:1024 sc1
    buffer_load_dwordx4 v[180:183], v2, s[12:15], s42 offen offset:2048 sc1
    buffer_load_dwordx4 v[184:187], v2, s[12:15], s43 offen offset:2048 sc1
    buffer_load_dwordx4 v[188:191], v2, s[12:15], s42 offen offset:3072 sc1
    buffer_load_dwordx4 v[192:195], v2, s[12:15], s43 offen offset:3072 sc1
    s_add_u32 s49, s49, 1
    s_cmp_ge_u32 s49, 20000
    s_waitcnt vmcnt(0)
    s_cbranch_scc1 sequential_preLN__sliding_block__mixer_token_mlp__prompt_kernel_or2
    v_max_u32 v22, v151, v155
    v_cmp_eq_u32 vcc, -1, v22
    s_cbranch_vccnz sequential_preLN__sliding_block__mixer_token_mlp__prompt_kernel_os2
    s_branch sequential_preLN__sliding_block__mixer_token_mlp__prompt_kernel_or2
sequential_preLN__sliding_block__mixer_token_mlp__prompt_kernel_os3:
    s_add_u32 s42, s94, 0
    s_add_u32 s43, s94, 32768
    buffer_load_dwordx4 v[156:159], v2, s[12:15], s42 offen offset:3072 sc1
    buffer_load_dwordx4 v[160:163], v2, s[12:15], s43 offen offset:3072 sc1
    s_add_u32 s42, s94, 4096
    s_add_u32 s43, s94, 36864
    buffer_load_dwordx4 v[164:167], v2, s[12:15], s42 offen offset:0 sc1
    buffer_load_dwordx4 v[168:171], v2, s[12:15], s43 offen offset:0 sc1
    buffer_load_dwordx4 v[172:175], v2, s[12:15], s42 offen offset:1024 sc1
    buffer_load_dwordx4 v[176:179], v2, s[12:15], s43 offen offset:1024 sc1
    buffer_load_dwordx4 v[180:183], v2, s[12:15], s42 offen offset:2048 sc1
    buffer_load_dwordx4 v[184:187], v2, s[12:15], s43 offen offset:2048 sc1
    buffer_load_dwordx4 v[188:191], v2, s[12:15], s42 offen offset:3072 sc1
    buffer_load_dwordx4 v[192:195], v2, s[12:15], s43 offen offset:3072 sc1
    s_add_u32 s49, s49, 1
    s_cmp_ge_u32 s49, 20000
    s_waitcnt vmcnt(0)
    s_cbranch_scc1 sequential_preLN__sliding_block__mixer_token_mlp__prompt_kernel_or3
    v_max_u32 v22, v159, v163
    v_cmp_eq_u32 vcc, -1, v22
    s_cbranch_vccnz sequential_preLN__sliding_block__mixer_token_mlp__prompt_kernel_os3
    s_branch sequential_preLN__sliding_block__mixer_token_mlp__prompt_kernel_or3
sequential_preLN__sliding_block__mixer_token_mlp__prompt_kernel_os4:
    s_add_u32 s42, s94, 4096
    s_add_u32 s43, s94, 36864
    buffer_load_dwordx4 v[164:167], v2, s[12:15], s42 offen offset:0 sc1
    buffer_load_dwordx4 v[168:171], v2, s[12:15], s43 offen offset:0 sc1
    buffer_load_dwordx4 v[172:175], v2, s[12:15], s42 offen offset:1024 sc1
    buffer_load_dwordx4 v[176:179], v2, s[12:15], s43 offen offset:1024 sc1
    buffer_load_dwordx4 v[180:183], v2, s[12:15], s42 offen offset:2048 sc1
    buffer_load_dwordx4 v[184:187], v2, s[12:15], s43 offen offset:2048 sc1
    buffer_load_dwordx4 v[188:191], v2, s[12:15], s42 offen offset:3072 sc1
    buffer_load_dwordx4 v[192:195], v2, s[12:15], s43 offen offset:3072 sc1
    s_add_u32 s49, s49, 1
    s_cmp_ge_u32 s49, 20000
    s_waitcnt vmcnt(0)
    s_cbranch_scc1 sequential_preLN__sliding_block__mixer_token_mlp__prompt_kernel_or4
    v_max_u32 v22, v167, v171
    v_cmp_eq_u32 vcc, -1, v22
    s_cbranch_vccnz sequential_preLN__sliding_block__mixer_token_mlp__prompt_kernel_os4
    s_branch sequential_preLN__sliding_block__mixer_token_mlp__prompt_kernel_or4
sequential_preLN__sliding_block__mixer_token_mlp__prompt_kernel_os5:
    s_add_u32 s42, s94, 4096
    s_add_u32 s43, s94, 36864
    buffer_load_dwordx4 v[172:175], v2, s[12:15], s42 offen offset:1024 sc1
    buffer_load_dwordx4 v[176:179], v2, s[12:15], s43 offen offset:1024 sc1
    buffer_load_dwordx4 v[180:183], v2, s[12:15], s42 offen offset:2048 sc1
    buffer_load_dwordx4 v[184:187], v2, s[12:15], s43 offen offset:2048 sc1
    buffer_load_dwordx4 v[188:191], v2, s[12:15], s42 offen offset:3072 sc1
    buffer_load_dwordx4 v[192:195], v2, s[12:15], s43 offen offset:3072 sc1
    s_add_u32 s49, s49, 1
    s_cmp_ge_u32 s49, 20000
    s_waitcnt vmcnt(0)
    s_cbranch_scc1 sequential_preLN__sliding_block__mixer_token_mlp__prompt_kernel_or5
    v_max_u32 v22, v175, v179
    v_cmp_eq_u32 vcc, -1, v22
    s_cbranch_vccnz sequential_preLN__sliding_block__mixer_token_mlp__prompt_kernel_os5
    s_branch sequential_preLN__sliding_block__mixer_token_mlp__prompt_kernel_or5
sequential_preLN__sliding_block__mixer_token_mlp__prompt_kernel_os6:
    s_add_u32 s42, s94, 4096
    s_add_u32 s43, s94, 36864
    buffer_load_dwordx4 v[180:183], v2, s[12:15], s42 offen offset:2048 sc1
    buffer_load_dwordx4 v[184:187], v2, s[12:15], s43 offen offset:2048 sc1
    buffer_load_dwordx4 v[188:191], v2, s[12:15], s42 offen offset:3072 sc1
    buffer_load_dwordx4 v[192:195], v2, s[12:15], s43 offen offset:3072 sc1
    s_add_u32 s49, s49, 1
    s_cmp_ge_u32 s49, 20000
    s_waitcnt vmcnt(0)
    s_cbranch_scc1 sequential_preLN__sliding_block__mixer_token_mlp__prompt_kernel_or6
    v_max_u32 v22, v183, v187
    v_cmp_eq_u32 vcc, -1, v22
    s_cbranch_vccnz sequential_preLN__sliding_block__mixer_token_mlp__prompt_kernel_os6
    s_branch sequential_preLN__sliding_block__mixer_token_mlp__prompt_kernel_or6
sequential_preLN__sliding_block__mixer_token_mlp__prompt_kernel_os7:
    s_add_u32 s42, s94, 4096
    s_add_u32 s43, s94, 36864
    buffer_load_dwordx4 v[188:191], v2, s[12:15], s42 offen offset:3072 sc1
    buffer_load_dwordx4 v[192:195], v2, s[12:15], s43 offen offset:3072 sc1
    s_add_u32 s49, s49, 1
    s_cmp_ge_u32 s49, 20000
    s_waitcnt vmcnt(0)
    s_cbranch_scc1 sequential_preLN__sliding_block__mixer_token_mlp__prompt_kernel_or7
    v_max_u32 v22, v191, v195
    v_cmp_eq_u32 vcc, -1, v22
    s_cbranch_vccnz sequential_preLN__sliding_block__mixer_token_mlp__prompt_kernel_os7
    s_branch sequential_preLN__sliding_block__mixer_token_mlp__prompt_kernel_or7
sequential_preLN__sliding_block__mixer_token_mlp__prompt_kernel_g1s0:
    s_add_u32 s42, s92, 0
    s_and_b32 s42, s42, 15
    s_mul_i32 s42, s42, 3584
    buffer_load_dwordx4 v[132:135], v7, s[12:15], s42 offen offset:0 sc1
    buffer_load_dwordx4 v[136:139], v8, s[12:15], s42 offen offset:0 sc1
    buffer_load_dwordx4 v[140:143], v7, s[12:15], s42 offen offset:1792 sc1
    buffer_load_dwordx4 v[144:147], v8, s[12:15], s42 offen offset:1792 sc1
    s_add_u32 s42, s92, 1
    s_and_b32 s42, s42, 15
    s_mul_i32 s42, s42, 3584
    buffer_load_dwordx4 v[148:151], v7, s[12:15], s42 offen offset:0 sc1
    buffer_load_dwordx4 v[152:155], v8, s[12:15], s42 offen offset:0 sc1
    s_add_u32 s49, s49, 1
    s_cmp_ge_u32 s49, 20000
    s_waitcnt vmcnt(0)
    s_cbranch_scc1 sequential_preLN__sliding_block__mixer_token_mlp__prompt_kernel_g1r0
    v_max_u32 v22, v135, v139
    v_cmp_eq_u32 vcc, -1, v22
    s_cbranch_vccnz sequential_preLN__sliding_block__mixer_token_mlp__prompt_kernel_g1s0
    s_branch sequential_preLN__sliding_block__mixer_token_mlp__prompt_kernel_g1r0
sequential_preLN__sliding_block__mixer_token_mlp__prompt_kernel_g1s1:
    s_add_u32 s42, s92, 0
    s_and_b32 s42, s42, 15
    s_mul_i32 s42, s42, 3584
    buffer_load_dwordx4 v[140:143], v7, s[12:15], s42 offen offset:1792 sc1
    buffer_load_dwordx4 v[144:147], v8, s[12:15], s42 offen offset:1792 sc1
    s_add_u32 s42, s92, 1
    s_and_b32 s42, s42, 15
    s_mul_i32 s42, s42, 3584
    buffer_load_dwordx4 v[148:151], v7, s[12:15], s42 offen offset:0 sc1
    buffer_load_dwordx4 v[152:155], v8, s[12:15], s42 offen offset:0 sc1
    buffer_load_dwordx4 v[156:159], v7, s[12:15], s42 offen offset:1792 sc1
    buffer_load_dwordx4 v[160:163], v8, s[12:15], s42 offen offset:1792 sc1
    s_add_u32 s42, s92, 2
    s_and_b32 s42, s42, 15
    s_mul_i32 s42, s42, 3584
    buffer_load_dwordx4 v[164:167], v7, s[12:15], s42 offen offset:0 sc1
    buffer_load_dwordx4 v[168:171], v8, s[12:15], s42 offen offset:0 sc1
    s_add_u32 s49, s49, 1
    s_cmp_ge_u32 s49, 20000
    s_waitcnt vmcnt(0)
    s_cbranch_scc1 sequential_preLN__sliding_block__mixer_token_mlp__prompt_kernel_g1r1
    v_max_u32 v22, v143, v147
    v_cmp_eq_u32 vcc, -1, v22
    s_cbranch_vccnz sequential_preLN__sliding_block__mixer_token_mlp__prompt_kernel_g1s1
    s_branch sequential_preLN__sliding_block__mixer_token_mlp__prompt_kernel_g1r1
sequential_preLN__sliding_block__mixer_token_mlp__prompt_kernel_g1s2:
    s_add_u32 s42, s92, 1
    s_and_b32 s42, s42, 15
    s_mul_i32 s42, s42, 3584
    buffer_load_dwordx4 v[148:151], v7, s[12:15], s42 offen offset:0 sc1
    buffer_load_dwordx4 v[152:155], v8, s[12:15], s42 offen offset:0 sc1
    buffer_load_dwordx4 v[156:159], v7, s[12:15], s42 offen offset:1792 sc1
    buffer_load_dwordx4 v[160:163], v8, s[12:15], s42 offen offset:1792 sc1
    s_add_u32 s42, s92, 2
    s_and_b32 s42, s42, 15
    s_mul_i32 s42, s42, 3584
    buffer_load_dwordx4 v[164:167], v7, s[12:15], s42 offen offset:0 sc1
    buffer_load_dwordx4 v[168:171], v8, s[12:15], s42 offen offset:0 sc1
    buffer_load_dwordx4 v[172:175], v7, s[12:15], s42 offen offset:1792 sc1
    buffer_load_dwordx4 v[176:179], v8, s[12:15], s42 offen offset:1792 sc1
    s_add_u32 s42, s92, 3
    s_and_b32 s42, s42, 15
    s_mul_i32 s42, s42, 3584
    buffer_load_dwordx4 v[180:183], v7, s[12:15], s42 offen offset:0 sc1
    buffer_load_dwordx4 v[184:187], v8, s[12:15], s42 offen offset:0 sc1
    s_add_u32 s49, s49, 1
    s_cmp_ge_u32 s49, 20000
    s_waitcnt vmcnt(0)
    s_cbranch_scc1 sequential_preLN__sliding_block__mixer_token_mlp__prompt_kernel_g1r2
    v_max_u32 v22, v151, v155
    v_cmp_eq_u32 vcc, -1, v22
    s_cbranch_vccnz sequential_preLN__sliding_block__mixer_token_mlp__prompt_kernel_g1s2
    s_branch sequential_preLN__sliding_block__mixer_token_mlp__prompt_kernel_g1r2
sequential_preLN__sliding_block__mixer_token_mlp__prompt_kernel_g1s3:
    s_add_u32 s42, s92, 1
    s_and_b32 s42, s42, 15
    s_mul_i32 s42, s42, 3584
    buffer_load_dwordx4 v[156:159], v7, s[12:15], s42 offen offset:1792 sc1
    buffer_load_dwordx4 v[160:163], v8, s[12:15], s42 offen offset:1792 sc1
    s_add_u32 s42, s92, 2
    s_and_b32 s42, s42, 15
    s_mul_i32 s42, s42, 3584
    buffer_load_dwordx4 v[164:167], v7, s[12:15], s42 offen offset:0 sc1
    buffer_load_dwordx4 v[168:171], v8, s[12:15], s42 offen offset:0 sc1
    buffer_load_dwordx4 v[172:175], v7, s[12:15], s42 offen offset:1792 sc1
    buffer_load_dwordx4 v[176:179], v8, s[12:15], s42 offen offset:1792 sc1
    s_add_u32 s42, s92, 3
    s_and_b32 s42, s42, 15
    s_mul_i32 s42, s42, 3584
    buffer_load_dwordx4 v[180:183], v7, s[12:15], s42 offen offset:0 sc1
    buffer_load_dwordx4 v[184:187], v8, s[12:15], s42 offen offset:0 sc1
    buffer_load_dwordx4 v[188:191], v7, s[12:15], s42 offen offset:1792 sc1
    buffer_load_dwordx4 v[192:195], v8, s[12:15], s42 offen offset:1792 sc1
    s_add_u32 s42, s92, 4
    s_and_b32 s42, s42, 15
    s_mul_i32 s42, s42, 3584
    buffer_load_dwordx4 v[196:199], v7, s[12:15], s42 offen offset:0 sc1
    buffer_load_dwordx4 v[200:203], v8, s[12:15], s42 offen offset:0 sc1
    s_add_u32 s49, s49, 1
    s_cmp_ge_u32 s49, 20000
    s_waitcnt vmcnt(0)
    s_cbranch_scc1 sequential_preLN__sliding_block__mixer_token_mlp__prompt_kernel_g1r3
    v_max_u32 v22, v159, v163
    v_cmp_eq_u32 vcc, -1, v22
    s_cbranch_vccnz sequential_preLN__sliding_block__mixer_token_mlp__prompt_kernel_g1s3
    s_branch sequential_preLN__sliding_block__mixer_token_mlp__prompt_kernel_g1r3
sequential_preLN__sliding_block__mixer_token_mlp__prompt_kernel_g1s4:
    s_add_u32 s42, s92, 2
    s_and_b32 s42, s42, 15
    s_mul_i32 s42, s42, 3584
    buffer_load_dwordx4 v[164:167], v7, s[12:15], s42 offen offset:0 sc1
    buffer_load_dwordx4 v[168:171], v8, s[12:15], s42 offen offset:0 sc1
    buffer_load_dwordx4 v[172:175], v7, s[12:15], s42 offen offset:1792 sc1
    buffer_load_dwordx4 v[176:179], v8, s[12:15], s42 offen offset:1792 sc1
    s_add_u32 s42, s92, 3
    s_and_b32 s42, s42, 15
    s_mul_i32 s42, s42, 3584
    buffer_load_dwordx4 v[180:183], v7, s[12:15], s42 offen offset:0 sc1
    buffer_load_dwordx4 v[184:187], v8, s[12:15], s42 offen offset:0 sc1
    buffer_load_dwordx4 v[188:191], v7, s[12:15], s42 offen offset:1792 sc1
    buffer_load_dwordx4 v[192:195], v8, s[12:15], s42 offen offset:1792 sc1
    s_add_u32 s42, s92, 4
    s_and_b32 s42, s42, 15
    s_mul_i32 s42, s42, 3584
    buffer_load_dwordx4 v[196:199], v7, s[12:15], s42 offen offset:0 sc1
    buffer_load_dwordx4 v[200:203], v8, s[12:15], s42 offen offset:0 sc1
    buffer_load_dwordx4 v[204:207], v7, s[12:15], s42 offen offset:1792 sc1
    buffer_load_dwordx4 v[208:211], v8, s[12:15], s42 offen offset:1792 sc1
    s_add_u32 s42, s92, 5
    s_and_b32 s42, s42, 15
    s_mul_i32 s42, s42, 3584
    buffer_load_dwordx4 v[212:215], v7, s[12:15], s42 offen offset:0 sc1
    buffer_load_dwordx4 v[216:219], v8, s[12:15], s42 offen offset:0 sc1
    s_add_u32 s49, s49, 1
    s_cmp_ge_u32 s49, 20000
    s_waitcnt vmcnt(0)
    s_cbranch_scc1 sequential_preLN__sliding_block__mixer_token_mlp__prompt_kernel_g1r4
    v_max_u32 v22, v167, v171
    v_cmp_eq_u32 vcc, -1, v22
    s_cbranch_vccnz sequential_preLN__sliding_block__mixer_token_mlp__prompt_kernel_g1s4
    s_branch sequential_preLN__sliding_block__mixer_token_mlp__prompt_kernel_g1r4
sequential_preLN__sliding_block__mixer_token_mlp__prompt_kernel_g1s5:
    s_add_u32 s42, s92, 2
    s_and_b32 s42, s42, 15
    s_mul_i32 s42, s42, 3584
    buffer_load_dwordx4 v[172:175], v7, s[12:15], s42 offen offset:1792 sc1
    buffer_load_dwordx4 v[176:179], v8, s[12:15], s42 offen offset:1792 sc1
    s_add_u32 s42, s92, 3
    s_and_b32 s42, s42, 15
    s_mul_i32 s42, s42, 3584
    buffer_load_dwordx4 v[180:183], v7, s[12:15], s42 offen offset:0 sc1
    buffer_load_dwordx4 v[184:187], v8, s[12:15], s42 offen offset:0 sc1
    buffer_load_dwordx4 v[188:191], v7, s[12:15], s42 offen offset:1792 sc1
    buffer_load_dwordx4 v[192:195], v8, s[12:15], s42 offen offset:1792 sc1
    s_add_u32 s42, s92, 4
    s_and_b32 s42, s42, 15
    s_mul_i32 s42, s42, 3584
    buffer_load_dwordx4 v[196:199], v7, s[12:15], s42 offen offset:0 sc1
    buffer_load_dwordx4 v[200:203], v8, s[12:15], s42 offen offset:0 sc1
    buffer_load_dwordx4 v[204:207], v7, s[12:15], s42 offen offset:1792 sc1
    buffer_load_dwordx4 v[208:211], v8, s[12:15], s42 offen offset:1792 sc1
    s_add_u32 s42, s92, 5
    s_and_b32 s42, s42, 15
    s_mul_i32 s42, s42, 3584
    buffer_load_dwordx4 v[212:215], v7, s[12:15], s42 offen offset:0 sc1
    buffer_load_dwordx4 v[216:219], v8, s[12:15], s42 offen offset:0 sc1
    buffer_load_dwordx4 v[220:223], v7, s[12:15], s42 offen offset:1792 sc1
    buffer_load_dwordx4 v[224:227], v8, s[12:15], s42 offen offset:1792 sc1
    s_add_u32 s42, s92, 6
    s_and_b32 s42, s42, 15
    s_mul_i32 s42, s42, 3584
    buffer_load_dwordx4 v[132:135], v7, s[12:15], s42 offen offset:0 sc1
    buffer_load_dwordx4 v[136:139], v8, s[12:15], s42 offen offset:0 sc1
    s_add_u32 s49, s49, 1
    s_cmp_ge_u32 s49, 20000
    s_waitcnt vmcnt(0)
    s_cbranch_scc1 sequential_preLN__sliding_block__mixer_token_mlp__prompt_kernel_g1r5
    v_max_u32 v22, v175, v179
    v_cmp_eq_u32 vcc, -1, v22
    s_cbranch_vccnz sequential_preLN__sliding_block__mixer_token_mlp__prompt_kernel_g1s5
    s_branch sequential_preLN__sliding_block__mixer_token_mlp__prompt_kernel_g1r5
sequential_preLN__sliding_block__mixer_token_mlp__prompt_kernel_g1s6:
    s_add_u32 s42, s92, 3
    s_and_b32 s42, s42, 15
    s_mul_i32 s42, s42, 3584
    buffer_load_dwordx4 v[180:183], v7, s[12:15], s42 offen offset:0 sc1
    buffer_load_dwordx4 v[184:187], v8, s[12:15], s42 offen offset:0 sc1
    buffer_load_dwordx4 v[188:191], v7, s[12:15], s42 offen offset:1792 sc1
    buffer_load_dwordx4 v[192:195], v8, s[12:15], s42 offen offset:1792 sc1
    s_add_u32 s42, s92, 4
    s_and_b32 s42, s42, 15
    s_mul_i32 s42, s42, 3584
    buffer_load_dwordx4 v[196:199], v7, s[12:15], s42 offen offset:0 sc1
    buffer_load_dwordx4 v[200:203], v8, s[12:15], s42 offen offset:0 sc1
    buffer_load_dwordx4 v[204:207], v7, s[12:15], s42 offen offset:1792 sc1
    buffer_load_dwordx4 v[208:211], v8, s[12:15], s42 offen offset:1792 sc1
    s_add_u32 s42, s92, 5
    s_and_b32 s42, s42, 15
    s_mul_i32 s42, s42, 3584
    buffer_load_dwordx4 v[212:215], v7, s[12:15], s42 offen offset:0 sc1
    buffer_load_dwordx4 v[216:219], v8, s[12:15], s42 offen offset:0 sc1
    buffer_load_dwordx4 v[220:223], v7, s[12:15], s42 offen offset:1792 sc1
    buffer_load_dwordx4 v[224:227], v8, s[12:15], s42 offen offset:1792 sc1
    s_add_u32 s42, s92, 6
    s_and_b32 s42, s42, 15
    s_mul_i32 s42, s42, 3584
    buffer_load_dwordx4 v[132:135], v7, s[12:15], s42 offen offset:0 sc1
    buffer_load_dwordx4 v[136:139], v8, s[12:15], s42 offen offset:0 sc1
    buffer_load_dwordx4 v[140:143], v7, s[12:15], s42 offen offset:1792 sc1
    buffer_load_dwordx4 v[144:147], v8, s[12:15], s42 offen offset:1792 sc1
    s_add_u32 s42, s92, 7
    s_and_b32 s42, s42, 15
    s_mul_i32 s42, s42, 3584
    buffer_load_dwordx4 v[148:151], v7, s[12:15], s42 offen offset:0 sc1
    buffer_load_dwordx4 v[152:155], v8, s[12:15], s42 offen offset:0 sc1
    s_add_u32 s49, s49, 1
    s_cmp_ge_u32 s49, 20000
    s_waitcnt vmcnt(0)
    s_cbranch_scc1 sequential_preLN__sliding_block__mixer_token_mlp__prompt_kernel_g1r6
    v_max_u32 v22, v183, v187
    v_cmp_eq_u32 vcc, -1, v22
    s_cbranch_vccnz sequential_preLN__sliding_block__mixer_token_mlp__prompt_kernel_g1s6
    s_branch sequential_preLN__sliding_block__mixer_token_mlp__prompt_kernel_g1r6
sequential_preLN__sliding_block__mixer_token_mlp__prompt_kernel_g1s7:
    s_add_u32 s42, s92, 3
    s_and_b32 s42, s42, 15
    s_mul_i32 s42, s42, 3584
    buffer_load_dwordx4 v[188:191], v7, s[12:15], s42 offen offset:1792 sc1
    buffer_load_dwordx4 v[192:195], v8, s[12:15], s42 offen offset:1792 sc1
    s_add_u32 s42, s92, 4
    s_and_b32 s42, s42, 15
    s_mul_i32 s42, s42, 3584
    buffer_load_dwordx4 v[196:199], v7, s[12:15], s42 offen offset:0 sc1
    buffer_load_dwordx4 v[200:203], v8, s[12:15], s42 offen offset:0 sc1
    buffer_load_dwordx4 v[204:207], v7, s[12:15], s42 offen offset:1792 sc1
    buffer_load_dwordx4 v[208:211], v8, s[12:15], s42 offen offset:1792 sc1
    s_add_u32 s42, s92, 5
    s_and_b32 s42, s42, 15
    s_mul_i32 s42, s42, 3584
    buffer_load_dwordx4 v[212:215], v7, s[12:15], s42 offen offset:0 sc1
    buffer_load_dwordx4 v[216:219], v8, s[12:15], s42 offen offset:0 sc1
    buffer_load_dwordx4 v[220:223], v7, s[12:15], s42 offen offset:1792 sc1
    buffer_load_dwordx4 v[224:227], v8, s[12:15], s42 offen offset:1792 sc1
    s_add_u32 s42, s92, 6
    s_and_b32 s42, s42, 15
    s_mul_i32 s42, s42, 3584
    buffer_load_dwordx4 v[132:135], v7, s[12:15], s42 offen offset:0 sc1
    buffer_load_dwordx4 v[136:139], v8, s[12:15], s42 offen offset:0 sc1
    buffer_load_dwordx4 v[140:143], v7, s[12:15], s42 offen offset:1792 sc1
    buffer_load_dwordx4 v[144:147], v8, s[12:15], s42 offen offset:1792 sc1
    s_add_u32 s42, s92, 7
    s_and_b32 s42, s42, 15
    s_mul_i32 s42, s42, 3584
    buffer_load_dwordx4 v[148:151], v7, s[12:15], s42 offen offset:0 sc1
    buffer_load_dwordx4 v[152:155], v8, s[12:15], s42 offen offset:0 sc1
    buffer_load_dwordx4 v[156:159], v7, s[12:15], s42 offen offset:1792 sc1
    buffer_load_dwordx4 v[160:163], v8, s[12:15], s42 offen offset:1792 sc1
    s_add_u32 s42, s92, 8
    s_and_b32 s42, s42, 15
    s_mul_i32 s42, s42, 3584
    buffer_load_dwordx4 v[164:167], v7, s[12:15], s42 offen offset:0 sc1
    buffer_load_dwordx4 v[168:171], v8, s[12:15], s42 offen offset:0 sc1
    s_add_u32 s49, s49, 1
    s_cmp_ge_u32 s49, 20000
    s_waitcnt vmcnt(0)
    s_cbranch_scc1 sequential_preLN__sliding_block__mixer_token_mlp__prompt_kernel_g1r7
    v_max_u32 v22, v191, v195
    v_cmp_eq_u32 vcc, -1, v22
    s_cbranch_vccnz sequential_preLN__sliding_block__mixer_token_mlp__prompt_kernel_g1s7
    s_branch sequential_preLN__sliding_block__mixer_token_mlp__prompt_kernel_g1r7
sequential_preLN__sliding_block__mixer_token_mlp__prompt_kernel_g1s8:
    s_add_u32 s42, s92, 4
    s_and_b32 s42, s42, 15
    s_mul_i32 s42, s42, 3584
    buffer_load_dwordx4 v[196:199], v7, s[12:15], s42 offen offset:0 sc1
    buffer_load_dwordx4 v[200:203], v8, s[12:15], s42 offen offset:0 sc1
    buffer_load_dwordx4 v[204:207], v7, s[12:15], s42 offen offset:1792 sc1
    buffer_load_dwordx4 v[208:211], v8, s[12:15], s42 offen offset:1792 sc1
    s_add_u32 s42, s92, 5
    s_and_b32 s42, s42, 15
    s_mul_i32 s42, s42, 3584
    buffer_load_dwordx4 v[212:215], v7, s[12:15], s42 offen offset:0 sc1
    buffer_load_dwordx4 v[216:219], v8, s[12:15], s42 offen offset:0 sc1
    buffer_load_dwordx4 v[220:223], v7, s[12:15], s42 offen offset:1792 sc1
    buffer_load_dwordx4 v[224:227], v8, s[12:15], s42 offen offset:1792 sc1
    s_add_u32 s42, s92, 6
    s_and_b32 s42, s42, 15
    s_mul_i32 s42, s42, 3584
    buffer_load_dwordx4 v[132:135], v7, s[12:15], s42 offen offset:0 sc1
    buffer_load_dwordx4 v[136:139], v8, s[12:15], s42 offen offset:0 sc1
    buffer_load_dwordx4 v[140:143], v7, s[12:15], s42 offen offset:1792 sc1
    buffer_load_dwordx4 v[144:147], v8, s[12:15], s42 offen offset:1792 sc1
    s_add_u32 s42, s92, 7
    s_and_b32 s42, s42, 15
    s_mul_i32 s42, s42, 3584
    buffer_load_dwordx4 v[148:151], v7, s[12:15], s42 offen offset:0 sc1
    buffer_load_dwordx4 v[152:155], v8, s[12:15], s42 offen offset:0 sc1
    buffer_load_dwordx4 v[156:159], v7, s[12:15], s42 offen offset:1792 sc1
    buffer_load_dwordx4 v[160:163], v8, s[12:15], s42 offen offset:1792 sc1
    s_add_u32 s42, s92, 8
    s_and_b32 s42, s42, 15
    s_mul_i32 s42, s42, 3584
    buffer_load_dwordx4 v[164:167], v7, s[12:15], s42 offen offset:0 sc1
    buffer_load_dwordx4 v[168:171], v8, s[12:15], s42 offen offset:0 sc1
    buffer_load_dwordx4 v[172:175], v7, s[12:15], s42 offen offset:1792 sc1
    buffer_load_dwordx4 v[176:179], v8, s[12:15], s42 offen offset:1792 sc1
    s_add_u32 s42, s92, 9
    s_and_b32 s42, s42, 15
    s_mul_i32 s42, s42, 3584
    buffer_load_dwordx4 v[180:183], v7, s[12:15], s42 offen offset:0 sc1
    buffer_load_dwordx4 v[184:187], v8, s[12:15], s42 offen offset:0 sc1
    s_add_u32 s49, s49, 1
    s_cmp_ge_u32 s49, 20000
    s_waitcnt vmcnt(0)
    s_cbranch_scc1 sequential_preLN__sliding_block__mixer_token_mlp__prompt_kernel_g1r8
    v_max_u32 v22, v199, v203
    v_cmp_eq_u32 vcc, -1, v22
    s_cbranch_vccnz sequential_preLN__sliding_block__mixer_token_mlp__prompt_kernel_g1s8
    s_branch sequential_preLN__sliding_block__mixer_token_mlp__prompt_kernel_g1r8
sequential_preLN__sliding_block__mixer_token_mlp__prompt_kernel_g1s9:
    s_add_u32 s42, s92, 4
    s_and_b32 s42, s42, 15
    s_mul_i32 s42, s42, 3584
    buffer_load_dwordx4 v[204:207], v7, s[12:15], s42 offen offset:1792 sc1
    buffer_load_dwordx4 v[208:211], v8, s[12:15], s42 offen offset:1792 sc1
    s_add_u32 s42, s92, 5
    s_and_b32 s42, s42, 15
    s_mul_i32 s42, s42, 3584
    buffer_load_dwordx4 v[212:215], v7, s[12:15], s42 offen offset:0 sc1
    buffer_load_dwordx4 v[216:219], v8, s[12:15], s42 offen offset:0 sc1
    buffer_load_dwordx4 v[220:223], v7, s[12:15], s42 offen offset:1792 sc1
    buffer_load_dwordx4 v[224:227], v8, s[12:15], s42 offen offset:1792 sc1
    s_add_u32 s42, s92, 6
    s_and_b32 s42, s42, 15
    s_mul_i32 s42, s42, 3584
    buffer_load_dwordx4 v[132:135], v7, s[12:15], s42 offen offset:0 sc1
    buffer_load_dwordx4 v[136:139], v8, s[12:15], s42 offen offset:0 sc1
    buffer_load_dwordx4 v[140:143], v7, s[12:15], s42 offen offset:1792 sc1
    buffer_load_dwordx4 v[144:147], v8, s[12:15], s42 offen offset:1792 sc1
    s_add_u32 s42, s92, 7
    s_and_b32 s42, s42, 15
    s_mul_i32 s42, s42, 3584
    buffer_load_dwordx4 v[148:151], v7, s[12:15], s42 offen offset:0 sc1
    buffer_load_dwordx4 v[152:155], v8, s[12:15], s42 offen offset:0 sc1
    buffer_load_dwordx4 v[156:159], v7, s[12:15], s42 offen offset:1792 sc1
    buffer_load_dwordx4 v[160:163], v8, s[12:15], s42 offen offset:1792 sc1
    s_add_u32 s42, s92, 8
    s_and_b32 s42, s42, 15
    s_mul_i32 s42, s42, 3584
    buffer_load_dwordx4 v[164:167], v7, s[12:15], s42 offen offset:0 sc1
    buffer_load_dwordx4 v[168:171], v8, s[12:15], s42 offen offset:0 sc1
    buffer_load_dwordx4 v[172:175], v7, s[12:15], s42 offen offset:1792 sc1
    buffer_load_dwordx4 v[176:179], v8, s[12:15], s42 offen offset:1792 sc1
    s_add_u32 s42, s92, 9
    s_and_b32 s42, s42, 15
    s_mul_i32 s42, s42, 3584
    buffer_load_dwordx4 v[180:183], v7, s[12:15], s42 offen offset:0 sc1
    buffer_load_dwordx4 v[184:187], v8, s[12:15], s42 offen offset:0 sc1
    buffer_load_dwordx4 v[188:191], v7, s[12:15], s42 offen offset:1792 sc1
    buffer_load_dwordx4 v[192:195], v8, s[12:15], s42 offen offset:1792 sc1
    s_add_u32 s49, s49, 1
    s_cmp_ge_u32 s49, 20000
    s_waitcnt vmcnt(0)
    s_cbranch_scc1 sequential_preLN__sliding_block__mixer_token_mlp__prompt_kernel_g1r9
    v_max_u32 v22, v207, v211
    v_cmp_eq_u32 vcc, -1, v22
    s_cbranch_vccnz sequential_preLN__sliding_block__mixer_token_mlp__prompt_kernel_g1s9
    s_branch sequential_preLN__sliding_block__mixer_token_mlp__prompt_kernel_g1r9
sequential_preLN__sliding_block__mixer_token_mlp__prompt_kernel_g1s10:
    s_add_u32 s42, s92, 5
    s_and_b32 s42, s42, 15
    s_mul_i32 s42, s42, 3584
    buffer_load_dwordx4 v[212:215], v7, s[12:15], s42 offen offset:0 sc1
    buffer_load_dwordx4 v[216:219], v8, s[12:15], s42 offen offset:0 sc1
    buffer_load_dwordx4 v[220:223], v7, s[12:15], s42 offen offset:1792 sc1
    buffer_load_dwordx4 v[224:227], v8, s[12:15], s42 offen offset:1792 sc1
    s_add_u32 s42, s92, 6
    s_and_b32 s42, s42, 15
    s_mul_i32 s42, s42, 3584
    buffer_load_dwordx4 v[132:135], v7, s[12:15], s42 offen offset:0 sc1
    buffer_load_dwordx4 v[136:139], v8, s[12:15], s42 offen offset:0 sc1
    buffer_load_dwordx4 v[140:143], v7, s[12:15], s42 offen offset:1792 sc1
    buffer_load_dwordx4 v[144:147], v8, s[12:15], s42 offen offset:1792 sc1
    s_add_u32 s42, s92, 7
    s_and_b32 s42, s42, 15
    s_mul_i32 s42, s42, 3584
    buffer_load_dwordx4 v[148:151], v7, s[12:15], s42 offen offset:0 sc1
    buffer_load_dwordx4 v[152:155], v8, s[12:15], s42 offen offset:0 sc1
    buffer_load_dwordx4 v[156:159], v7, s[12:15], s42 offen offset:1792 sc1
    buffer_load_dwordx4 v[160:163], v8, s[12:15], s42 offen offset:1792 sc1
    s_add_u32 s42, s92, 8
    s_and_b32 s42, s42, 15
    s_mul_i32 s42, s42, 3584
    buffer_load_dwordx4 v[164:167], v7, s[12:15], s42 offen offset:0 sc1
    buffer_load_dwordx4 v[168:171], v8, s[12:15], s42 offen offset:0 sc1
    buffer_load_dwordx4 v[172:175], v7, s[12:15], s42 offen offset:1792 sc1
    buffer_load_dwordx4 v[176:179], v8, s[12:15], s42 offen offset:1792 sc1
    s_add_u32 s42, s92, 9
    s_and_b32 s42, s42, 15
    s_mul_i32 s42, s42, 3584
    buffer_load_dwordx4 v[180:183], v7, s[12:15], s42 offen offset:0 sc1
    buffer_load_dwordx4 v[184:187], v8, s[12:15], s42 offen offset:0 sc1
    buffer_load_dwordx4 v[188:191], v7, s[12:15], s42 offen offset:1792 sc1
    buffer_load_dwordx4 v[192:195], v8, s[12:15], s42 offen offset:1792 sc1
    s_add_u32 s42, s92, 10
    s_and_b32 s42, s42, 15
    s_mul_i32 s42, s42, 3584
    buffer_load_dwordx4 v[196:199], v7, s[12:15], s42 offen offset:0 sc1
    buffer_load_dwordx4 v[200:203], v8, s[12:15], s42 offen offset:0 sc1
    s_add_u32 s49, s49, 1
    s_cmp_ge_u32 s49, 20000
    s_waitcnt vmcnt(0)
    s_cbranch_scc1 sequential_preLN__sliding_block__mixer_token_mlp__prompt_kernel_g1r10
    v_max_u32 v22, v215, v219
    v_cmp_eq_u32 vcc, -1, v22
    s_cbranch_vccnz sequential_preLN__sliding_block__mixer_token_mlp__prompt_kernel_g1s10
    s_branch sequential_preLN__sliding_block__mixer_token_mlp__prompt_kernel_g1r10
sequential_preLN__sliding_block__mixer_token_mlp__prompt_kernel_g1s11:
    s_add_u32 s42, s92, 5
    s_and_b32 s42, s42, 15
    s_mul_i32 s42, s42, 3584
    buffer_load_dwordx4 v[220:223], v7, s[12:15], s42 offen offset:1792 sc1
    buffer_load_dwordx4 v[224:227], v8, s[12:15], s42 offen offset:1792 sc1
    s_add_u32 s42, s92, 6
    s_and_b32 s42, s42, 15
    s_mul_i32 s42, s42, 3584
    buffer_load_dwordx4 v[132:135], v7, s[12:15], s42 offen offset:0 sc1
    buffer_load_dwordx4 v[136:139], v8, s[12:15], s42 offen offset:0 sc1
    buffer_load_dwordx4 v[140:143], v7, s[12:15], s42 offen offset:1792 sc1
    buffer_load_dwordx4 v[144:147], v8, s[12:15], s42 offen offset:1792 sc1
    s_add_u32 s42, s92, 7
    s_and_b32 s42, s42, 15
    s_mul_i32 s42, s42, 3584
    buffer_load_dwordx4 v[148:151], v7, s[12:15], s42 offen offset:0 sc1
    buffer_load_dwordx4 v[152:155], v8, s[12:15], s42 offen offset:0 sc1
    buffer_load_dwordx4 v[156:159], v7, s[12:15], s42 offen offset:1792 sc1
    buffer_load_dwordx4 v[160:163], v8, s[12:15], s42 offen offset:1792 sc1
    s_add_u32 s42, s92, 8
    s_and_b32 s42, s42, 15
    s_mul_i32 s42, s42, 3584
    buffer_load_dwordx4 v[164:167], v7, s[12:15], s42 offen offset:0 sc1
    buffer_load_dwordx4 v[168:171], v8, s[12:15], s42 offen offset:0 sc1
    buffer_load_dwordx4 v[172:175], v7, s[12:15], s42 offen offset:1792 sc1
    buffer_load_dwordx4 v[176:179], v8, s[12:15], s42 offen offset:1792 sc1
    s_add_u32 s42, s92, 9
    s_and_b32 s42, s42, 15
    s_mul_i32 s42, s42, 3584
    buffer_load_dwordx4 v[180:183], v7, s[12:15], s42 offen offset:0 sc1
    buffer_load_dwordx4 v[184:187], v8, s[12:15], s42 offen offset:0 sc1
    buffer_load_dwordx4 v[188:191], v7, s[12:15], s42 offen offset:1792 sc1
    buffer_load_dwordx4 v[192:195], v8, s[12:15], s42 offen offset:1792 sc1
    s_add_u32 s42, s92, 10
    s_and_b32 s42, s42, 15
    s_mul_i32 s42, s42, 3584
    buffer_load_dwordx4 v[196:199], v7, s[12:15], s42 offen offset:0 sc1
    buffer_load_dwordx4 v[200:203], v8, s[12:15], s42 offen offset:0 sc1
    buffer_load_dwordx4 v[204:207], v7, s[12:15], s42 offen offset:1792 sc1
    buffer_load_dwordx4 v[208:211], v8, s[12:15], s42 offen offset:1792 sc1
    s_add_u32 s49, s49, 1
    s_cmp_ge_u32 s49, 20000
    s_waitcnt vmcnt(0)
    s_cbranch_scc1 sequential_preLN__sliding_block__mixer_token_mlp__prompt_kernel_g1r11
    v_max_u32 v22, v223, v227
    v_cmp_eq_u32 vcc, -1, v22
    s_cbranch_vccnz sequential_preLN__sliding_block__mixer_token_mlp__prompt_kernel_g1s11
    s_branch sequential_preLN__sliding_block__mixer_token_mlp__prompt_kernel_g1r11
sequential_preLN__sliding_block__mixer_token_mlp__prompt_kernel_g1s12:
    s_add_u32 s42, s92, 6
    s_and_b32 s42, s42, 15
    s_mul_i32 s42, s42, 3584
    buffer_load_dwordx4 v[132:135], v7, s[12:15], s42 offen offset:0 sc1
    buffer_load_dwordx4 v[136:139], v8, s[12:15], s42 offen offset:0 sc1
    buffer_load_dwordx4 v[140:143], v7, s[12:15], s42 offen offset:1792 sc1
    buffer_load_dwordx4 v[144:147], v8, s[12:15], s42 offen offset:1792 sc1
    s_add_u32 s42, s92, 7
    s_and_b32 s42, s42, 15
    s_mul_i32 s42, s42, 3584
    buffer_load_dwordx4 v[148:151], v7, s[12:15], s42 offen offset:0 sc1
    buffer_load_dwordx4 v[152:155], v8, s[12:15], s42 offen offset:0 sc1
    buffer_load_dwordx4 v[156:159], v7, s[12:15], s42 offen offset:1792 sc1
    buffer_load_dwordx4 v[160:163], v8, s[12:15], s42 offen offset:1792 sc1
    s_add_u32 s42, s92, 8
    s_and_b32 s42, s42, 15
    s_mul_i32 s42, s42, 3584
    buffer_load_dwordx4 v[164:167], v7, s[12:15], s42 offen offset:0 sc1
    buffer_load_dwordx4 v[168:171], v8, s[12:15], s42 offen offset:0 sc1
    buffer_load_dwordx4 v[172:175], v7, s[12:15], s42 offen offset:1792 sc1
    buffer_load_dwordx4 v[176:179], v8, s[12:15], s42 offen offset:1792 sc1
    s_add_u32 s42, s92, 9
    s_and_b32 s42, s42, 15
    s_mul_i32 s42, s42, 3584
    buffer_load_dwordx4 v[180:183], v7, s[12:15], s42 offen offset:0 sc1
    buffer_load_dwordx4 v[184:187], v8, s[12:15], s42 offen offset:0 sc1
    buffer_load_dwordx4 v[188:191], v7, s[12:15], s42 offen offset:1792 sc1
    buffer_load_dwordx4 v[192:195], v8, s[12:15], s42 offen offset:1792 sc1
    s_add_u32 s42, s92, 10
    s_and_b32 s42, s42, 15
    s_mul_i32 s42, s42, 3584
    buffer_load_dwordx4 v[196:199], v7, s[12:15], s42 offen offset:0 sc1
    buffer_load_dwordx4 v[200:203], v8, s[12:15], s42 offen offset:0 sc1
    buffer_load_dwordx4 v[204:207], v7, s[12:15], s42 offen offset:1792 sc1
    buffer_load_dwordx4 v[208:211], v8, s[12:15], s42 offen offset:1792 sc1
    s_add_u32 s42, s92, 11
    s_and_b32 s42, s42, 15
    s_mul_i32 s42, s42, 3584
    buffer_load_dwordx4 v[212:215], v7, s[12:15], s42 offen offset:0 sc1
    buffer_load_dwordx4 v[216:219], v8, s[12:15], s42 offen offset:0 sc1
    s_add_u32 s49, s49, 1
    s_cmp_ge_u32 s49, 20000
    s_waitcnt vmcnt(0)
    s_cbranch_scc1 sequential_preLN__sliding_block__mixer_token_mlp__prompt_kernel_g1r12
    v_max_u32 v22, v135, v139
    v_cmp_eq_u32 vcc, -1, v22
    s_cbranch_vccnz sequential_preLN__sliding_block__mixer_token_mlp__prompt_kernel_g1s12
    s_branch sequential_preLN__sliding_block__mixer_token_mlp__prompt_kernel_g1r12
sequential_preLN__sliding_block__mixer_token_mlp__prompt_kernel_g1s13:
    s_add_u32 s42, s92, 6
    s_and_b32 s42, s42, 15
    s_mul_i32 s42, s42, 3584
    buffer_load_dwordx4 v[140:143], v7, s[12:15], s42 offen offset:1792 sc1
    buffer_load_dwordx4 v[144:147], v8, s[12:15], s42 offen offset:1792 sc1
    s_add_u32 s42, s92, 7
    s_and_b32 s42, s42, 15
    s_mul_i32 s42, s42, 3584
    buffer_load_dwordx4 v[148:151], v7, s[12:15], s42 offen offset:0 sc1
    buffer_load_dwordx4 v[152:155], v8, s[12:15], s42 offen offset:0 sc1
    buffer_load_dwordx4 v[156:159], v7, s[12:15], s42 offen offset:1792 sc1
    buffer_load_dwordx4 v[160:163], v8, s[12:15], s42 offen offset:1792 sc1
    s_add_u32 s42, s92, 8
    s_and_b32 s42, s42, 15
    s_mul_i32 s42, s42, 3584
    buffer_load_dwordx4 v[164:167], v7, s[12:15], s42 offen offset:0 sc1
    buffer_load_dwordx4 v[168:171], v8, s[12:15], s42 offen offset:0 sc1
    buffer_load_dwordx4 v[172:175], v7, s[12:15], s42 offen offset:1792 sc1
    buffer_load_dwordx4 v[176:179], v8, s[12:15], s42 offen offset:1792 sc1
    s_add_u32 s42, s92, 9
    s_and_b32 s42, s42, 15
    s_mul_i32 s42, s42, 3584
    buffer_load_dwordx4 v[180:183], v7, s[12:15], s42 offen offset:0 sc1
    buffer_load_dwordx4 v[184:187], v8, s[12:15], s42 offen offset:0 sc1
    buffer_load_dwordx4 v[188:191], v7, s[12:15], s42 offen offset:1792 sc1
    buffer_load_dwordx4 v[192:195], v8, s[12:15], s42 offen offset:1792 sc1
    s_add_u32 s42, s92, 10
    s_and_b32 s42, s42, 15
    s_mul_i32 s42, s42, 3584
    buffer_load_dwordx4 v[196:199], v7, s[12:15], s42 offen offset:0 sc1
    buffer_load_dwordx4 v[200:203], v8, s[12:15], s42 offen offset:0 sc1
    buffer_load_dwordx4 v[204:207], v7, s[12:15], s42 offen offset:1792 sc1
    buffer_load_dwordx4 v[208:211], v8, s[12:15], s42 offen offset:1792 sc1
    s_add_u32 s42, s92, 11
    s_and_b32 s42, s42, 15
    s_mul_i32 s42, s42, 3584
    buffer_load_dwordx4 v[212:215], v7, s[12:15], s42 offen offset:0 sc1
    buffer_load_dwordx4 v[216:219], v8, s[12:15], s42 offen offset:0 sc1
    buffer_load_dwordx4 v[220:223], v7, s[12:15], s42 offen offset:1792 sc1
    buffer_load_dwordx4 v[224:227], v8, s[12:15], s42 offen offset:1792 sc1
    s_add_u32 s49, s49, 1
    s_cmp_ge_u32 s49, 20000
    s_waitcnt vmcnt(0)
    s_cbranch_scc1 sequential_preLN__sliding_block__mixer_token_mlp__prompt_kernel_g1r13
    v_max_u32 v22, v143, v147
    v_cmp_eq_u32 vcc, -1, v22
    s_cbranch_vccnz sequential_preLN__sliding_block__mixer_token_mlp__prompt_kernel_g1s13
    s_branch sequential_preLN__sliding_block__mixer_token_mlp__prompt_kernel_g1r13
sequential_preLN__sliding_block__mixer_token_mlp__prompt_kernel_g1s14:
    s_add_u32 s42, s92, 7
    s_and_b32 s42, s42, 15
    s_mul_i32 s42, s42, 3584
    buffer_load_dwordx4 v[148:151], v7, s[12:15], s42 offen offset:0 sc1
    buffer_load_dwordx4 v[152:155], v8, s[12:15], s42 offen offset:0 sc1
    buffer_load_dwordx4 v[156:159], v7, s[12:15], s42 offen offset:1792 sc1
    buffer_load_dwordx4 v[160:163], v8, s[12:15], s42 offen offset:1792 sc1
    s_add_u32 s42, s92, 8
    s_and_b32 s42, s42, 15
    s_mul_i32 s42, s42, 3584
    buffer_load_dwordx4 v[164:167], v7, s[12:15], s42 offen offset:0 sc1
    buffer_load_dwordx4 v[168:171], v8, s[12:15], s42 offen offset:0 sc1
    buffer_load_dwordx4 v[172:175], v7, s[12:15], s42 offen offset:1792 sc1
    buffer_load_dwordx4 v[176:179], v8, s[12:15], s42 offen offset:1792 sc1
    s_add_u32 s42, s92, 9
    s_and_b32 s42, s42, 15
    s_mul_i32 s42, s42, 3584
    buffer_load_dwordx4 v[180:183], v7, s[12:15], s42 offen offset:0 sc1
    buffer_load_dwordx4 v[184:187], v8, s[12:15], s42 offen offset:0 sc1
    buffer_load_dwordx4 v[188:191], v7, s[12:15], s42 offen offset:1792 sc1
    buffer_load_dwordx4 v[192:195], v8, s[12:15], s42 offen offset:1792 sc1
    s_add_u32 s42, s92, 10
    s_and_b32 s42, s42, 15
    s_mul_i32 s42, s42, 3584
    buffer_load_dwordx4 v[196:199], v7, s[12:15], s42 offen offset:0 sc1
    buffer_load_dwordx4 v[200:203], v8, s[12:15], s42 offen offset:0 sc1
    buffer_load_dwordx4 v[204:207], v7, s[12:15], s42 offen offset:1792 sc1
    buffer_load_dwordx4 v[208:211], v8, s[12:15], s42 offen offset:1792 sc1
    s_add_u32 s42, s92, 11
    s_and_b32 s42, s42, 15
    s_mul_i32 s42, s42, 3584
    buffer_load_dwordx4 v[212:215], v7, s[12:15], s42 offen offset:0 sc1
    buffer_load_dwordx4 v[216:219], v8, s[12:15], s42 offen offset:0 sc1
    buffer_load_dwordx4 v[220:223], v7, s[12:15], s42 offen offset:1792 sc1
    buffer_load_dwordx4 v[224:227], v8, s[12:15], s42 offen offset:1792 sc1
    s_add_u32 s42, s92, 12
    s_and_b32 s42, s42, 15
    s_mul_i32 s42, s42, 3584
    buffer_load_dwordx4 v[132:135], v7, s[12:15], s42 offen offset:0 sc1
    buffer_load_dwordx4 v[136:139], v8, s[12:15], s42 offen offset:0 sc1
    s_add_u32 s49, s49, 1
    s_cmp_ge_u32 s49, 20000
    s_waitcnt vmcnt(0)
    s_cbranch_scc1 sequential_preLN__sliding_block__mixer_token_mlp__prompt_kernel_g1r14
    v_max_u32 v22, v151, v155
    v_cmp_eq_u32 vcc, -1, v22
    s_cbranch_vccnz sequential_preLN__sliding_block__mixer_token_mlp__prompt_kernel_g1s14
    s_branch sequential_preLN__sliding_block__mixer_token_mlp__prompt_kernel_g1r14
sequential_preLN__sliding_block__mixer_token_mlp__prompt_kernel_g1s15:
    s_add_u32 s42, s92, 7
    s_and_b32 s42, s42, 15
    s_mul_i32 s42, s42, 3584
    buffer_load_dwordx4 v[156:159], v7, s[12:15], s42 offen offset:1792 sc1
    buffer_load_dwordx4 v[160:163], v8, s[12:15], s42 offen offset:1792 sc1
    s_add_u32 s42, s92, 8
    s_and_b32 s42, s42, 15
    s_mul_i32 s42, s42, 3584
    buffer_load_dwordx4 v[164:167], v7, s[12:15], s42 offen offset:0 sc1
    buffer_load_dwordx4 v[168:171], v8, s[12:15], s42 offen offset:0 sc1
    buffer_load_dwordx4 v[172:175], v7, s[12:15], s42 offen offset:1792 sc1
    buffer_load_dwordx4 v[176:179], v8, s[12:15], s42 offen offset:1792 sc1
    s_add_u32 s42, s92, 9
    s_and_b32 s42, s42, 15
    s_mul_i32 s42, s42, 3584
    buffer_load_dwordx4 v[180:183], v7, s[12:15], s42 offen offset:0 sc1
    buffer_load_dwordx4 v[184:187], v8, s[12:15], s42 offen offset:0 sc1
    buffer_load_dwordx4 v[188:191], v7, s[12:15], s42 offen offset:1792 sc1
    buffer_load_dwordx4 v[192:195], v8, s[12:15], s42 offen offset:1792 sc1
    s_add_u32 s42, s92, 10
    s_and_b32 s42, s42, 15
    s_mul_i32 s42, s42, 3584
    buffer_load_dwordx4 v[196:199], v7, s[12:15], s42 offen offset:0 sc1
    buffer_load_dwordx4 v[200:203], v8, s[12:15], s42 offen offset:0 sc1
    buffer_load_dwordx4 v[204:207], v7, s[12:15], s42 offen offset:1792 sc1
    buffer_load_dwordx4 v[208:211], v8, s[12:15], s42 offen offset:1792 sc1
    s_add_u32 s42, s92, 11
    s_and_b32 s42, s42, 15
    s_mul_i32 s42, s42, 3584
    buffer_load_dwordx4 v[212:215], v7, s[12:15], s42 offen offset:0 sc1
    buffer_load_dwordx4 v[216:219], v8, s[12:15], s42 offen offset:0 sc1
    buffer_load_dwordx4 v[220:223], v7, s[12:15], s42 offen offset:1792 sc1
    buffer_load_dwordx4 v[224:227], v8, s[12:15], s42 offen offset:1792 sc1
    s_add_u32 s42, s92, 12
    s_and_b32 s42, s42, 15
    s_mul_i32 s42, s42, 3584
    buffer_load_dwordx4 v[132:135], v7, s[12:15], s42 offen offset:0 sc1
    buffer_load_dwordx4 v[136:139], v8, s[12:15], s42 offen offset:0 sc1
    buffer_load_dwordx4 v[140:143], v7, s[12:15], s42 offen offset:1792 sc1
    buffer_load_dwordx4 v[144:147], v8, s[12:15], s42 offen offset:1792 sc1
    s_add_u32 s49, s49, 1
    s_cmp_ge_u32 s49, 20000
    s_waitcnt vmcnt(0)
    s_cbranch_scc1 sequential_preLN__sliding_block__mixer_token_mlp__prompt_kernel_g1r15
    v_max_u32 v22, v159, v163
    v_cmp_eq_u32 vcc, -1, v22
    s_cbranch_vccnz sequential_preLN__sliding_block__mixer_token_mlp__prompt_kernel_g1s15
    s_branch sequential_preLN__sliding_block__mixer_token_mlp__prompt_kernel_g1r15
sequential_preLN__sliding_block__mixer_token_mlp__prompt_kernel_g1s16:
    s_add_u32 s42, s92, 8
    s_and_b32 s42, s42, 15
    s_mul_i32 s42, s42, 3584
    buffer_load_dwordx4 v[164:167], v7, s[12:15], s42 offen offset:0 sc1
    buffer_load_dwordx4 v[168:171], v8, s[12:15], s42 offen offset:0 sc1
    buffer_load_dwordx4 v[172:175], v7, s[12:15], s42 offen offset:1792 sc1
    buffer_load_dwordx4 v[176:179], v8, s[12:15], s42 offen offset:1792 sc1
    s_add_u32 s42, s92, 9
    s_and_b32 s42, s42, 15
    s_mul_i32 s42, s42, 3584
    buffer_load_dwordx4 v[180:183], v7, s[12:15], s42 offen offset:0 sc1
    buffer_load_dwordx4 v[184:187], v8, s[12:15], s42 offen offset:0 sc1
    buffer_load_dwordx4 v[188:191], v7, s[12:15], s42 offen offset:1792 sc1
    buffer_load_dwordx4 v[192:195], v8, s[12:15], s42 offen offset:1792 sc1
    s_add_u32 s42, s92, 10
    s_and_b32 s42, s42, 15
    s_mul_i32 s42, s42, 3584
    buffer_load_dwordx4 v[196:199], v7, s[12:15], s42 offen offset:0 sc1
    buffer_load_dwordx4 v[200:203], v8, s[12:15], s42 offen offset:0 sc1
    buffer_load_dwordx4 v[204:207], v7, s[12:15], s42 offen offset:1792 sc1
    buffer_load_dwordx4 v[208:211], v8, s[12:15], s42 offen offset:1792 sc1
    s_add_u32 s42, s92, 11
    s_and_b32 s42, s42, 15
    s_mul_i32 s42, s42, 3584
    buffer_load_dwordx4 v[212:215], v7, s[12:15], s42 offen offset:0 sc1
    buffer_load_dwordx4 v[216:219], v8, s[12:15], s42 offen offset:0 sc1
    buffer_load_dwordx4 v[220:223], v7, s[12:15], s42 offen offset:1792 sc1
    buffer_load_dwordx4 v[224:227], v8, s[12:15], s42 offen offset:1792 sc1
    s_add_u32 s42, s92, 12
    s_and_b32 s42, s42, 15
    s_mul_i32 s42, s42, 3584
    buffer_load_dwordx4 v[132:135], v7, s[12:15], s42 offen offset:0 sc1
    buffer_load_dwordx4 v[136:139], v8, s[12:15], s42 offen offset:0 sc1
    buffer_load_dwordx4 v[140:143], v7, s[12:15], s42 offen offset:1792 sc1
    buffer_load_dwordx4 v[144:147], v8, s[12:15], s42 offen offset:1792 sc1
    s_add_u32 s42, s92, 13
    s_and_b32 s42, s42, 15
    s_mul_i32 s42, s42, 3584
    buffer_load_dwordx4 v[148:151], v7, s[12:15], s42 offen offset:0 sc1
    buffer_load_dwordx4 v[152:155], v8, s[12:15], s42 offen offset:0 sc1
    s_add_u32 s49, s49, 1
    s_cmp_ge_u32 s49, 20000
    s_waitcnt vmcnt(0)
    s_cbranch_scc1 sequential_preLN__sliding_block__mixer_token_mlp__prompt_kernel_g1r16
    v_max_u32 v22, v167, v171
    v_cmp_eq_u32 vcc, -1, v22
    s_cbranch_vccnz sequential_preLN__sliding_block__mixer_token_mlp__prompt_kernel_g1s16
    s_branch sequential_preLN__sliding_block__mixer_token_mlp__prompt_kernel_g1r16
sequential_preLN__sliding_block__mixer_token_mlp__prompt_kernel_g1s17:
    s_add_u32 s42, s92, 8
    s_and_b32 s42, s42, 15
    s_mul_i32 s42, s42, 3584
    buffer_load_dwordx4 v[172:175], v7, s[12:15], s42 offen offset:1792 sc1
    buffer_load_dwordx4 v[176:179], v8, s[12:15], s42 offen offset:1792 sc1
    s_add_u32 s42, s92, 9
    s_and_b32 s42, s42, 15
    s_mul_i32 s42, s42, 3584
    buffer_load_dwordx4 v[180:183], v7, s[12:15], s42 offen offset:0 sc1
    buffer_load_dwordx4 v[184:187], v8, s[12:15], s42 offen offset:0 sc1
    buffer_load_dwordx4 v[188:191], v7, s[12:15], s42 offen offset:1792 sc1
    buffer_load_dwordx4 v[192:195], v8, s[12:15], s42 offen offset:1792 sc1
    s_add_u32 s42, s92, 10
    s_and_b32 s42, s42, 15
    s_mul_i32 s42, s42, 3584
    buffer_load_dwordx4 v[196:199], v7, s[12:15], s42 offen offset:0 sc1
    buffer_load_dwordx4 v[200:203], v8, s[12:15], s42 offen offset:0 sc1
    buffer_load_dwordx4 v[204:207], v7, s[12:15], s42 offen offset:1792 sc1
    buffer_load_dwordx4 v[208:211], v8, s[12:15], s42 offen offset:1792 sc1
    s_add_u32 s42, s92, 11
    s_and_b32 s42, s42, 15
    s_mul_i32 s42, s42, 3584
    buffer_load_dwordx4 v[212:215], v7, s[12:15], s42 offen offset:0 sc1
    buffer_load_dwordx4 v[216:219], v8, s[12:15], s42 offen offset:0 sc1
    buffer_load_dwordx4 v[220:223], v7, s[12:15], s42 offen offset:1792 sc1
    buffer_load_dwordx4 v[224:227], v8, s[12:15], s42 offen offset:1792 sc1
    s_add_u32 s42, s92, 12
    s_and_b32 s42, s42, 15
    s_mul_i32 s42, s42, 3584
    buffer_load_dwordx4 v[132:135], v7, s[12:15], s42 offen offset:0 sc1
    buffer_load_dwordx4 v[136:139], v8, s[12:15], s42 offen offset:0 sc1
    buffer_load_dwordx4 v[140:143], v7, s[12:15], s42 offen offset:1792 sc1
    buffer_load_dwordx4 v[144:147], v8, s[12:15], s42 offen offset:1792 sc1
    s_add_u32 s42, s92, 13
    s_and_b32 s42, s42, 15
    s_mul_i32 s42, s42, 3584
    buffer_load_dwordx4 v[148:151], v7, s[12:15], s42 offen offset:0 sc1
    buffer_load_dwordx4 v[152:155], v8, s[12:15], s42 offen offset:0 sc1
    buffer_load_dwordx4 v[156:159], v7, s[12:15], s42 offen offset:1792 sc1
    buffer_load_dwordx4 v[160:163], v8, s[12:15], s42 offen offset:1792 sc1
    s_add_u32 s49, s49, 1
    s_cmp_ge_u32 s49, 20000
    s_waitcnt vmcnt(0)
    s_cbranch_scc1 sequential_preLN__sliding_block__mixer_token_mlp__prompt_kernel_g1r17
    v_max_u32 v22, v175, v179
    v_cmp_eq_u32 vcc, -1, v22
    s_cbranch_vccnz sequential_preLN__sliding_block__mixer_token_mlp__prompt_kernel_g1s17
    s_branch sequential_preLN__sliding_block__mixer_token_mlp__prompt_kernel_g1r17
sequential_preLN__sliding_block__mixer_token_mlp__prompt_kernel_g1s18:
    s_add_u32 s42, s92, 9
    s_and_b32 s42, s42, 15
    s_mul_i32 s42, s42, 3584
    buffer_load_dwordx4 v[180:183], v7, s[12:15], s42 offen offset:0 sc1
    buffer_load_dwordx4 v[184:187], v8, s[12:15], s42 offen offset:0 sc1
    buffer_load_dwordx4 v[188:191], v7, s[12:15], s42 offen offset:1792 sc1
    buffer_load_dwordx4 v[192:195], v8, s[12:15], s42 offen offset:1792 sc1
    s_add_u32 s42, s92, 10
    s_and_b32 s42, s42, 15
    s_mul_i32 s42, s42, 3584
    buffer_load_dwordx4 v[196:199], v7, s[12:15], s42 offen offset:0 sc1
    buffer_load_dwordx4 v[200:203], v8, s[12:15], s42 offen offset:0 sc1
    buffer_load_dwordx4 v[204:207], v7, s[12:15], s42 offen offset:1792 sc1
    buffer_load_dwordx4 v[208:211], v8, s[12:15], s42 offen offset:1792 sc1
    s_add_u32 s42, s92, 11
    s_and_b32 s42, s42, 15
    s_mul_i32 s42, s42, 3584
    buffer_load_dwordx4 v[212:215], v7, s[12:15], s42 offen offset:0 sc1
    buffer_load_dwordx4 v[216:219], v8, s[12:15], s42 offen offset:0 sc1
    buffer_load_dwordx4 v[220:223], v7, s[12:15], s42 offen offset:1792 sc1
    buffer_load_dwordx4 v[224:227], v8, s[12:15], s42 offen offset:1792 sc1
    s_add_u32 s42, s92, 12
    s_and_b32 s42, s42, 15
    s_mul_i32 s42, s42, 3584
    buffer_load_dwordx4 v[132:135], v7, s[12:15], s42 offen offset:0 sc1
    buffer_load_dwordx4 v[136:139], v8, s[12:15], s42 offen offset:0 sc1
    buffer_load_dwordx4 v[140:143], v7, s[12:15], s42 offen offset:1792 sc1
    buffer_load_dwordx4 v[144:147], v8, s[12:15], s42 offen offset:1792 sc1
    s_add_u32 s42, s92, 13
    s_and_b32 s42, s42, 15
    s_mul_i32 s42, s42, 3584
    buffer_load_dwordx4 v[148:151], v7, s[12:15], s42 offen offset:0 sc1
    buffer_load_dwordx4 v[152:155], v8, s[12:15], s42 offen offset:0 sc1
    buffer_load_dwordx4 v[156:159], v7, s[12:15], s42 offen offset:1792 sc1
    buffer_load_dwordx4 v[160:163], v8, s[12:15], s42 offen offset:1792 sc1
    s_add_u32 s42, s92, 14
    s_and_b32 s42, s42, 15
    s_mul_i32 s42, s42, 3584
    buffer_load_dwordx4 v[164:167], v7, s[12:15], s42 offen offset:0 sc1
    buffer_load_dwordx4 v[168:171], v8, s[12:15], s42 offen offset:0 sc1
    s_add_u32 s49, s49, 1
    s_cmp_ge_u32 s49, 20000
    s_waitcnt vmcnt(0)
    s_cbranch_scc1 sequential_preLN__sliding_block__mixer_token_mlp__prompt_kernel_g1r18
    v_max_u32 v22, v183, v187
    v_cmp_eq_u32 vcc, -1, v22
    s_cbranch_vccnz sequential_preLN__sliding_block__mixer_token_mlp__prompt_kernel_g1s18
    s_branch sequential_preLN__sliding_block__mixer_token_mlp__prompt_kernel_g1r18
sequential_preLN__sliding_block__mixer_token_mlp__prompt_kernel_g1s19:
    s_add_u32 s42, s92, 9
    s_and_b32 s42, s42, 15
    s_mul_i32 s42, s42, 3584
    buffer_load_dwordx4 v[188:191], v7, s[12:15], s42 offen offset:1792 sc1
    buffer_load_dwordx4 v[192:195], v8, s[12:15], s42 offen offset:1792 sc1
    s_add_u32 s42, s92, 10
    s_and_b32 s42, s42, 15
    s_mul_i32 s42, s42, 3584
    buffer_load_dwordx4 v[196:199], v7, s[12:15], s42 offen offset:0 sc1
    buffer_load_dwordx4 v[200:203], v8, s[12:15], s42 offen offset:0 sc1
    buffer_load_dwordx4 v[204:207], v7, s[12:15], s42 offen offset:1792 sc1
    buffer_load_dwordx4 v[208:211], v8, s[12:15], s42 offen offset:1792 sc1
    s_add_u32 s42, s92, 11
    s_and_b32 s42, s42, 15
    s_mul_i32 s42, s42, 3584
    buffer_load_dwordx4 v[212:215], v7, s[12:15], s42 offen offset:0 sc1
    buffer_load_dwordx4 v[216:219], v8, s[12:15], s42 offen offset:0 sc1
    buffer_load_dwordx4 v[220:223], v7, s[12:15], s42 offen offset:1792 sc1
    buffer_load_dwordx4 v[224:227], v8, s[12:15], s42 offen offset:1792 sc1
    s_add_u32 s42, s92, 12
    s_and_b32 s42, s42, 15
    s_mul_i32 s42, s42, 3584
    buffer_load_dwordx4 v[132:135], v7, s[12:15], s42 offen offset:0 sc1
    buffer_load_dwordx4 v[136:139], v8, s[12:15], s42 offen offset:0 sc1
    buffer_load_dwordx4 v[140:143], v7, s[12:15], s42 offen offset:1792 sc1
    buffer_load_dwordx4 v[144:147], v8, s[12:15], s42 offen offset:1792 sc1
    s_add_u32 s42, s92, 13
    s_and_b32 s42, s42, 15
    s_mul_i32 s42, s42, 3584
    buffer_load_dwordx4 v[148:151], v7, s[12:15], s42 offen offset:0 sc1
    buffer_load_dwordx4 v[152:155], v8, s[12:15], s42 offen offset:0 sc1
    buffer_load_dwordx4 v[156:159], v7, s[12:15], s42 offen offset:1792 sc1
    buffer_load_dwordx4 v[160:163], v8, s[12:15], s42 offen offset:1792 sc1
    s_add_u32 s42, s92, 14
    s_and_b32 s42, s42, 15
    s_mul_i32 s42, s42, 3584
    buffer_load_dwordx4 v[164:167], v7, s[12:15], s42 offen offset:0 sc1
    buffer_load_dwordx4 v[168:171], v8, s[12:15], s42 offen offset:0 sc1
    buffer_load_dwordx4 v[172:175], v7, s[12:15], s42 offen offset:1792 sc1
    buffer_load_dwordx4 v[176:179], v8, s[12:15], s42 offen offset:1792 sc1
    s_add_u32 s49, s49, 1
    s_cmp_ge_u32 s49, 20000
    s_waitcnt vmcnt(0)
    s_cbranch_scc1 sequential_preLN__sliding_block__mixer_token_mlp__prompt_kernel_g1r19
    v_max_u32 v22, v191, v195
    v_cmp_eq_u32 vcc, -1, v22
    s_cbranch_vccnz sequential_preLN__sliding_block__mixer_token_mlp__prompt_kernel_g1s19
    s_branch sequential_preLN__sliding_block__mixer_token_mlp__prompt_kernel_g1r19
sequential_preLN__sliding_block__mixer_token_mlp__prompt_kernel_g1s20:
    s_add_u32 s42, s92, 10
    s_and_b32 s42, s42, 15
    s_mul_i32 s42, s42, 3584
    buffer_load_dwordx4 v[196:199], v7, s[12:15], s42 offen offset:0 sc1
    buffer_load_dwordx4 v[200:203], v8, s[12:15], s42 offen offset:0 sc1
    buffer_load_dwordx4 v[204:207], v7, s[12:15], s42 offen offset:1792 sc1
    buffer_load_dwordx4 v[208:211], v8, s[12:15], s42 offen offset:1792 sc1
    s_add_u32 s42, s92, 11
    s_and_b32 s42, s42, 15
    s_mul_i32 s42, s42, 3584
    buffer_load_dwordx4 v[212:215], v7, s[12:15], s42 offen offset:0 sc1
    buffer_load_dwordx4 v[216:219], v8, s[12:15], s42 offen offset:0 sc1
    buffer_load_dwordx4 v[220:223], v7, s[12:15], s42 offen offset:1792 sc1
    buffer_load_dwordx4 v[224:227], v8, s[12:15], s42 offen offset:1792 sc1
    s_add_u32 s42, s92, 12
    s_and_b32 s42, s42, 15
    s_mul_i32 s42, s42, 3584
    buffer_load_dwordx4 v[132:135], v7, s[12:15], s42 offen offset:0 sc1
    buffer_load_dwordx4 v[136:139], v8, s[12:15], s42 offen offset:0 sc1
    buffer_load_dwordx4 v[140:143], v7, s[12:15], s42 offen offset:1792 sc1
    buffer_load_dwordx4 v[144:147], v8, s[12:15], s42 offen offset:1792 sc1
    s_add_u32 s42, s92, 13
    s_and_b32 s42, s42, 15
    s_mul_i32 s42, s42, 3584
    buffer_load_dwordx4 v[148:151], v7, s[12:15], s42 offen offset:0 sc1
    buffer_load_dwordx4 v[152:155], v8, s[12:15], s42 offen offset:0 sc1
    buffer_load_dwordx4 v[156:159], v7, s[12:15], s42 offen offset:1792 sc1
    buffer_load_dwordx4 v[160:163], v8, s[12:15], s42 offen offset:1792 sc1
    s_add_u32 s42, s92, 14
    s_and_b32 s42, s42, 15
    s_mul_i32 s42, s42, 3584
    buffer_load_dwordx4 v[164:167], v7, s[12:15], s42 offen offset:0 sc1
    buffer_load_dwordx4 v[168:171], v8, s[12:15], s42 offen offset:0 sc1
    buffer_load_dwordx4 v[172:175], v7, s[12:15], s42 offen offset:1792 sc1
    buffer_load_dwordx4 v[176:179], v8, s[12:15], s42 offen offset:1792 sc1
    s_add_u32 s42, s92, 15
    s_and_b32 s42, s42, 15
    s_mul_i32 s42, s42, 3584
    buffer_load_dwordx4 v[180:183], v7, s[12:15], s42 offen offset:0 sc1
    buffer_load_dwordx4 v[184:187], v8, s[12:15], s42 offen offset:0 sc1
    s_add_u32 s49, s49, 1
    s_cmp_ge_u32 s49, 20000
    s_waitcnt vmcnt(0)
    s_cbranch_scc1 sequential_preLN__sliding_block__mixer_token_mlp__prompt_kernel_g1r20
    v_max_u32 v22, v199, v203
    v_cmp_eq_u32 vcc, -1, v22
    s_cbranch_vccnz sequential_preLN__sliding_block__mixer_token_mlp__prompt_kernel_g1s20
    s_branch sequential_preLN__sliding_block__mixer_token_mlp__prompt_kernel_g1r20
sequential_preLN__sliding_block__mixer_token_mlp__prompt_kernel_g1s21:
    s_add_u32 s42, s92, 10
    s_and_b32 s42, s42, 15
    s_mul_i32 s42, s42, 3584
    buffer_load_dwordx4 v[204:207], v7, s[12:15], s42 offen offset:1792 sc1
    buffer_load_dwordx4 v[208:211], v8, s[12:15], s42 offen offset:1792 sc1
    s_add_u32 s42, s92, 11
    s_and_b32 s42, s42, 15
    s_mul_i32 s42, s42, 3584
    buffer_load_dwordx4 v[212:215], v7, s[12:15], s42 offen offset:0 sc1
    buffer_load_dwordx4 v[216:219], v8, s[12:15], s42 offen offset:0 sc1
    buffer_load_dwordx4 v[220:223], v7, s[12:15], s42 offen offset:1792 sc1
    buffer_load_dwordx4 v[224:227], v8, s[12:15], s42 offen offset:1792 sc1
    s_add_u32 s42, s92, 12
    s_and_b32 s42, s42, 15
    s_mul_i32 s42, s42, 3584
    buffer_load_dwordx4 v[132:135], v7, s[12:15], s42 offen offset:0 sc1
    buffer_load_dwordx4 v[136:139], v8, s[12:15], s42 offen offset:0 sc1
    buffer_load_dwordx4 v[140:143], v7, s[12:15], s42 offen offset:1792 sc1
    buffer_load_dwordx4 v[144:147], v8, s[12:15], s42 offen offset:1792 sc1
    s_add_u32 s42, s92, 13
    s_and_b32 s42, s42, 15
    s_mul_i32 s42, s42, 3584
    buffer_load_dwordx4 v[148:151], v7, s[12:15], s42 offen offset:0 sc1
    buffer_load_dwordx4 v[152:155], v8, s[12:15], s42 offen offset:0 sc1
    buffer_load_dwordx4 v[156:159], v7, s[12:15], s42 offen offset:1792 sc1
    buffer_load_dwordx4 v[160:163], v8, s[12:15], s42 offen offset:1792 sc1
    s_add_u32 s42, s92, 14
    s_and_b32 s42, s42, 15
    s_mul_i32 s42, s42, 3584
    buffer_load_dwordx4 v[164:167], v7, s[12:15], s42 offen offset:0 sc1
    buffer_load_dwordx4 v[168:171], v8, s[12:15], s42 offen offset:0 sc1
    buffer_load_dwordx4 v[172:175], v7, s[12:15], s42 offen offset:1792 sc1
    buffer_load_dwordx4 v[176:179], v8, s[12:15], s42 offen offset:1792 sc1
    s_add_u32 s42, s92, 15
    s_and_b32 s42, s42, 15
    s_mul_i32 s42, s42, 3584
    buffer_load_dwordx4 v[180:183], v7, s[12:15], s42 offen offset:0 sc1
    buffer_load_dwordx4 v[184:187], v8, s[12:15], s42 offen offset:0 sc1
    buffer_load_dwordx4 v[188:191], v7, s[12:15], s42 offen offset:1792 sc1
    buffer_load_dwordx4 v[192:195], v8, s[12:15], s42 offen offset:1792 sc1
    s_add_u32 s49, s49, 1
    s_cmp_ge_u32 s49, 20000
    s_waitcnt vmcnt(0)
    s_cbranch_scc1 sequential_preLN__sliding_block__mixer_token_mlp__prompt_kernel_g1r21
    v_max_u32 v22, v207, v211
    v_cmp_eq_u32 vcc, -1, v22
    s_cbranch_vccnz sequential_preLN__sliding_block__mixer_token_mlp__prompt_kernel_g1s21
    s_branch sequential_preLN__sliding_block__mixer_token_mlp__prompt_kernel_g1r21
sequential_preLN__sliding_block__mixer_token_mlp__prompt_kernel_g1s22:
    s_add_u32 s42, s92, 11
    s_and_b32 s42, s42, 15
    s_mul_i32 s42, s42, 3584
    buffer_load_dwordx4 v[212:215], v7, s[12:15], s42 offen offset:0 sc1
    buffer_load_dwordx4 v[216:219], v8, s[12:15], s42 offen offset:0 sc1
    buffer_load_dwordx4 v[220:223], v7, s[12:15], s42 offen offset:1792 sc1
    buffer_load_dwordx4 v[224:227], v8, s[12:15], s42 offen offset:1792 sc1
    s_add_u32 s42, s92, 12
    s_and_b32 s42, s42, 15
    s_mul_i32 s42, s42, 3584
    buffer_load_dwordx4 v[132:135], v7, s[12:15], s42 offen offset:0 sc1
    buffer_load_dwordx4 v[136:139], v8, s[12:15], s42 offen offset:0 sc1
    buffer_load_dwordx4 v[140:143], v7, s[12:15], s42 offen offset:1792 sc1
    buffer_load_dwordx4 v[144:147], v8, s[12:15], s42 offen offset:1792 sc1
    s_add_u32 s42, s92, 13
    s_and_b32 s42, s42, 15
    s_mul_i32 s42, s42, 3584
    buffer_load_dwordx4 v[148:151], v7, s[12:15], s42 offen offset:0 sc1
    buffer_load_dwordx4 v[152:155], v8, s[12:15], s42 offen offset:0 sc1
    buffer_load_dwordx4 v[156:159], v7, s[12:15], s42 offen offset:1792 sc1
    buffer_load_dwordx4 v[160:163], v8, s[12:15], s42 offen offset:1792 sc1
    s_add_u32 s42, s92, 14
    s_and_b32 s42, s42, 15
    s_mul_i32 s42, s42, 3584
    buffer_load_dwordx4 v[164:167], v7, s[12:15], s42 offen offset:0 sc1
    buffer_load_dwordx4 v[168:171], v8, s[12:15], s42 offen offset:0 sc1
    buffer_load_dwordx4 v[172:175], v7, s[12:15], s42 offen offset:1792 sc1
    buffer_load_dwordx4 v[176:179], v8, s[12:15], s42 offen offset:1792 sc1
    s_add_u32 s42, s92, 15
    s_and_b32 s42, s42, 15
    s_mul_i32 s42, s42, 3584
    buffer_load_dwordx4 v[180:183], v7, s[12:15], s42 offen offset:0 sc1
    buffer_load_dwordx4 v[184:187], v8, s[12:15], s42 offen offset:0 sc1
    buffer_load_dwordx4 v[188:191], v7, s[12:15], s42 offen offset:1792 sc1
    buffer_load_dwordx4 v[192:195], v8, s[12:15], s42 offen offset:1792 sc1
    s_add_u32 s49, s49, 1
    s_cmp_ge_u32 s49, 20000
    s_waitcnt vmcnt(0)
    s_cbranch_scc1 sequential_preLN__sliding_block__mixer_token_mlp__prompt_kernel_g1r22
    v_max_u32 v22, v215, v219
    v_cmp_eq_u32 vcc, -1, v22
    s_cbranch_vccnz sequential_preLN__sliding_block__mixer_token_mlp__prompt_kernel_g1s22
    s_branch sequential_preLN__sliding_block__mixer_token_mlp__prompt_kernel_g1r22
sequential_preLN__sliding_block__mixer_token_mlp__prompt_kernel_g1s23:
    s_add_u32 s42, s92, 11
    s_and_b32 s42, s42, 15
    s_mul_i32 s42, s42, 3584
    buffer_load_dwordx4 v[220:223], v7, s[12:15], s42 offen offset:1792 sc1
    buffer_load_dwordx4 v[224:227], v8, s[12:15], s42 offen offset:1792 sc1
    s_add_u32 s42, s92, 12
    s_and_b32 s42, s42, 15
    s_mul_i32 s42, s42, 3584
    buffer_load_dwordx4 v[132:135], v7, s[12:15], s42 offen offset:0 sc1
    buffer_load_dwordx4 v[136:139], v8, s[12:15], s42 offen offset:0 sc1
    buffer_load_dwordx4 v[140:143], v7, s[12:15], s42 offen offset:1792 sc1
    buffer_load_dwordx4 v[144:147], v8, s[12:15], s42 offen offset:1792 sc1
    s_add_u32 s42, s92, 13
    s_and_b32 s42, s42, 15
    s_mul_i32 s42, s42, 3584
    buffer_load_dwordx4 v[148:151], v7, s[12:15], s42 offen offset:0 sc1
    buffer_load_dwordx4 v[152:155], v8, s[12:15], s42 offen offset:0 sc1
    buffer_load_dwordx4 v[156:159], v7, s[12:15], s42 offen offset:1792 sc1
    buffer_load_dwordx4 v[160:163], v8, s[12:15], s42 offen offset:1792 sc1
    s_add_u32 s42, s92, 14
    s_and_b32 s42, s42, 15
    s_mul_i32 s42, s42, 3584
    buffer_load_dwordx4 v[164:167], v7, s[12:15], s42 offen offset:0 sc1
    buffer_load_dwordx4 v[168:171], v8, s[12:15], s42 offen offset:0 sc1
    buffer_load_dwordx4 v[172:175], v7, s[12:15], s42 offen offset:1792 sc1
    buffer_load_dwordx4 v[176:179], v8, s[12:15], s42 offen offset:1792 sc1
    s_add_u32 s42, s92, 15
    s_and_b32 s42, s42, 15
    s_mul_i32 s42, s42, 3584
    buffer_load_dwordx4 v[180:183], v7, s[12:15], s42 offen offset:0 sc1
    buffer_load_dwordx4 v[184:187], v8, s[12:15], s42 offen offset:0 sc1
    buffer_load_dwordx4 v[188:191], v7, s[12:15], s42 offen offset:1792 sc1
    buffer_load_dwordx4 v[192:195], v8, s[12:15], s42 offen offset:1792 sc1
    s_add_u32 s49, s49, 1
    s_cmp_ge_u32 s49, 20000
    s_waitcnt vmcnt(0)
    s_cbranch_scc1 sequential_preLN__sliding_block__mixer_token_mlp__prompt_kernel_g1r23
    v_max_u32 v22, v223, v227
    v_cmp_eq_u32 vcc, -1, v22
    s_cbranch_vccnz sequential_preLN__sliding_block__mixer_token_mlp__prompt_kernel_g1s23
    s_branch sequential_preLN__sliding_block__mixer_token_mlp__prompt_kernel_g1r23
sequential_preLN__sliding_block__mixer_token_mlp__prompt_kernel_g1s24:
    s_add_u32 s42, s92, 12
    s_and_b32 s42, s42, 15
    s_mul_i32 s42, s42, 3584
    buffer_load_dwordx4 v[132:135], v7, s[12:15], s42 offen offset:0 sc1
    buffer_load_dwordx4 v[136:139], v8, s[12:15], s42 offen offset:0 sc1
    buffer_load_dwordx4 v[140:143], v7, s[12:15], s42 offen offset:1792 sc1
    buffer_load_dwordx4 v[144:147], v8, s[12:15], s42 offen offset:1792 sc1
    s_add_u32 s42, s92, 13
    s_and_b32 s42, s42, 15
    s_mul_i32 s42, s42, 3584
    buffer_load_dwordx4 v[148:151], v7, s[12:15], s42 offen offset:0 sc1
    buffer_load_dwordx4 v[152:155], v8, s[12:15], s42 offen offset:0 sc1
    buffer_load_dwordx4 v[156:159], v7, s[12:15], s42 offen offset:1792 sc1
    buffer_load_dwordx4 v[160:163], v8, s[12:15], s42 offen offset:1792 sc1
    s_add_u32 s42, s92, 14
    s_and_b32 s42, s42, 15
    s_mul_i32 s42, s42, 3584
    buffer_load_dwordx4 v[164:167], v7, s[12:15], s42 offen offset:0 sc1
    buffer_load_dwordx4 v[168:171], v8, s[12:15], s42 offen offset:0 sc1
    buffer_load_dwordx4 v[172:175], v7, s[12:15], s42 offen offset:1792 sc1
    buffer_load_dwordx4 v[176:179], v8, s[12:15], s42 offen offset:1792 sc1
    s_add_u32 s42, s92, 15
    s_and_b32 s42, s42, 15
    s_mul_i32 s42, s42, 3584
    buffer_load_dwordx4 v[180:183], v7, s[12:15], s42 offen offset:0 sc1
    buffer_load_dwordx4 v[184:187], v8, s[12:15], s42 offen offset:0 sc1
    buffer_load_dwordx4 v[188:191], v7, s[12:15], s42 offen offset:1792 sc1
    buffer_load_dwordx4 v[192:195], v8, s[12:15], s42 offen offset:1792 sc1
    s_add_u32 s49, s49, 1
    s_cmp_ge_u32 s49, 20000
    s_waitcnt vmcnt(0)
    s_cbranch_scc1 sequential_preLN__sliding_block__mixer_token_mlp__prompt_kernel_g1r24
    v_max_u32 v22, v135, v139
    v_cmp_eq_u32 vcc, -1, v22
    s_cbranch_vccnz sequential_preLN__sliding_block__mixer_token_mlp__prompt_kernel_g1s24
    s_branch sequential_preLN__sliding_block__mixer_token_mlp__prompt_kernel_g1r24
sequential_preLN__sliding_block__mixer_token_mlp__prompt_kernel_g1s25:
    s_add_u32 s42, s92, 12
    s_and_b32 s42, s42, 15
    s_mul_i32 s42, s42, 3584
    buffer_load_dwordx4 v[140:143], v7, s[12:15], s42 offen offset:1792 sc1
    buffer_load_dwordx4 v[144:147], v8, s[12:15], s42 offen offset:1792 sc1
    s_add_u32 s42, s92, 13
    s_and_b32 s42, s42, 15
    s_mul_i32 s42, s42, 3584
    buffer_load_dwordx4 v[148:151], v7, s[12:15], s42 offen offset:0 sc1
    buffer_load_dwordx4 v[152:155], v8, s[12:15], s42 offen offset:0 sc1
    buffer_load_dwordx4 v[156:159], v7, s[12:15], s42 offen offset:1792 sc1
    buffer_load_dwordx4 v[160:163], v8, s[12:15], s42 offen offset:1792 sc1
    s_add_u32 s42, s92, 14
    s_and_b32 s42, s42, 15
    s_mul_i32 s42, s42, 3584
    buffer_load_dwordx4 v[164:167], v7, s[12:15], s42 offen offset:0 sc1
    buffer_load_dwordx4 v[168:171], v8, s[12:15], s42 offen offset:0 sc1
    buffer_load_dwordx4 v[172:175], v7, s[12:15], s42 offen offset:1792 sc1
    buffer_load_dwordx4 v[176:179], v8, s[12:15], s42 offen offset:1792 sc1
    s_add_u32 s42, s92, 15
    s_and_b32 s42, s42, 15
    s_mul_i32 s42, s42, 3584
    buffer_load_dwordx4 v[180:183], v7, s[12:15], s42 offen offset:0 sc1
    buffer_load_dwordx4 v[184:187], v8, s[12:15], s42 offen offset:0 sc1
    buffer_load_dwordx4 v[188:191], v7, s[12:15], s42 offen offset:1792 sc1
    buffer_load_dwordx4 v[192:195], v8, s[12:15], s42 offen offset:1792 sc1
    s_add_u32 s49, s49, 1
    s_cmp_ge_u32 s49, 20000
    s_waitcnt vmcnt(0)
    s_cbranch_scc1 sequential_preLN__sliding_block__mixer_token_mlp__prompt_kernel_g1r25
    v_max_u32 v22, v143, v147
    v_cmp_eq_u32 vcc, -1, v22
    s_cbranch_vccnz sequential_preLN__sliding_block__mixer_token_mlp__prompt_kernel_g1s25
    s_branch sequential_preLN__sliding_block__mixer_token_mlp__prompt_kernel_g1r25
sequential_preLN__sliding_block__mixer_token_mlp__prompt_kernel_g1s26:
    s_add_u32 s42, s92, 13
    s_and_b32 s42, s42, 15
    s_mul_i32 s42, s42, 3584
    buffer_load_dwordx4 v[148:151], v7, s[12:15], s42 offen offset:0 sc1
    buffer_load_dwordx4 v[152:155], v8, s[12:15], s42 offen offset:0 sc1
    buffer_load_dwordx4 v[156:159], v7, s[12:15], s42 offen offset:1792 sc1
    buffer_load_dwordx4 v[160:163], v8, s[12:15], s42 offen offset:1792 sc1
    s_add_u32 s42, s92, 14
    s_and_b32 s42, s42, 15
    s_mul_i32 s42, s42, 3584
    buffer_load_dwordx4 v[164:167], v7, s[12:15], s42 offen offset:0 sc1
    buffer_load_dwordx4 v[168:171], v8, s[12:15], s42 offen offset:0 sc1
    buffer_load_dwordx4 v[172:175], v7, s[12:15], s42 offen offset:1792 sc1
    buffer_load_dwordx4 v[176:179], v8, s[12:15], s42 offen offset:1792 sc1
    s_add_u32 s42, s92, 15
    s_and_b32 s42, s42, 15
    s_mul_i32 s42, s42, 3584
    buffer_load_dwordx4 v[180:183], v7, s[12:15], s42 offen offset:0 sc1
    buffer_load_dwordx4 v[184:187], v8, s[12:15], s42 offen offset:0 sc1
    buffer_load_dwordx4 v[188:191], v7, s[12:15], s42 offen offset:1792 sc1
    buffer_load_dwordx4 v[192:195], v8, s[12:15], s42 offen offset:1792 sc1
    s_add_u32 s49, s49, 1
    s_cmp_ge_u32 s49, 20000
    s_waitcnt vmcnt(0)
    s_cbranch_scc1 sequential_preLN__sliding_block__mixer_token_mlp__prompt_kernel_g1r26
    v_max_u32 v22, v151, v155
    v_cmp_eq_u32 vcc, -1, v22
    s_cbranch_vccnz sequential_preLN__sliding_block__mixer_token_mlp__prompt_kernel_g1s26
    s_branch sequential_preLN__sliding_block__mixer_token_mlp__prompt_kernel_g1r26
sequential_preLN__sliding_block__mixer_token_mlp__prompt_kernel_g1s27:
    s_add_u32 s42, s92, 13
    s_and_b32 s42, s42, 15
    s_mul_i32 s42, s42, 3584
    buffer_load_dwordx4 v[156:159], v7, s[12:15], s42 offen offset:1792 sc1
    buffer_load_dwordx4 v[160:163], v8, s[12:15], s42 offen offset:1792 sc1
    s_add_u32 s42, s92, 14
    s_and_b32 s42, s42, 15
    s_mul_i32 s42, s42, 3584
    buffer_load_dwordx4 v[164:167], v7, s[12:15], s42 offen offset:0 sc1
    buffer_load_dwordx4 v[168:171], v8, s[12:15], s42 offen offset:0 sc1
    buffer_load_dwordx4 v[172:175], v7, s[12:15], s42 offen offset:1792 sc1
    buffer_load_dwordx4 v[176:179], v8, s[12:15], s42 offen offset:1792 sc1
    s_add_u32 s42, s92, 15
    s_and_b32 s42, s42, 15
    s_mul_i32 s42, s42, 3584
    buffer_load_dwordx4 v[180:183], v7, s[12:15], s42 offen offset:0 sc1
    buffer_load_dwordx4 v[184:187], v8, s[12:15], s42 offen offset:0 sc1
    buffer_load_dwordx4 v[188:191], v7, s[12:15], s42 offen offset:1792 sc1
    buffer_load_dwordx4 v[192:195], v8, s[12:15], s42 offen offset:1792 sc1
    s_add_u32 s49, s49, 1
    s_cmp_ge_u32 s49, 20000
    s_waitcnt vmcnt(0)
    s_cbranch_scc1 sequential_preLN__sliding_block__mixer_token_mlp__prompt_kernel_g1r27
    v_max_u32 v22, v159, v163
    v_cmp_eq_u32 vcc, -1, v22
    s_cbranch_vccnz sequential_preLN__sliding_block__mixer_token_mlp__prompt_kernel_g1s27
    s_branch sequential_preLN__sliding_block__mixer_token_mlp__prompt_kernel_g1r27
sequential_preLN__sliding_block__mixer_token_mlp__prompt_kernel_g1s28:
    s_add_u32 s42, s92, 14
    s_and_b32 s42, s42, 15
    s_mul_i32 s42, s42, 3584
    buffer_load_dwordx4 v[164:167], v7, s[12:15], s42 offen offset:0 sc1
    buffer_load_dwordx4 v[168:171], v8, s[12:15], s42 offen offset:0 sc1
    buffer_load_dwordx4 v[172:175], v7, s[12:15], s42 offen offset:1792 sc1
    buffer_load_dwordx4 v[176:179], v8, s[12:15], s42 offen offset:1792 sc1
    s_add_u32 s42, s92, 15
    s_and_b32 s42, s42, 15
    s_mul_i32 s42, s42, 3584
    buffer_load_dwordx4 v[180:183], v7, s[12:15], s42 offen offset:0 sc1
    buffer_load_dwordx4 v[184:187], v8, s[12:15], s42 offen offset:0 sc1
    buffer_load_dwordx4 v[188:191], v7, s[12:15], s42 offen offset:1792 sc1
    buffer_load_dwordx4 v[192:195], v8, s[12:15], s42 offen offset:1792 sc1
    s_add_u32 s49, s49, 1
    s_cmp_ge_u32 s49, 20000
    s_waitcnt vmcnt(0)
    s_cbranch_scc1 sequential_preLN__sliding_block__mixer_token_mlp__prompt_kernel_g1r28
    v_max_u32 v22, v167, v171
    v_cmp_eq_u32 vcc, -1, v22
    s_cbranch_vccnz sequential_preLN__sliding_block__mixer_token_mlp__prompt_kernel_g1s28
    s_branch sequential_preLN__sliding_block__mixer_token_mlp__prompt_kernel_g1r28
sequential_preLN__sliding_block__mixer_token_mlp__prompt_kernel_g1s29:
    s_add_u32 s42, s92, 14
    s_and_b32 s42, s42, 15
    s_mul_i32 s42, s42, 3584
    buffer_load_dwordx4 v[172:175], v7, s[12:15], s42 offen offset:1792 sc1
    buffer_load_dwordx4 v[176:179], v8, s[12:15], s42 offen offset:1792 sc1
    s_add_u32 s42, s92, 15
    s_and_b32 s42, s42, 15
    s_mul_i32 s42, s42, 3584
    buffer_load_dwordx4 v[180:183], v7, s[12:15], s42 offen offset:0 sc1
    buffer_load_dwordx4 v[184:187], v8, s[12:15], s42 offen offset:0 sc1
    buffer_load_dwordx4 v[188:191], v7, s[12:15], s42 offen offset:1792 sc1
    buffer_load_dwordx4 v[192:195], v8, s[12:15], s42 offen offset:1792 sc1
    s_add_u32 s49, s49, 1
    s_cmp_ge_u32 s49, 20000
    s_waitcnt vmcnt(0)
    s_cbranch_scc1 sequential_preLN__sliding_block__mixer_token_mlp__prompt_kernel_g1r29
    v_max_u32 v22, v175, v179
    v_cmp_eq_u32 vcc, -1, v22
    s_cbranch_vccnz sequential_preLN__sliding_block__mixer_token_mlp__prompt_kernel_g1s29
    s_branch sequential_preLN__sliding_block__mixer_token_mlp__prompt_kernel_g1r29
sequential_preLN__sliding_block__mixer_token_mlp__prompt_kernel_g1s30:
    s_add_u32 s42, s92, 15
    s_and_b32 s42, s42, 15
    s_mul_i32 s42, s42, 3584
    buffer_load_dwordx4 v[180:183], v7, s[12:15], s42 offen offset:0 sc1
    buffer_load_dwordx4 v[184:187], v8, s[12:15], s42 offen offset:0 sc1
    buffer_load_dwordx4 v[188:191], v7, s[12:15], s42 offen offset:1792 sc1
    buffer_load_dwordx4 v[192:195], v8, s[12:15], s42 offen offset:1792 sc1
    s_add_u32 s49, s49, 1
    s_cmp_ge_u32 s49, 20000
    s_waitcnt vmcnt(0)
    s_cbranch_scc1 sequential_preLN__sliding_block__mixer_token_mlp__prompt_kernel_g1r30
    v_max_u32 v22, v183, v187
    v_cmp_eq_u32 vcc, -1, v22
    s_cbranch_vccnz sequential_preLN__sliding_block__mixer_token_mlp__prompt_kernel_g1s30
    s_branch sequential_preLN__sliding_block__mixer_token_mlp__prompt_kernel_g1r30
sequential_preLN__sliding_block__mixer_token_mlp__prompt_kernel_g1s31:
    s_add_u32 s42, s92, 15
    s_and_b32 s42, s42, 15
    s_mul_i32 s42, s42, 3584
    buffer_load_dwordx4 v[188:191], v7, s[12:15], s42 offen offset:1792 sc1
    buffer_load_dwordx4 v[192:195], v8, s[12:15], s42 offen offset:1792 sc1
    s_add_u32 s49, s49, 1
    s_cmp_ge_u32 s49, 20000
    s_waitcnt vmcnt(0)
    s_cbranch_scc1 sequential_preLN__sliding_block__mixer_token_mlp__prompt_kernel_g1r31
    v_max_u32 v22, v191, v195
    v_cmp_eq_u32 vcc, -1, v22
    s_cbranch_vccnz sequential_preLN__sliding_block__mixer_token_mlp__prompt_kernel_g1s31
    s_branch sequential_preLN__sliding_block__mixer_token_mlp__prompt_kernel_g1r31
sequential_preLN__sliding_block__mixer_token_mlp__prompt_kernel_g2s0:
    s_add_u32 s42, s93, 0
    s_sub_u32 s51, s42, 14
    s_min_u32 s42, s42, s51
    s_mul_i32 s42, s42, 3584
    buffer_load_dwordx4 v[132:135], v7, s[12:15], s42 offen offset:0 sc1
    buffer_load_dwordx4 v[136:139], v8, s[12:15], s42 offen offset:0 sc1
    buffer_load_dwordx4 v[140:143], v7, s[12:15], s42 offen offset:1792 sc1
    buffer_load_dwordx4 v[144:147], v8, s[12:15], s42 offen offset:1792 sc1
    s_add_u32 s42, s93, 1
    s_sub_u32 s51, s42, 14
    s_min_u32 s42, s42, s51
    s_mul_i32 s42, s42, 3584
    buffer_load_dwordx4 v[148:151], v7, s[12:15], s42 offen offset:0 sc1
    buffer_load_dwordx4 v[152:155], v8, s[12:15], s42 offen offset:0 sc1
    s_add_u32 s49, s49, 1
    s_cmp_ge_u32 s49, 20000
    s_waitcnt vmcnt(0)
    s_cbranch_scc1 sequential_preLN__sliding_block__mixer_token_mlp__prompt_kernel_g2r0
    v_max_u32 v22, v135, v139
    v_cmp_eq_u32 vcc, -1, v22
    s_cbranch_vccnz sequential_preLN__sliding_block__mixer_token_mlp__prompt_kernel_g2s0
    s_branch sequential_preLN__sliding_block__mixer_token_mlp__prompt_kernel_g2r0
sequential_preLN__sliding_block__mixer_token_mlp__prompt_kernel_g2s1:
    s_add_u32 s42, s93, 0
    s_sub_u32 s51, s42, 14
    s_min_u32 s42, s42, s51
    s_mul_i32 s42, s42, 3584
    buffer_load_dwordx4 v[140:143], v7, s[12:15], s42 offen offset:1792 sc1
    buffer_load_dwordx4 v[144:147], v8, s[12:15], s42 offen offset:1792 sc1
    s_add_u32 s42, s93, 1
    s_sub_u32 s51, s42, 14
    s_min_u32 s42, s42, s51
    s_mul_i32 s42, s42, 3584
    buffer_load_dwordx4 v[148:151], v7, s[12:15], s42 offen offset:0 sc1
    buffer_load_dwordx4 v[152:155], v8, s[12:15], s42 offen offset:0 sc1
    buffer_load_dwordx4 v[156:159], v7, s[12:15], s42 offen offset:1792 sc1
    buffer_load_dwordx4 v[160:163], v8, s[12:15], s42 offen offset:1792 sc1
    s_add_u32 s42, s93, 2
    s_sub_u32 s51, s42, 14
    s_min_u32 s42, s42, s51
    s_mul_i32 s42, s42, 3584
    buffer_load_dwordx4 v[164:167], v7, s[12:15], s42 offen offset:0 sc1
    buffer_load_dwordx4 v[168:171], v8, s[12:15], s42 offen offset:0 sc1
    s_add_u32 s49, s49, 1
    s_cmp_ge_u32 s49, 20000
    s_waitcnt vmcnt(0)
    s_cbranch_scc1 sequential_preLN__sliding_block__mixer_token_mlp__prompt_kernel_g2r1
    v_max_u32 v22, v143, v147
    v_cmp_eq_u32 vcc, -1, v22
    s_cbranch_vccnz sequential_preLN__sliding_block__mixer_token_mlp__prompt_kernel_g2s1
    s_branch sequential_preLN__sliding_block__mixer_token_mlp__prompt_kernel_g2r1
sequential_preLN__sliding_block__mixer_token_mlp__prompt_kernel_g2s2:
    s_add_u32 s42, s93, 1
    s_sub_u32 s51, s42, 14
    s_min_u32 s42, s42, s51
    s_mul_i32 s42, s42, 3584
    buffer_load_dwordx4 v[148:151], v7, s[12:15], s42 offen offset:0 sc1
    buffer_load_dwordx4 v[152:155], v8, s[12:15], s42 offen offset:0 sc1
    buffer_load_dwordx4 v[156:159], v7, s[12:15], s42 offen offset:1792 sc1
    buffer_load_dwordx4 v[160:163], v8, s[12:15], s42 offen offset:1792 sc1
    s_add_u32 s42, s93, 2
    s_sub_u32 s51, s42, 14
    s_min_u32 s42, s42, s51
    s_mul_i32 s42, s42, 3584
    buffer_load_dwordx4 v[164:167], v7, s[12:15], s42 offen offset:0 sc1
    buffer_load_dwordx4 v[168:171], v8, s[12:15], s42 offen offset:0 sc1
    buffer_load_dwordx4 v[172:175], v7, s[12:15], s42 offen offset:1792 sc1
    buffer_load_dwordx4 v[176:179], v8, s[12:15], s42 offen offset:1792 sc1
    s_add_u32 s42, s93, 3
    s_sub_u32 s51, s42, 14
    s_min_u32 s42, s42, s51
    s_mul_i32 s42, s42, 3584
    buffer_load_dwordx4 v[180:183], v7, s[12:15], s42 offen offset:0 sc1
    buffer_load_dwordx4 v[184:187], v8, s[12:15], s42 offen offset:0 sc1
    s_add_u32 s49, s49, 1
    s_cmp_ge_u32 s49, 20000
    s_waitcnt vmcnt(0)
    s_cbranch_scc1 sequential_preLN__sliding_block__mixer_token_mlp__prompt_kernel_g2r2
    v_max_u32 v22, v151, v155
    v_cmp_eq_u32 vcc, -1, v22
    s_cbranch_vccnz sequential_preLN__sliding_block__mixer_token_mlp__prompt_kernel_g2s2
    s_branch sequential_preLN__sliding_block__mixer_token_mlp__prompt_kernel_g2r2
sequential_preLN__sliding_block__mixer_token_mlp__prompt_kernel_g2s3:
    s_add_u32 s42, s93, 1
    s_sub_u32 s51, s42, 14
    s_min_u32 s42, s42, s51
    s_mul_i32 s42, s42, 3584
    buffer_load_dwordx4 v[156:159], v7, s[12:15], s42 offen offset:1792 sc1
    buffer_load_dwordx4 v[160:163], v8, s[12:15], s42 offen offset:1792 sc1
    s_add_u32 s42, s93, 2
    s_sub_u32 s51, s42, 14
    s_min_u32 s42, s42, s51
    s_mul_i32 s42, s42, 3584
    buffer_load_dwordx4 v[164:167], v7, s[12:15], s42 offen offset:0 sc1
    buffer_load_dwordx4 v[168:171], v8, s[12:15], s42 offen offset:0 sc1
    buffer_load_dwordx4 v[172:175], v7, s[12:15], s42 offen offset:1792 sc1
    buffer_load_dwordx4 v[176:179], v8, s[12:15], s42 offen offset:1792 sc1
    s_add_u32 s42, s93, 3
    s_sub_u32 s51, s42, 14
    s_min_u32 s42, s42, s51
    s_mul_i32 s42, s42, 3584
    buffer_load_dwordx4 v[180:183], v7, s[12:15], s42 offen offset:0 sc1
    buffer_load_dwordx4 v[184:187], v8, s[12:15], s42 offen offset:0 sc1
    buffer_load_dwordx4 v[188:191], v7, s[12:15], s42 offen offset:1792 sc1
    buffer_load_dwordx4 v[192:195], v8, s[12:15], s42 offen offset:1792 sc1
    s_add_u32 s42, s93, 4
    s_sub_u32 s51, s42, 14
    s_min_u32 s42, s42, s51
    s_mul_i32 s42, s42, 3584
    buffer_load_dwordx4 v[196:199], v7, s[12:15], s42 offen offset:0 sc1
    buffer_load_dwordx4 v[200:203], v8, s[12:15], s42 offen offset:0 sc1
    s_add_u32 s49, s49, 1
    s_cmp_ge_u32 s49, 20000
    s_waitcnt vmcnt(0)
    s_cbranch_scc1 sequential_preLN__sliding_block__mixer_token_mlp__prompt_kernel_g2r3
    v_max_u32 v22, v159, v163
    v_cmp_eq_u32 vcc, -1, v22
    s_cbranch_vccnz sequential_preLN__sliding_block__mixer_token_mlp__prompt_kernel_g2s3
    s_branch sequential_preLN__sliding_block__mixer_token_mlp__prompt_kernel_g2r3
sequential_preLN__sliding_block__mixer_token_mlp__prompt_kernel_g2s4:
    s_add_u32 s42, s93, 2
    s_sub_u32 s51, s42, 14
    s_min_u32 s42, s42, s51
    s_mul_i32 s42, s42, 3584
    buffer_load_dwordx4 v[164:167], v7, s[12:15], s42 offen offset:0 sc1
    buffer_load_dwordx4 v[168:171], v8, s[12:15], s42 offen offset:0 sc1
    buffer_load_dwordx4 v[172:175], v7, s[12:15], s42 offen offset:1792 sc1
    buffer_load_dwordx4 v[176:179], v8, s[12:15], s42 offen offset:1792 sc1
    s_add_u32 s42, s93, 3
    s_sub_u32 s51, s42, 14
    s_min_u32 s42, s42, s51
    s_mul_i32 s42, s42, 3584
    buffer_load_dwordx4 v[180:183], v7, s[12:15], s42 offen offset:0 sc1
    buffer_load_dwordx4 v[184:187], v8, s[12:15], s42 offen offset:0 sc1
    buffer_load_dwordx4 v[188:191], v7, s[12:15], s42 offen offset:1792 sc1
    buffer_load_dwordx4 v[192:195], v8, s[12:15], s42 offen offset:1792 sc1
    s_add_u32 s42, s93, 4
    s_sub_u32 s51, s42, 14
    s_min_u32 s42, s42, s51
    s_mul_i32 s42, s42, 3584
    buffer_load_dwordx4 v[196:199], v7, s[12:15], s42 offen offset:0 sc1
    buffer_load_dwordx4 v[200:203], v8, s[12:15], s42 offen offset:0 sc1
    buffer_load_dwordx4 v[204:207], v7, s[12:15], s42 offen offset:1792 sc1
    buffer_load_dwordx4 v[208:211], v8, s[12:15], s42 offen offset:1792 sc1
    s_add_u32 s42, s93, 5
    s_sub_u32 s51, s42, 14
    s_min_u32 s42, s42, s51
    s_mul_i32 s42, s42, 3584
    buffer_load_dwordx4 v[212:215], v7, s[12:15], s42 offen offset:0 sc1
    buffer_load_dwordx4 v[216:219], v8, s[12:15], s42 offen offset:0 sc1
    s_add_u32 s49, s49, 1
    s_cmp_ge_u32 s49, 20000
    s_waitcnt vmcnt(0)
    s_cbranch_scc1 sequential_preLN__sliding_block__mixer_token_mlp__prompt_kernel_g2r4
    v_max_u32 v22, v167, v171
    v_cmp_eq_u32 vcc, -1, v22
    s_cbranch_vccnz sequential_preLN__sliding_block__mixer_token_mlp__prompt_kernel_g2s4
    s_branch sequential_preLN__sliding_block__mixer_token_mlp__prompt_kernel_g2r4
sequential_preLN__sliding_block__mixer_token_mlp__prompt_kernel_g2s5:
    s_add_u32 s42, s93, 2
    s_sub_u32 s51, s42, 14
    s_min_u32 s42, s42, s51
    s_mul_i32 s42, s42, 3584
    buffer_load_dwordx4 v[172:175], v7, s[12:15], s42 offen offset:1792 sc1
    buffer_load_dwordx4 v[176:179], v8, s[12:15], s42 offen offset:1792 sc1
    s_add_u32 s42, s93, 3
    s_sub_u32 s51, s42, 14
    s_min_u32 s42, s42, s51
    s_mul_i32 s42, s42, 3584
    buffer_load_dwordx4 v[180:183], v7, s[12:15], s42 offen offset:0 sc1
    buffer_load_dwordx4 v[184:187], v8, s[12:15], s42 offen offset:0 sc1
    buffer_load_dwordx4 v[188:191], v7, s[12:15], s42 offen offset:1792 sc1
    buffer_load_dwordx4 v[192:195], v8, s[12:15], s42 offen offset:1792 sc1
    s_add_u32 s42, s93, 4
    s_sub_u32 s51, s42, 14
    s_min_u32 s42, s42, s51
    s_mul_i32 s42, s42, 3584
    buffer_load_dwordx4 v[196:199], v7, s[12:15], s42 offen offset:0 sc1
    buffer_load_dwordx4 v[200:203], v8, s[12:15], s42 offen offset:0 sc1
    buffer_load_dwordx4 v[204:207], v7, s[12:15], s42 offen offset:1792 sc1
    buffer_load_dwordx4 v[208:211], v8, s[12:15], s42 offen offset:1792 sc1
    s_add_u32 s42, s93, 5
    s_sub_u32 s51, s42, 14
    s_min_u32 s42, s42, s51
    s_mul_i32 s42, s42, 3584
    buffer_load_dwordx4 v[212:215], v7, s[12:15], s42 offen offset:0 sc1
    buffer_load_dwordx4 v[216:219], v8, s[12:15], s42 offen offset:0 sc1
    buffer_load_dwordx4 v[220:223], v7, s[12:15], s42 offen offset:1792 sc1
    buffer_load_dwordx4 v[224:227], v8, s[12:15], s42 offen offset:1792 sc1
    s_add_u32 s42, s93, 6
    s_sub_u32 s51, s42, 14
    s_min_u32 s42, s42, s51
    s_mul_i32 s42, s42, 3584
    buffer_load_dwordx4 v[132:135], v7, s[12:15], s42 offen offset:0 sc1
    buffer_load_dwordx4 v[136:139], v8, s[12:15], s42 offen offset:0 sc1
    s_add_u32 s49, s49, 1
    s_cmp_ge_u32 s49, 20000
    s_waitcnt vmcnt(0)
    s_cbranch_scc1 sequential_preLN__sliding_block__mixer_token_mlp__prompt_kernel_g2r5
    v_max_u32 v22, v175, v179
    v_cmp_eq_u32 vcc, -1, v22
    s_cbranch_vccnz sequential_preLN__sliding_block__mixer_token_mlp__prompt_kernel_g2s5
    s_branch sequential_preLN__sliding_block__mixer_token_mlp__prompt_kernel_g2r5
sequential_preLN__sliding_block__mixer_token_mlp__prompt_kernel_g2s6:
    s_add_u32 s42, s93, 3
    s_sub_u32 s51, s42, 14
    s_min_u32 s42, s42, s51
    s_mul_i32 s42, s42, 3584
    buffer_load_dwordx4 v[180:183], v7, s[12:15], s42 offen offset:0 sc1
    buffer_load_dwordx4 v[184:187], v8, s[12:15], s42 offen offset:0 sc1
    buffer_load_dwordx4 v[188:191], v7, s[12:15], s42 offen offset:1792 sc1
    buffer_load_dwordx4 v[192:195], v8, s[12:15], s42 offen offset:1792 sc1
    s_add_u32 s42, s93, 4
    s_sub_u32 s51, s42, 14
    s_min_u32 s42, s42, s51
    s_mul_i32 s42, s42, 3584
    buffer_load_dwordx4 v[196:199], v7, s[12:15], s42 offen offset:0 sc1
    buffer_load_dwordx4 v[200:203], v8, s[12:15], s42 offen offset:0 sc1
    buffer_load_dwordx4 v[204:207], v7, s[12:15], s42 offen offset:1792 sc1
    buffer_load_dwordx4 v[208:211], v8, s[12:15], s42 offen offset:1792 sc1
    s_add_u32 s42, s93, 5
    s_sub_u32 s51, s42, 14
    s_min_u32 s42, s42, s51
    s_mul_i32 s42, s42, 3584
    buffer_load_dwordx4 v[212:215], v7, s[12:15], s42 offen offset:0 sc1
    buffer_load_dwordx4 v[216:219], v8, s[12:15], s42 offen offset:0 sc1
    buffer_load_dwordx4 v[220:223], v7, s[12:15], s42 offen offset:1792 sc1
    buffer_load_dwordx4 v[224:227], v8, s[12:15], s42 offen offset:1792 sc1
    s_add_u32 s42, s93, 6
    s_sub_u32 s51, s42, 14
    s_min_u32 s42, s42, s51
    s_mul_i32 s42, s42, 3584
    buffer_load_dwordx4 v[132:135], v7, s[12:15], s42 offen offset:0 sc1
    buffer_load_dwordx4 v[136:139], v8, s[12:15], s42 offen offset:0 sc1
    buffer_load_dwordx4 v[140:143], v7, s[12:15], s42 offen offset:1792 sc1
    buffer_load_dwordx4 v[144:147], v8, s[12:15], s42 offen offset:1792 sc1
    s_add_u32 s42, s93, 7
    s_sub_u32 s51, s42, 14
    s_min_u32 s42, s42, s51
    s_mul_i32 s42, s42, 3584
    buffer_load_dwordx4 v[148:151], v7, s[12:15], s42 offen offset:0 sc1
    buffer_load_dwordx4 v[152:155], v8, s[12:15], s42 offen offset:0 sc1
    s_add_u32 s49, s49, 1
    s_cmp_ge_u32 s49, 20000
    s_waitcnt vmcnt(0)
    s_cbranch_scc1 sequential_preLN__sliding_block__mixer_token_mlp__prompt_kernel_g2r6
    v_max_u32 v22, v183, v187
    v_cmp_eq_u32 vcc, -1, v22
    s_cbranch_vccnz sequential_preLN__sliding_block__mixer_token_mlp__prompt_kernel_g2s6
    s_branch sequential_preLN__sliding_block__mixer_token_mlp__prompt_kernel_g2r6
sequential_preLN__sliding_block__mixer_token_mlp__prompt_kernel_g2s7:
    s_add_u32 s42, s93, 3
    s_sub_u32 s51, s42, 14
    s_min_u32 s42, s42, s51
    s_mul_i32 s42, s42, 3584
    buffer_load_dwordx4 v[188:191], v7, s[12:15], s42 offen offset:1792 sc1
    buffer_load_dwordx4 v[192:195], v8, s[12:15], s42 offen offset:1792 sc1
    s_add_u32 s42, s93, 4
    s_sub_u32 s51, s42, 14
    s_min_u32 s42, s42, s51
    s_mul_i32 s42, s42, 3584
    buffer_load_dwordx4 v[196:199], v7, s[12:15], s42 offen offset:0 sc1
    buffer_load_dwordx4 v[200:203], v8, s[12:15], s42 offen offset:0 sc1
    buffer_load_dwordx4 v[204:207], v7, s[12:15], s42 offen offset:1792 sc1
    buffer_load_dwordx4 v[208:211], v8, s[12:15], s42 offen offset:1792 sc1
    s_add_u32 s42, s93, 5
    s_sub_u32 s51, s42, 14
    s_min_u32 s42, s42, s51
    s_mul_i32 s42, s42, 3584
    buffer_load_dwordx4 v[212:215], v7, s[12:15], s42 offen offset:0 sc1
    buffer_load_dwordx4 v[216:219], v8, s[12:15], s42 offen offset:0 sc1
    buffer_load_dwordx4 v[220:223], v7, s[12:15], s42 offen offset:1792 sc1
    buffer_load_dwordx4 v[224:227], v8, s[12:15], s42 offen offset:1792 sc1
    s_add_u32 s42, s93, 6
    s_sub_u32 s51, s42, 14
    s_min_u32 s42, s42, s51
    s_mul_i32 s42, s42, 3584
    buffer_load_dwordx4 v[132:135], v7, s[12:15], s42 offen offset:0 sc1
    buffer_load_dwordx4 v[136:139], v8, s[12:15], s42 offen offset:0 sc1
    buffer_load_dwordx4 v[140:143], v7, s[12:15], s42 offen offset:1792 sc1
    buffer_load_dwordx4 v[144:147], v8, s[12:15], s42 offen offset:1792 sc1
    s_add_u32 s42, s93, 7
    s_sub_u32 s51, s42, 14
    s_min_u32 s42, s42, s51
    s_mul_i32 s42, s42, 3584
    buffer_load_dwordx4 v[148:151], v7, s[12:15], s42 offen offset:0 sc1
    buffer_load_dwordx4 v[152:155], v8, s[12:15], s42 offen offset:0 sc1
    buffer_load_dwordx4 v[156:159], v7, s[12:15], s42 offen offset:1792 sc1
    buffer_load_dwordx4 v[160:163], v8, s[12:15], s42 offen offset:1792 sc1
    s_add_u32 s42, s93, 8
    s_sub_u32 s51, s42, 14
    s_min_u32 s42, s42, s51
    s_mul_i32 s42, s42, 3584
    buffer_load_dwordx4 v[164:167], v7, s[12:15], s42 offen offset:0 sc1
    buffer_load_dwordx4 v[168:171], v8, s[12:15], s42 offen offset:0 sc1
    s_add_u32 s49, s49, 1
    s_cmp_ge_u32 s49, 20000
    s_waitcnt vmcnt(0)
    s_cbranch_scc1 sequential_preLN__sliding_block__mixer_token_mlp__prompt_kernel_g2r7
    v_max_u32 v22, v191, v195
    v_cmp_eq_u32 vcc, -1, v22
    s_cbranch_vccnz sequential_preLN__sliding_block__mixer_token_mlp__prompt_kernel_g2s7
    s_branch sequential_preLN__sliding_block__mixer_token_mlp__prompt_kernel_g2r7
sequential_preLN__sliding_block__mixer_token_mlp__prompt_kernel_g2s8:
    s_add_u32 s42, s93, 4
    s_sub_u32 s51, s42, 14
    s_min_u32 s42, s42, s51
    s_mul_i32 s42, s42, 3584
    buffer_load_dwordx4 v[196:199], v7, s[12:15], s42 offen offset:0 sc1
    buffer_load_dwordx4 v[200:203], v8, s[12:15], s42 offen offset:0 sc1
    buffer_load_dwordx4 v[204:207], v7, s[12:15], s42 offen offset:1792 sc1
    buffer_load_dwordx4 v[208:211], v8, s[12:15], s42 offen offset:1792 sc1
    s_add_u32 s42, s93, 5
    s_sub_u32 s51, s42, 14
    s_min_u32 s42, s42, s51
    s_mul_i32 s42, s42, 3584
    buffer_load_dwordx4 v[212:215], v7, s[12:15], s42 offen offset:0 sc1
    buffer_load_dwordx4 v[216:219], v8, s[12:15], s42 offen offset:0 sc1
    buffer_load_dwordx4 v[220:223], v7, s[12:15], s42 offen offset:1792 sc1
    buffer_load_dwordx4 v[224:227], v8, s[12:15], s42 offen offset:1792 sc1
    s_add_u32 s42, s93, 6
    s_sub_u32 s51, s42, 14
    s_min_u32 s42, s42, s51
    s_mul_i32 s42, s42, 3584
    buffer_load_dwordx4 v[132:135], v7, s[12:15], s42 offen offset:0 sc1
    buffer_load_dwordx4 v[136:139], v8, s[12:15], s42 offen offset:0 sc1
    buffer_load_dwordx4 v[140:143], v7, s[12:15], s42 offen offset:1792 sc1
    buffer_load_dwordx4 v[144:147], v8, s[12:15], s42 offen offset:1792 sc1
    s_add_u32 s42, s93, 7
    s_sub_u32 s51, s42, 14
    s_min_u32 s42, s42, s51
    s_mul_i32 s42, s42, 3584
    buffer_load_dwordx4 v[148:151], v7, s[12:15], s42 offen offset:0 sc1
    buffer_load_dwordx4 v[152:155], v8, s[12:15], s42 offen offset:0 sc1
    buffer_load_dwordx4 v[156:159], v7, s[12:15], s42 offen offset:1792 sc1
    buffer_load_dwordx4 v[160:163], v8, s[12:15], s42 offen offset:1792 sc1
    s_add_u32 s42, s93, 8
    s_sub_u32 s51, s42, 14
    s_min_u32 s42, s42, s51
    s_mul_i32 s42, s42, 3584
    buffer_load_dwordx4 v[164:167], v7, s[12:15], s42 offen offset:0 sc1
    buffer_load_dwordx4 v[168:171], v8, s[12:15], s42 offen offset:0 sc1
    buffer_load_dwordx4 v[172:175], v7, s[12:15], s42 offen offset:1792 sc1
    buffer_load_dwordx4 v[176:179], v8, s[12:15], s42 offen offset:1792 sc1
    s_add_u32 s42, s93, 9
    s_sub_u32 s51, s42, 14
    s_min_u32 s42, s42, s51
    s_mul_i32 s42, s42, 3584
    buffer_load_dwordx4 v[180:183], v7, s[12:15], s42 offen offset:0 sc1
    buffer_load_dwordx4 v[184:187], v8, s[12:15], s42 offen offset:0 sc1
    s_add_u32 s49, s49, 1
    s_cmp_ge_u32 s49, 20000
    s_waitcnt vmcnt(0)
    s_cbranch_scc1 sequential_preLN__sliding_block__mixer_token_mlp__prompt_kernel_g2r8
    v_max_u32 v22, v199, v203
    v_cmp_eq_u32 vcc, -1, v22
    s_cbranch_vccnz sequential_preLN__sliding_block__mixer_token_mlp__prompt_kernel_g2s8
    s_branch sequential_preLN__sliding_block__mixer_token_mlp__prompt_kernel_g2r8
sequential_preLN__sliding_block__mixer_token_mlp__prompt_kernel_g2s9:
    s_add_u32 s42, s93, 4
    s_sub_u32 s51, s42, 14
    s_min_u32 s42, s42, s51
    s_mul_i32 s42, s42, 3584
    buffer_load_dwordx4 v[204:207], v7, s[12:15], s42 offen offset:1792 sc1
    buffer_load_dwordx4 v[208:211], v8, s[12:15], s42 offen offset:1792 sc1
    s_add_u32 s42, s93, 5
    s_sub_u32 s51, s42, 14
    s_min_u32 s42, s42, s51
    s_mul_i32 s42, s42, 3584
    buffer_load_dwordx4 v[212:215], v7, s[12:15], s42 offen offset:0 sc1
    buffer_load_dwordx4 v[216:219], v8, s[12:15], s42 offen offset:0 sc1
    buffer_load_dwordx4 v[220:223], v7, s[12:15], s42 offen offset:1792 sc1
    buffer_load_dwordx4 v[224:227], v8, s[12:15], s42 offen offset:1792 sc1
    s_add_u32 s42, s93, 6
    s_sub_u32 s51, s42, 14
    s_min_u32 s42, s42, s51
    s_mul_i32 s42, s42, 3584
    buffer_load_dwordx4 v[132:135], v7, s[12:15], s42 offen offset:0 sc1
    buffer_load_dwordx4 v[136:139], v8, s[12:15], s42 offen offset:0 sc1
    buffer_load_dwordx4 v[140:143], v7, s[12:15], s42 offen offset:1792 sc1
    buffer_load_dwordx4 v[144:147], v8, s[12:15], s42 offen offset:1792 sc1
    s_add_u32 s42, s93, 7
    s_sub_u32 s51, s42, 14
    s_min_u32 s42, s42, s51
    s_mul_i32 s42, s42, 3584
    buffer_load_dwordx4 v[148:151], v7, s[12:15], s42 offen offset:0 sc1
    buffer_load_dwordx4 v[152:155], v8, s[12:15], s42 offen offset:0 sc1
    buffer_load_dwordx4 v[156:159], v7, s[12:15], s42 offen offset:1792 sc1
    buffer_load_dwordx4 v[160:163], v8, s[12:15], s42 offen offset:1792 sc1
    s_add_u32 s42, s93, 8
    s_sub_u32 s51, s42, 14
    s_min_u32 s42, s42, s51
    s_mul_i32 s42, s42, 3584
    buffer_load_dwordx4 v[164:167], v7, s[12:15], s42 offen offset:0 sc1
    buffer_load_dwordx4 v[168:171], v8, s[12:15], s42 offen offset:0 sc1
    buffer_load_dwordx4 v[172:175], v7, s[12:15], s42 offen offset:1792 sc1
    buffer_load_dwordx4 v[176:179], v8, s[12:15], s42 offen offset:1792 sc1
    s_add_u32 s42, s93, 9
    s_sub_u32 s51, s42, 14
    s_min_u32 s42, s42, s51
    s_mul_i32 s42, s42, 3584
    buffer_load_dwordx4 v[180:183], v7, s[12:15], s42 offen offset:0 sc1
    buffer_load_dwordx4 v[184:187], v8, s[12:15], s42 offen offset:0 sc1
    buffer_load_dwordx4 v[188:191], v7, s[12:15], s42 offen offset:1792 sc1
    buffer_load_dwordx4 v[192:195], v8, s[12:15], s42 offen offset:1792 sc1
    s_add_u32 s49, s49, 1
    s_cmp_ge_u32 s49, 20000
    s_waitcnt vmcnt(0)
    s_cbranch_scc1 sequential_preLN__sliding_block__mixer_token_mlp__prompt_kernel_g2r9
    v_max_u32 v22, v207, v211
    v_cmp_eq_u32 vcc, -1, v22
    s_cbranch_vccnz sequential_preLN__sliding_block__mixer_token_mlp__prompt_kernel_g2s9
    s_branch sequential_preLN__sliding_block__mixer_token_mlp__prompt_kernel_g2r9
sequential_preLN__sliding_block__mixer_token_mlp__prompt_kernel_g2s10:
    s_add_u32 s42, s93, 5
    s_sub_u32 s51, s42, 14
    s_min_u32 s42, s42, s51
    s_mul_i32 s42, s42, 3584
    buffer_load_dwordx4 v[212:215], v7, s[12:15], s42 offen offset:0 sc1
    buffer_load_dwordx4 v[216:219], v8, s[12:15], s42 offen offset:0 sc1
    buffer_load_dwordx4 v[220:223], v7, s[12:15], s42 offen offset:1792 sc1
    buffer_load_dwordx4 v[224:227], v8, s[12:15], s42 offen offset:1792 sc1
    s_add_u32 s42, s93, 6
    s_sub_u32 s51, s42, 14
    s_min_u32 s42, s42, s51
    s_mul_i32 s42, s42, 3584
    buffer_load_dwordx4 v[132:135], v7, s[12:15], s42 offen offset:0 sc1
    buffer_load_dwordx4 v[136:139], v8, s[12:15], s42 offen offset:0 sc1
    buffer_load_dwordx4 v[140:143], v7, s[12:15], s42 offen offset:1792 sc1
    buffer_load_dwordx4 v[144:147], v8, s[12:15], s42 offen offset:1792 sc1
    s_add_u32 s42, s93, 7
    s_sub_u32 s51, s42, 14
    s_min_u32 s42, s42, s51
    s_mul_i32 s42, s42, 3584
    buffer_load_dwordx4 v[148:151], v7, s[12:15], s42 offen offset:0 sc1
    buffer_load_dwordx4 v[152:155], v8, s[12:15], s42 offen offset:0 sc1
    buffer_load_dwordx4 v[156:159], v7, s[12:15], s42 offen offset:1792 sc1
    buffer_load_dwordx4 v[160:163], v8, s[12:15], s42 offen offset:1792 sc1
    s_add_u32 s42, s93, 8
    s_sub_u32 s51, s42, 14
    s_min_u32 s42, s42, s51
    s_mul_i32 s42, s42, 3584
    buffer_load_dwordx4 v[164:167], v7, s[12:15], s42 offen offset:0 sc1
    buffer_load_dwordx4 v[168:171], v8, s[12:15], s42 offen offset:0 sc1
    buffer_load_dwordx4 v[172:175], v7, s[12:15], s42 offen offset:1792 sc1
    buffer_load_dwordx4 v[176:179], v8, s[12:15], s42 offen offset:1792 sc1
    s_add_u32 s42, s93, 9
    s_sub_u32 s51, s42, 14
    s_min_u32 s42, s42, s51
    s_mul_i32 s42, s42, 3584
    buffer_load_dwordx4 v[180:183], v7, s[12:15], s42 offen offset:0 sc1
    buffer_load_dwordx4 v[184:187], v8, s[12:15], s42 offen offset:0 sc1
    buffer_load_dwordx4 v[188:191], v7, s[12:15], s42 offen offset:1792 sc1
    buffer_load_dwordx4 v[192:195], v8, s[12:15], s42 offen offset:1792 sc1
    s_add_u32 s42, s93, 10
    s_sub_u32 s51, s42, 14
    s_min_u32 s42, s42, s51
    s_mul_i32 s42, s42, 3584
    buffer_load_dwordx4 v[196:199], v7, s[12:15], s42 offen offset:0 sc1
    buffer_load_dwordx4 v[200:203], v8, s[12:15], s42 offen offset:0 sc1
    s_add_u32 s49, s49, 1
    s_cmp_ge_u32 s49, 20000
    s_waitcnt vmcnt(0)
    s_cbranch_scc1 sequential_preLN__sliding_block__mixer_token_mlp__prompt_kernel_g2r10
    v_max_u32 v22, v215, v219
    v_cmp_eq_u32 vcc, -1, v22
    s_cbranch_vccnz sequential_preLN__sliding_block__mixer_token_mlp__prompt_kernel_g2s10
    s_branch sequential_preLN__sliding_block__mixer_token_mlp__prompt_kernel_g2r10
sequential_preLN__sliding_block__mixer_token_mlp__prompt_kernel_g2s11:
    s_add_u32 s42, s93, 5
    s_sub_u32 s51, s42, 14
    s_min_u32 s42, s42, s51
    s_mul_i32 s42, s42, 3584
    buffer_load_dwordx4 v[220:223], v7, s[12:15], s42 offen offset:1792 sc1
    buffer_load_dwordx4 v[224:227], v8, s[12:15], s42 offen offset:1792 sc1
    s_add_u32 s42, s93, 6
    s_sub_u32 s51, s42, 14
    s_min_u32 s42, s42, s51
    s_mul_i32 s42, s42, 3584
    buffer_load_dwordx4 v[132:135], v7, s[12:15], s42 offen offset:0 sc1
    buffer_load_dwordx4 v[136:139], v8, s[12:15], s42 offen offset:0 sc1
    buffer_load_dwordx4 v[140:143], v7, s[12:15], s42 offen offset:1792 sc1
    buffer_load_dwordx4 v[144:147], v8, s[12:15], s42 offen offset:1792 sc1
    s_add_u32 s42, s93, 7
    s_sub_u32 s51, s42, 14
    s_min_u32 s42, s42, s51
    s_mul_i32 s42, s42, 3584
    buffer_load_dwordx4 v[148:151], v7, s[12:15], s42 offen offset:0 sc1
    buffer_load_dwordx4 v[152:155], v8, s[12:15], s42 offen offset:0 sc1
    buffer_load_dwordx4 v[156:159], v7, s[12:15], s42 offen offset:1792 sc1
    buffer_load_dwordx4 v[160:163], v8, s[12:15], s42 offen offset:1792 sc1
    s_add_u32 s42, s93, 8
    s_sub_u32 s51, s42, 14
    s_min_u32 s42, s42, s51
    s_mul_i32 s42, s42, 3584
    buffer_load_dwordx4 v[164:167], v7, s[12:15], s42 offen offset:0 sc1
    buffer_load_dwordx4 v[168:171], v8, s[12:15], s42 offen offset:0 sc1
    buffer_load_dwordx4 v[172:175], v7, s[12:15], s42 offen offset:1792 sc1
    buffer_load_dwordx4 v[176:179], v8, s[12:15], s42 offen offset:1792 sc1
    s_add_u32 s42, s93, 9
    s_sub_u32 s51, s42, 14
    s_min_u32 s42, s42, s51
    s_mul_i32 s42, s42, 3584
    buffer_load_dwordx4 v[180:183], v7, s[12:15], s42 offen offset:0 sc1
    buffer_load_dwordx4 v[184:187], v8, s[12:15], s42 offen offset:0 sc1
    buffer_load_dwordx4 v[188:191], v7, s[12:15], s42 offen offset:1792 sc1
    buffer_load_dwordx4 v[192:195], v8, s[12:15], s42 offen offset:1792 sc1
    s_add_u32 s42, s93, 10
    s_sub_u32 s51, s42, 14
    s_min_u32 s42, s42, s51
    s_mul_i32 s42, s42, 3584
    buffer_load_dwordx4 v[196:199], v7, s[12:15], s42 offen offset:0 sc1
    buffer_load_dwordx4 v[200:203], v8, s[12:15], s42 offen offset:0 sc1
    buffer_load_dwordx4 v[204:207], v7, s[12:15], s42 offen offset:1792 sc1
    buffer_load_dwordx4 v[208:211], v8, s[12:15], s42 offen offset:1792 sc1
    s_add_u32 s49, s49, 1
    s_cmp_ge_u32 s49, 20000
    s_waitcnt vmcnt(0)
    s_cbranch_scc1 sequential_preLN__sliding_block__mixer_token_mlp__prompt_kernel_g2r11
    v_max_u32 v22, v223, v227
    v_cmp_eq_u32 vcc, -1, v22
    s_cbranch_vccnz sequential_preLN__sliding_block__mixer_token_mlp__prompt_kernel_g2s11
    s_branch sequential_preLN__sliding_block__mixer_token_mlp__prompt_kernel_g2r11
sequential_preLN__sliding_block__mixer_token_mlp__prompt_kernel_g2s12:
    s_add_u32 s42, s93, 6
    s_sub_u32 s51, s42, 14
    s_min_u32 s42, s42, s51
    s_mul_i32 s42, s42, 3584
    buffer_load_dwordx4 v[132:135], v7, s[12:15], s42 offen offset:0 sc1
    buffer_load_dwordx4 v[136:139], v8, s[12:15], s42 offen offset:0 sc1
    buffer_load_dwordx4 v[140:143], v7, s[12:15], s42 offen offset:1792 sc1
    buffer_load_dwordx4 v[144:147], v8, s[12:15], s42 offen offset:1792 sc1
    s_add_u32 s42, s93, 7
    s_sub_u32 s51, s42, 14
    s_min_u32 s42, s42, s51
    s_mul_i32 s42, s42, 3584
    buffer_load_dwordx4 v[148:151], v7, s[12:15], s42 offen offset:0 sc1
    buffer_load_dwordx4 v[152:155], v8, s[12:15], s42 offen offset:0 sc1
    buffer_load_dwordx4 v[156:159], v7, s[12:15], s42 offen offset:1792 sc1
    buffer_load_dwordx4 v[160:163], v8, s[12:15], s42 offen offset:1792 sc1
    s_add_u32 s42, s93, 8
    s_sub_u32 s51, s42, 14
    s_min_u32 s42, s42, s51
    s_mul_i32 s42, s42, 3584
    buffer_load_dwordx4 v[164:167], v7, s[12:15], s42 offen offset:0 sc1
    buffer_load_dwordx4 v[168:171], v8, s[12:15], s42 offen offset:0 sc1
    buffer_load_dwordx4 v[172:175], v7, s[12:15], s42 offen offset:1792 sc1
    buffer_load_dwordx4 v[176:179], v8, s[12:15], s42 offen offset:1792 sc1
    s_add_u32 s42, s93, 9
    s_sub_u32 s51, s42, 14
    s_min_u32 s42, s42, s51
    s_mul_i32 s42, s42, 3584
    buffer_load_dwordx4 v[180:183], v7, s[12:15], s42 offen offset:0 sc1
    buffer_load_dwordx4 v[184:187], v8, s[12:15], s42 offen offset:0 sc1
    buffer_load_dwordx4 v[188:191], v7, s[12:15], s42 offen offset:1792 sc1
    buffer_load_dwordx4 v[192:195], v8, s[12:15], s42 offen offset:1792 sc1
    s_add_u32 s42, s93, 10
    s_sub_u32 s51, s42, 14
    s_min_u32 s42, s42, s51
    s_mul_i32 s42, s42, 3584
    buffer_load_dwordx4 v[196:199], v7, s[12:15], s42 offen offset:0 sc1
    buffer_load_dwordx4 v[200:203], v8, s[12:15], s42 offen offset:0 sc1
    buffer_load_dwordx4 v[204:207], v7, s[12:15], s42 offen offset:1792 sc1
    buffer_load_dwordx4 v[208:211], v8, s[12:15], s42 offen offset:1792 sc1
    s_add_u32 s42, s93, 11
    s_sub_u32 s51, s42, 14
    s_min_u32 s42, s42, s51
    s_mul_i32 s42, s42, 3584
    buffer_load_dwordx4 v[212:215], v7, s[12:15], s42 offen offset:0 sc1
    buffer_load_dwordx4 v[216:219], v8, s[12:15], s42 offen offset:0 sc1
    s_add_u32 s49, s49, 1
    s_cmp_ge_u32 s49, 20000
    s_waitcnt vmcnt(0)
    s_cbranch_scc1 sequential_preLN__sliding_block__mixer_token_mlp__prompt_kernel_g2r12
    v_max_u32 v22, v135, v139
    v_cmp_eq_u32 vcc, -1, v22
    s_cbranch_vccnz sequential_preLN__sliding_block__mixer_token_mlp__prompt_kernel_g2s12
    s_branch sequential_preLN__sliding_block__mixer_token_mlp__prompt_kernel_g2r12
sequential_preLN__sliding_block__mixer_token_mlp__prompt_kernel_g2s13:
    s_add_u32 s42, s93, 6
    s_sub_u32 s51, s42, 14
    s_min_u32 s42, s42, s51
    s_mul_i32 s42, s42, 3584
    buffer_load_dwordx4 v[140:143], v7, s[12:15], s42 offen offset:1792 sc1
    buffer_load_dwordx4 v[144:147], v8, s[12:15], s42 offen offset:1792 sc1
    s_add_u32 s42, s93, 7
    s_sub_u32 s51, s42, 14
    s_min_u32 s42, s42, s51
    s_mul_i32 s42, s42, 3584
    buffer_load_dwordx4 v[148:151], v7, s[12:15], s42 offen offset:0 sc1
    buffer_load_dwordx4 v[152:155], v8, s[12:15], s42 offen offset:0 sc1
    buffer_load_dwordx4 v[156:159], v7, s[12:15], s42 offen offset:1792 sc1
    buffer_load_dwordx4 v[160:163], v8, s[12:15], s42 offen offset:1792 sc1
    s_add_u32 s42, s93, 8
    s_sub_u32 s51, s42, 14
    s_min_u32 s42, s42, s51
    s_mul_i32 s42, s42, 3584
    buffer_load_dwordx4 v[164:167], v7, s[12:15], s42 offen offset:0 sc1
    buffer_load_dwordx4 v[168:171], v8, s[12:15], s42 offen offset:0 sc1
    buffer_load_dwordx4 v[172:175], v7, s[12:15], s42 offen offset:1792 sc1
    buffer_load_dwordx4 v[176:179], v8, s[12:15], s42 offen offset:1792 sc1
    s_add_u32 s42, s93, 9
    s_sub_u32 s51, s42, 14
    s_min_u32 s42, s42, s51
    s_mul_i32 s42, s42, 3584
    buffer_load_dwordx4 v[180:183], v7, s[12:15], s42 offen offset:0 sc1
    buffer_load_dwordx4 v[184:187], v8, s[12:15], s42 offen offset:0 sc1
    buffer_load_dwordx4 v[188:191], v7, s[12:15], s42 offen offset:1792 sc1
    buffer_load_dwordx4 v[192:195], v8, s[12:15], s42 offen offset:1792 sc1
    s_add_u32 s42, s93, 10
    s_sub_u32 s51, s42, 14
    s_min_u32 s42, s42, s51
    s_mul_i32 s42, s42, 3584
    buffer_load_dwordx4 v[196:199], v7, s[12:15], s42 offen offset:0 sc1
    buffer_load_dwordx4 v[200:203], v8, s[12:15], s42 offen offset:0 sc1
    buffer_load_dwordx4 v[204:207], v7, s[12:15], s42 offen offset:1792 sc1
    buffer_load_dwordx4 v[208:211], v8, s[12:15], s42 offen offset:1792 sc1
    s_add_u32 s42, s93, 11
    s_sub_u32 s51, s42, 14
    s_min_u32 s42, s42, s51
    s_mul_i32 s42, s42, 3584
    buffer_load_dwordx4 v[212:215], v7, s[12:15], s42 offen offset:0 sc1
    buffer_load_dwordx4 v[216:219], v8, s[12:15], s42 offen offset:0 sc1
    buffer_load_dwordx4 v[220:223], v7, s[12:15], s42 offen offset:1792 sc1
    buffer_load_dwordx4 v[224:227], v8, s[12:15], s42 offen offset:1792 sc1
    s_add_u32 s49, s49, 1
    s_cmp_ge_u32 s49, 20000
    s_waitcnt vmcnt(0)
    s_cbranch_scc1 sequential_preLN__sliding_block__mixer_token_mlp__prompt_kernel_g2r13
    v_max_u32 v22, v143, v147
    v_cmp_eq_u32 vcc, -1, v22
    s_cbranch_vccnz sequential_preLN__sliding_block__mixer_token_mlp__prompt_kernel_g2s13
    s_branch sequential_preLN__sliding_block__mixer_token_mlp__prompt_kernel_g2r13
sequential_preLN__sliding_block__mixer_token_mlp__prompt_kernel_g2s14:
    s_add_u32 s42, s93, 7
    s_sub_u32 s51, s42, 14
    s_min_u32 s42, s42, s51
    s_mul_i32 s42, s42, 3584
    buffer_load_dwordx4 v[148:151], v7, s[12:15], s42 offen offset:0 sc1
    buffer_load_dwordx4 v[152:155], v8, s[12:15], s42 offen offset:0 sc1
    buffer_load_dwordx4 v[156:159], v7, s[12:15], s42 offen offset:1792 sc1
    buffer_load_dwordx4 v[160:163], v8, s[12:15], s42 offen offset:1792 sc1
    s_add_u32 s42, s93, 8
    s_sub_u32 s51, s42, 14
    s_min_u32 s42, s42, s51
    s_mul_i32 s42, s42, 3584
    buffer_load_dwordx4 v[164:167], v7, s[12:15], s42 offen offset:0 sc1
    buffer_load_dwordx4 v[168:171], v8, s[12:15], s42 offen offset:0 sc1
    buffer_load_dwordx4 v[172:175], v7, s[12:15], s42 offen offset:1792 sc1
    buffer_load_dwordx4 v[176:179], v8, s[12:15], s42 offen offset:1792 sc1
    s_add_u32 s42, s93, 9
    s_sub_u32 s51, s42, 14
    s_min_u32 s42, s42, s51
    s_mul_i32 s42, s42, 3584
    buffer_load_dwordx4 v[180:183], v7, s[12:15], s42 offen offset:0 sc1
    buffer_load_dwordx4 v[184:187], v8, s[12:15], s42 offen offset:0 sc1
    buffer_load_dwordx4 v[188:191], v7, s[12:15], s42 offen offset:1792 sc1
    buffer_load_dwordx4 v[192:195], v8, s[12:15], s42 offen offset:1792 sc1
    s_add_u32 s42, s93, 10
    s_sub_u32 s51, s42, 14
    s_min_u32 s42, s42, s51
    s_mul_i32 s42, s42, 3584
    buffer_load_dwordx4 v[196:199], v7, s[12:15], s42 offen offset:0 sc1
    buffer_load_dwordx4 v[200:203], v8, s[12:15], s42 offen offset:0 sc1
    buffer_load_dwordx4 v[204:207], v7, s[12:15], s42 offen offset:1792 sc1
    buffer_load_dwordx4 v[208:211], v8, s[12:15], s42 offen offset:1792 sc1
    s_add_u32 s42, s93, 11
    s_sub_u32 s51, s42, 14
    s_min_u32 s42, s42, s51
    s_mul_i32 s42, s42, 3584
    buffer_load_dwordx4 v[212:215], v7, s[12:15], s42 offen offset:0 sc1
    buffer_load_dwordx4 v[216:219], v8, s[12:15], s42 offen offset:0 sc1
    buffer_load_dwordx4 v[220:223], v7, s[12:15], s42 offen offset:1792 sc1
    buffer_load_dwordx4 v[224:227], v8, s[12:15], s42 offen offset:1792 sc1
    s_add_u32 s42, s93, 12
    s_sub_u32 s51, s42, 14
    s_min_u32 s42, s42, s51
    s_mul_i32 s42, s42, 3584
    buffer_load_dwordx4 v[132:135], v7, s[12:15], s42 offen offset:0 sc1
    buffer_load_dwordx4 v[136:139], v8, s[12:15], s42 offen offset:0 sc1
    s_add_u32 s49, s49, 1
    s_cmp_ge_u32 s49, 20000
    s_waitcnt vmcnt(0)
    s_cbranch_scc1 sequential_preLN__sliding_block__mixer_token_mlp__prompt_kernel_g2r14
    v_max_u32 v22, v151, v155
    v_cmp_eq_u32 vcc, -1, v22
    s_cbranch_vccnz sequential_preLN__sliding_block__mixer_token_mlp__prompt_kernel_g2s14
    s_branch sequential_preLN__sliding_block__mixer_token_mlp__prompt_kernel_g2r14
sequential_preLN__sliding_block__mixer_token_mlp__prompt_kernel_g2s15:
    s_add_u32 s42, s93, 7
    s_sub_u32 s51, s42, 14
    s_min_u32 s42, s42, s51
    s_mul_i32 s42, s42, 3584
    buffer_load_dwordx4 v[156:159], v7, s[12:15], s42 offen offset:1792 sc1
    buffer_load_dwordx4 v[160:163], v8, s[12:15], s42 offen offset:1792 sc1
    s_add_u32 s42, s93, 8
    s_sub_u32 s51, s42, 14
    s_min_u32 s42, s42, s51
    s_mul_i32 s42, s42, 3584
    buffer_load_dwordx4 v[164:167], v7, s[12:15], s42 offen offset:0 sc1
    buffer_load_dwordx4 v[168:171], v8, s[12:15], s42 offen offset:0 sc1
    buffer_load_dwordx4 v[172:175], v7, s[12:15], s42 offen offset:1792 sc1
    buffer_load_dwordx4 v[176:179], v8, s[12:15], s42 offen offset:1792 sc1
    s_add_u32 s42, s93, 9
    s_sub_u32 s51, s42, 14
    s_min_u32 s42, s42, s51
    s_mul_i32 s42, s42, 3584
    buffer_load_dwordx4 v[180:183], v7, s[12:15], s42 offen offset:0 sc1
    buffer_load_dwordx4 v[184:187], v8, s[12:15], s42 offen offset:0 sc1
    buffer_load_dwordx4 v[188:191], v7, s[12:15], s42 offen offset:1792 sc1
    buffer_load_dwordx4 v[192:195], v8, s[12:15], s42 offen offset:1792 sc1
    s_add_u32 s42, s93, 10
    s_sub_u32 s51, s42, 14
    s_min_u32 s42, s42, s51
    s_mul_i32 s42, s42, 3584
    buffer_load_dwordx4 v[196:199], v7, s[12:15], s42 offen offset:0 sc1
    buffer_load_dwordx4 v[200:203], v8, s[12:15], s42 offen offset:0 sc1
    buffer_load_dwordx4 v[204:207], v7, s[12:15], s42 offen offset:1792 sc1
    buffer_load_dwordx4 v[208:211], v8, s[12:15], s42 offen offset:1792 sc1
    s_add_u32 s42, s93, 11
    s_sub_u32 s51, s42, 14
    s_min_u32 s42, s42, s51
    s_mul_i32 s42, s42, 3584
    buffer_load_dwordx4 v[212:215], v7, s[12:15], s42 offen offset:0 sc1
    buffer_load_dwordx4 v[216:219], v8, s[12:15], s42 offen offset:0 sc1
    buffer_load_dwordx4 v[220:223], v7, s[12:15], s42 offen offset:1792 sc1
    buffer_load_dwordx4 v[224:227], v8, s[12:15], s42 offen offset:1792 sc1
    s_add_u32 s42, s93, 12
    s_sub_u32 s51, s42, 14
    s_min_u32 s42, s42, s51
    s_mul_i32 s42, s42, 3584
    buffer_load_dwordx4 v[132:135], v7, s[12:15], s42 offen offset:0 sc1
    buffer_load_dwordx4 v[136:139], v8, s[12:15], s42 offen offset:0 sc1
    buffer_load_dwordx4 v[140:143], v7, s[12:15], s42 offen offset:1792 sc1
    buffer_load_dwordx4 v[144:147], v8, s[12:15], s42 offen offset:1792 sc1
    s_add_u32 s49, s49, 1
    s_cmp_ge_u32 s49, 20000
    s_waitcnt vmcnt(0)
    s_cbranch_scc1 sequential_preLN__sliding_block__mixer_token_mlp__prompt_kernel_g2r15
    v_max_u32 v22, v159, v163
    v_cmp_eq_u32 vcc, -1, v22
    s_cbranch_vccnz sequential_preLN__sliding_block__mixer_token_mlp__prompt_kernel_g2s15
    s_branch sequential_preLN__sliding_block__mixer_token_mlp__prompt_kernel_g2r15
sequential_preLN__sliding_block__mixer_token_mlp__prompt_kernel_g2s16:
    s_add_u32 s42, s93, 8
    s_sub_u32 s51, s42, 14
    s_min_u32 s42, s42, s51
    s_mul_i32 s42, s42, 3584
    buffer_load_dwordx4 v[164:167], v7, s[12:15], s42 offen offset:0 sc1
    buffer_load_dwordx4 v[168:171], v8, s[12:15], s42 offen offset:0 sc1
    buffer_load_dwordx4 v[172:175], v7, s[12:15], s42 offen offset:1792 sc1
    buffer_load_dwordx4 v[176:179], v8, s[12:15], s42 offen offset:1792 sc1
    s_add_u32 s42, s93, 9
    s_sub_u32 s51, s42, 14
    s_min_u32 s42, s42, s51
    s_mul_i32 s42, s42, 3584
    buffer_load_dwordx4 v[180:183], v7, s[12:15], s42 offen offset:0 sc1
    buffer_load_dwordx4 v[184:187], v8, s[12:15], s42 offen offset:0 sc1
    buffer_load_dwordx4 v[188:191], v7, s[12:15], s42 offen offset:1792 sc1
    buffer_load_dwordx4 v[192:195], v8, s[12:15], s42 offen offset:1792 sc1
    s_add_u32 s42, s93, 10
    s_sub_u32 s51, s42, 14
    s_min_u32 s42, s42, s51
    s_mul_i32 s42, s42, 3584
    buffer_load_dwordx4 v[196:199], v7, s[12:15], s42 offen offset:0 sc1
    buffer_load_dwordx4 v[200:203], v8, s[12:15], s42 offen offset:0 sc1
    buffer_load_dwordx4 v[204:207], v7, s[12:15], s42 offen offset:1792 sc1
    buffer_load_dwordx4 v[208:211], v8, s[12:15], s42 offen offset:1792 sc1
    s_add_u32 s42, s93, 11
    s_sub_u32 s51, s42, 14
    s_min_u32 s42, s42, s51
    s_mul_i32 s42, s42, 3584
    buffer_load_dwordx4 v[212:215], v7, s[12:15], s42 offen offset:0 sc1
    buffer_load_dwordx4 v[216:219], v8, s[12:15], s42 offen offset:0 sc1
    buffer_load_dwordx4 v[220:223], v7, s[12:15], s42 offen offset:1792 sc1
    buffer_load_dwordx4 v[224:227], v8, s[12:15], s42 offen offset:1792 sc1
    s_add_u32 s42, s93, 12
    s_sub_u32 s51, s42, 14
    s_min_u32 s42, s42, s51
    s_mul_i32 s42, s42, 3584
    buffer_load_dwordx4 v[132:135], v7, s[12:15], s42 offen offset:0 sc1
    buffer_load_dwordx4 v[136:139], v8, s[12:15], s42 offen offset:0 sc1
    buffer_load_dwordx4 v[140:143], v7, s[12:15], s42 offen offset:1792 sc1
    buffer_load_dwordx4 v[144:147], v8, s[12:15], s42 offen offset:1792 sc1
    s_add_u32 s42, s93, 13
    s_sub_u32 s51, s42, 14
    s_min_u32 s42, s42, s51
    s_mul_i32 s42, s42, 3584
    buffer_load_dwordx4 v[148:151], v7, s[12:15], s42 offen offset:0 sc1
    buffer_load_dwordx4 v[152:155], v8, s[12:15], s42 offen offset:0 sc1
    s_add_u32 s49, s49, 1
    s_cmp_ge_u32 s49, 20000
    s_waitcnt vmcnt(0)
    s_cbranch_scc1 sequential_preLN__sliding_block__mixer_token_mlp__prompt_kernel_g2r16
    v_max_u32 v22, v167, v171
    v_cmp_eq_u32 vcc, -1, v22
    s_cbranch_vccnz sequential_preLN__sliding_block__mixer_token_mlp__prompt_kernel_g2s16
    s_branch sequential_preLN__sliding_block__mixer_token_mlp__prompt_kernel_g2r16
sequential_preLN__sliding_block__mixer_token_mlp__prompt_kernel_g2s17:
    s_add_u32 s42, s93, 8
    s_sub_u32 s51, s42, 14
    s_min_u32 s42, s42, s51
    s_mul_i32 s42, s42, 3584
    buffer_load_dwordx4 v[172:175], v7, s[12:15], s42 offen offset:1792 sc1
    buffer_load_dwordx4 v[176:179], v8, s[12:15], s42 offen offset:1792 sc1
    s_add_u32 s42, s93, 9
    s_sub_u32 s51, s42, 14
    s_min_u32 s42, s42, s51
    s_mul_i32 s42, s42, 3584
    buffer_load_dwordx4 v[180:183], v7, s[12:15], s42 offen offset:0 sc1
    buffer_load_dwordx4 v[184:187], v8, s[12:15], s42 offen offset:0 sc1
    buffer_load_dwordx4 v[188:191], v7, s[12:15], s42 offen offset:1792 sc1
    buffer_load_dwordx4 v[192:195], v8, s[12:15], s42 offen offset:1792 sc1
    s_add_u32 s42, s93, 10
    s_sub_u32 s51, s42, 14
    s_min_u32 s42, s42, s51
    s_mul_i32 s42, s42, 3584
    buffer_load_dwordx4 v[196:199], v7, s[12:15], s42 offen offset:0 sc1
    buffer_load_dwordx4 v[200:203], v8, s[12:15], s42 offen offset:0 sc1
    buffer_load_dwordx4 v[204:207], v7, s[12:15], s42 offen offset:1792 sc1
    buffer_load_dwordx4 v[208:211], v8, s[12:15], s42 offen offset:1792 sc1
    s_add_u32 s42, s93, 11
    s_sub_u32 s51, s42, 14
    s_min_u32 s42, s42, s51
    s_mul_i32 s42, s42, 3584
    buffer_load_dwordx4 v[212:215], v7, s[12:15], s42 offen offset:0 sc1
    buffer_load_dwordx4 v[216:219], v8, s[12:15], s42 offen offset:0 sc1
    buffer_load_dwordx4 v[220:223], v7, s[12:15], s42 offen offset:1792 sc1
    buffer_load_dwordx4 v[224:227], v8, s[12:15], s42 offen offset:1792 sc1
    s_add_u32 s42, s93, 12
    s_sub_u32 s51, s42, 14
    s_min_u32 s42, s42, s51
    s_mul_i32 s42, s42, 3584
    buffer_load_dwordx4 v[132:135], v7, s[12:15], s42 offen offset:0 sc1
    buffer_load_dwordx4 v[136:139], v8, s[12:15], s42 offen offset:0 sc1
    buffer_load_dwordx4 v[140:143], v7, s[12:15], s42 offen offset:1792 sc1
    buffer_load_dwordx4 v[144:147], v8, s[12:15], s42 offen offset:1792 sc1
    s_add_u32 s42, s93, 13
    s_sub_u32 s51, s42, 14
    s_min_u32 s42, s42, s51
    s_mul_i32 s42, s42, 3584
    buffer_load_dwordx4 v[148:151], v7, s[12:15], s42 offen offset:0 sc1
    buffer_load_dwordx4 v[152:155], v8, s[12:15], s42 offen offset:0 sc1
    buffer_load_dwordx4 v[156:159], v7, s[12:15], s42 offen offset:1792 sc1
    buffer_load_dwordx4 v[160:163], v8, s[12:15], s42 offen offset:1792 sc1
    s_add_u32 s49, s49, 1
    s_cmp_ge_u32 s49, 20000
    s_waitcnt vmcnt(0)
    s_cbranch_scc1 sequential_preLN__sliding_block__mixer_token_mlp__prompt_kernel_g2r17
    v_max_u32 v22, v175, v179
    v_cmp_eq_u32 vcc, -1, v22
    s_cbranch_vccnz sequential_preLN__sliding_block__mixer_token_mlp__prompt_kernel_g2s17
    s_branch sequential_preLN__sliding_block__mixer_token_mlp__prompt_kernel_g2r17
sequential_preLN__sliding_block__mixer_token_mlp__prompt_kernel_g2s18:
    s_add_u32 s42, s93, 9
    s_sub_u32 s51, s42, 14
    s_min_u32 s42, s42, s51
    s_mul_i32 s42, s42, 3584
    buffer_load_dwordx4 v[180:183], v7, s[12:15], s42 offen offset:0 sc1
    buffer_load_dwordx4 v[184:187], v8, s[12:15], s42 offen offset:0 sc1
    buffer_load_dwordx4 v[188:191], v7, s[12:15], s42 offen offset:1792 sc1
    buffer_load_dwordx4 v[192:195], v8, s[12:15], s42 offen offset:1792 sc1
    s_add_u32 s42, s93, 10
    s_sub_u32 s51, s42, 14
    s_min_u32 s42, s42, s51
    s_mul_i32 s42, s42, 3584
    buffer_load_dwordx4 v[196:199], v7, s[12:15], s42 offen offset:0 sc1
    buffer_load_dwordx4 v[200:203], v8, s[12:15], s42 offen offset:0 sc1
    buffer_load_dwordx4 v[204:207], v7, s[12:15], s42 offen offset:1792 sc1
    buffer_load_dwordx4 v[208:211], v8, s[12:15], s42 offen offset:1792 sc1
    s_add_u32 s42, s93, 11
    s_sub_u32 s51, s42, 14
    s_min_u32 s42, s42, s51
    s_mul_i32 s42, s42, 3584
    buffer_load_dwordx4 v[212:215], v7, s[12:15], s42 offen offset:0 sc1
    buffer_load_dwordx4 v[216:219], v8, s[12:15], s42 offen offset:0 sc1
    buffer_load_dwordx4 v[220:223], v7, s[12:15], s42 offen offset:1792 sc1
    buffer_load_dwordx4 v[224:227], v8, s[12:15], s42 offen offset:1792 sc1
    s_add_u32 s42, s93, 12
    s_sub_u32 s51, s42, 14
    s_min_u32 s42, s42, s51
    s_mul_i32 s42, s42, 3584
    buffer_load_dwordx4 v[132:135], v7, s[12:15], s42 offen offset:0 sc1
    buffer_load_dwordx4 v[136:139], v8, s[12:15], s42 offen offset:0 sc1
    buffer_load_dwordx4 v[140:143], v7, s[12:15], s42 offen offset:1792 sc1
    buffer_load_dwordx4 v[144:147], v8, s[12:15], s42 offen offset:1792 sc1
    s_add_u32 s42, s93, 13
    s_sub_u32 s51, s42, 14
    s_min_u32 s42, s42, s51
    s_mul_i32 s42, s42, 3584
    buffer_load_dwordx4 v[148:151], v7, s[12:15], s42 offen offset:0 sc1
    buffer_load_dwordx4 v[152:155], v8, s[12:15], s42 offen offset:0 sc1
    buffer_load_dwordx4 v[156:159], v7, s[12:15], s42 offen offset:1792 sc1
    buffer_load_dwordx4 v[160:163], v8, s[12:15], s42 offen offset:1792 sc1
    s_add_u32 s49, s49, 1
    s_cmp_ge_u32 s49, 20000
    s_waitcnt vmcnt(0)
    s_cbranch_scc1 sequential_preLN__sliding_block__mixer_token_mlp__prompt_kernel_g2r18
    v_max_u32 v22, v183, v187
    v_cmp_eq_u32 vcc, -1, v22
    s_cbranch_vccnz sequential_preLN__sliding_block__mixer_token_mlp__prompt_kernel_g2s18
    s_branch sequential_preLN__sliding_block__mixer_token_mlp__prompt_kernel_g2r18
sequential_preLN__sliding_block__mixer_token_mlp__prompt_kernel_g2s19:
    s_add_u32 s42, s93, 9
    s_sub_u32 s51, s42, 14
    s_min_u32 s42, s42, s51
    s_mul_i32 s42, s42, 3584
    buffer_load_dwordx4 v[188:191], v7, s[12:15], s42 offen offset:1792 sc1
    buffer_load_dwordx4 v[192:195], v8, s[12:15], s42 offen offset:1792 sc1
    s_add_u32 s42, s93, 10
    s_sub_u32 s51, s42, 14
    s_min_u32 s42, s42, s51
    s_mul_i32 s42, s42, 3584
    buffer_load_dwordx4 v[196:199], v7, s[12:15], s42 offen offset:0 sc1
    buffer_load_dwordx4 v[200:203], v8, s[12:15], s42 offen offset:0 sc1
    buffer_load_dwordx4 v[204:207], v7, s[12:15], s42 offen offset:1792 sc1
    buffer_load_dwordx4 v[208:211], v8, s[12:15], s42 offen offset:1792 sc1
    s_add_u32 s42, s93, 11
    s_sub_u32 s51, s42, 14
    s_min_u32 s42, s42, s51
    s_mul_i32 s42, s42, 3584
    buffer_load_dwordx4 v[212:215], v7, s[12:15], s42 offen offset:0 sc1
    buffer_load_dwordx4 v[216:219], v8, s[12:15], s42 offen offset:0 sc1
    buffer_load_dwordx4 v[220:223], v7, s[12:15], s42 offen offset:1792 sc1
    buffer_load_dwordx4 v[224:227], v8, s[12:15], s42 offen offset:1792 sc1
    s_add_u32 s42, s93, 12
    s_sub_u32 s51, s42, 14
    s_min_u32 s42, s42, s51
    s_mul_i32 s42, s42, 3584
    buffer_load_dwordx4 v[132:135], v7, s[12:15], s42 offen offset:0 sc1
    buffer_load_dwordx4 v[136:139], v8, s[12:15], s42 offen offset:0 sc1
    buffer_load_dwordx4 v[140:143], v7, s[12:15], s42 offen offset:1792 sc1
    buffer_load_dwordx4 v[144:147], v8, s[12:15], s42 offen offset:1792 sc1
    s_add_u32 s42, s93, 13
    s_sub_u32 s51, s42, 14
    s_min_u32 s42, s42, s51
    s_mul_i32 s42, s42, 3584
    buffer_load_dwordx4 v[148:151], v7, s[12:15], s42 offen offset:0 sc1
    buffer_load_dwordx4 v[152:155], v8, s[12:15], s42 offen offset:0 sc1
    buffer_load_dwordx4 v[156:159], v7, s[12:15], s42 offen offset:1792 sc1
    buffer_load_dwordx4 v[160:163], v8, s[12:15], s42 offen offset:1792 sc1
    s_add_u32 s49, s49, 1
    s_cmp_ge_u32 s49, 20000
    s_waitcnt vmcnt(0)
    s_cbranch_scc1 sequential_preLN__sliding_block__mixer_token_mlp__prompt_kernel_g2r19
    v_max_u32 v22, v191, v195
    v_cmp_eq_u32 vcc, -1, v22
    s_cbranch_vccnz sequential_preLN__sliding_block__mixer_token_mlp__prompt_kernel_g2s19
    s_branch sequential_preLN__sliding_block__mixer_token_mlp__prompt_kernel_g2r19
sequential_preLN__sliding_block__mixer_token_mlp__prompt_kernel_g2s20:
    s_add_u32 s42, s93, 10
    s_sub_u32 s51, s42, 14
    s_min_u32 s42, s42, s51
    s_mul_i32 s42, s42, 3584
    buffer_load_dwordx4 v[196:199], v7, s[12:15], s42 offen offset:0 sc1
    buffer_load_dwordx4 v[200:203], v8, s[12:15], s42 offen offset:0 sc1
    buffer_load_dwordx4 v[204:207], v7, s[12:15], s42 offen offset:1792 sc1
    buffer_load_dwordx4 v[208:211], v8, s[12:15], s42 offen offset:1792 sc1
    s_add_u32 s42, s93, 11
    s_sub_u32 s51, s42, 14
    s_min_u32 s42, s42, s51
    s_mul_i32 s42, s42, 3584
    buffer_load_dwordx4 v[212:215], v7, s[12:15], s42 offen offset:0 sc1
    buffer_load_dwordx4 v[216:219], v8, s[12:15], s42 offen offset:0 sc1
    buffer_load_dwordx4 v[220:223], v7, s[12:15], s42 offen offset:1792 sc1
    buffer_load_dwordx4 v[224:227], v8, s[12:15], s42 offen offset:1792 sc1
    s_add_u32 s42, s93, 12
    s_sub_u32 s51, s42, 14
    s_min_u32 s42, s42, s51
    s_mul_i32 s42, s42, 3584
    buffer_load_dwordx4 v[132:135], v7, s[12:15], s42 offen offset:0 sc1
    buffer_load_dwordx4 v[136:139], v8, s[12:15], s42 offen offset:0 sc1
    buffer_load_dwordx4 v[140:143], v7, s[12:15], s42 offen offset:1792 sc1
    buffer_load_dwordx4 v[144:147], v8, s[12:15], s42 offen offset:1792 sc1
    s_add_u32 s42, s93, 13
    s_sub_u32 s51, s42, 14
    s_min_u32 s42, s42, s51
    s_mul_i32 s42, s42, 3584
    buffer_load_dwordx4 v[148:151], v7, s[12:15], s42 offen offset:0 sc1
    buffer_load_dwordx4 v[152:155], v8, s[12:15], s42 offen offset:0 sc1
    buffer_load_dwordx4 v[156:159], v7, s[12:15], s42 offen offset:1792 sc1
    buffer_load_dwordx4 v[160:163], v8, s[12:15], s42 offen offset:1792 sc1
    s_add_u32 s49, s49, 1
    s_cmp_ge_u32 s49, 20000
    s_waitcnt vmcnt(0)
    s_cbranch_scc1 sequential_preLN__sliding_block__mixer_token_mlp__prompt_kernel_g2r20
    v_max_u32 v22, v199, v203
    v_cmp_eq_u32 vcc, -1, v22
    s_cbranch_vccnz sequential_preLN__sliding_block__mixer_token_mlp__prompt_kernel_g2s20
    s_branch sequential_preLN__sliding_block__mixer_token_mlp__prompt_kernel_g2r20
sequential_preLN__sliding_block__mixer_token_mlp__prompt_kernel_g2s21:
    s_add_u32 s42, s93, 10
    s_sub_u32 s51, s42, 14
    s_min_u32 s42, s42, s51
    s_mul_i32 s42, s42, 3584
    buffer_load_dwordx4 v[204:207], v7, s[12:15], s42 offen offset:1792 sc1
    buffer_load_dwordx4 v[208:211], v8, s[12:15], s42 offen offset:1792 sc1
    s_add_u32 s42, s93, 11
    s_sub_u32 s51, s42, 14
    s_min_u32 s42, s42, s51
    s_mul_i32 s42, s42, 3584
    buffer_load_dwordx4 v[212:215], v7, s[12:15], s42 offen offset:0 sc1
    buffer_load_dwordx4 v[216:219], v8, s[12:15], s42 offen offset:0 sc1
    buffer_load_dwordx4 v[220:223], v7, s[12:15], s42 offen offset:1792 sc1
    buffer_load_dwordx4 v[224:227], v8, s[12:15], s42 offen offset:1792 sc1
    s_add_u32 s42, s93, 12
    s_sub_u32 s51, s42, 14
    s_min_u32 s42, s42, s51
    s_mul_i32 s42, s42, 3584
    buffer_load_dwordx4 v[132:135], v7, s[12:15], s42 offen offset:0 sc1
    buffer_load_dwordx4 v[136:139], v8, s[12:15], s42 offen offset:0 sc1
    buffer_load_dwordx4 v[140:143], v7, s[12:15], s42 offen offset:1792 sc1
    buffer_load_dwordx4 v[144:147], v8, s[12:15], s42 offen offset:1792 sc1
    s_add_u32 s42, s93, 13
    s_sub_u32 s51, s42, 14
    s_min_u32 s42, s42, s51
    s_mul_i32 s42, s42, 3584
    buffer_load_dwordx4 v[148:151], v7, s[12:15], s42 offen offset:0 sc1
    buffer_load_dwordx4 v[152:155], v8, s[12:15], s42 offen offset:0 sc1
    buffer_load_dwordx4 v[156:159], v7, s[12:15], s42 offen offset:1792 sc1
    buffer_load_dwordx4 v[160:163], v8, s[12:15], s42 offen offset:1792 sc1
    s_add_u32 s49, s49, 1
    s_cmp_ge_u32 s49, 20000
    s_waitcnt vmcnt(0)
    s_cbranch_scc1 sequential_preLN__sliding_block__mixer_token_mlp__prompt_kernel_g2r21
    v_max_u32 v22, v207, v211
    v_cmp_eq_u32 vcc, -1, v22
    s_cbranch_vccnz sequential_preLN__sliding_block__mixer_token_mlp__prompt_kernel_g2s21
    s_branch sequential_preLN__sliding_block__mixer_token_mlp__prompt_kernel_g2r21
sequential_preLN__sliding_block__mixer_token_mlp__prompt_kernel_g2s22:
    s_add_u32 s42, s93, 11
    s_sub_u32 s51, s42, 14
    s_min_u32 s42, s42, s51
    s_mul_i32 s42, s42, 3584
    buffer_load_dwordx4 v[212:215], v7, s[12:15], s42 offen offset:0 sc1
    buffer_load_dwordx4 v[216:219], v8, s[12:15], s42 offen offset:0 sc1
    buffer_load_dwordx4 v[220:223], v7, s[12:15], s42 offen offset:1792 sc1
    buffer_load_dwordx4 v[224:227], v8, s[12:15], s42 offen offset:1792 sc1
    s_add_u32 s42, s93, 12
    s_sub_u32 s51, s42, 14
    s_min_u32 s42, s42, s51
    s_mul_i32 s42, s42, 3584
    buffer_load_dwordx4 v[132:135], v7, s[12:15], s42 offen offset:0 sc1
    buffer_load_dwordx4 v[136:139], v8, s[12:15], s42 offen offset:0 sc1
    buffer_load_dwordx4 v[140:143], v7, s[12:15], s42 offen offset:1792 sc1
    buffer_load_dwordx4 v[144:147], v8, s[12:15], s42 offen offset:1792 sc1
    s_add_u32 s42, s93, 13
    s_sub_u32 s51, s42, 14
    s_min_u32 s42, s42, s51
    s_mul_i32 s42, s42, 3584
    buffer_load_dwordx4 v[148:151], v7, s[12:15], s42 offen offset:0 sc1
    buffer_load_dwordx4 v[152:155], v8, s[12:15], s42 offen offset:0 sc1
    buffer_load_dwordx4 v[156:159], v7, s[12:15], s42 offen offset:1792 sc1
    buffer_load_dwordx4 v[160:163], v8, s[12:15], s42 offen offset:1792 sc1
    s_add_u32 s49, s49, 1
    s_cmp_ge_u32 s49, 20000
    s_waitcnt vmcnt(0)
    s_cbranch_scc1 sequential_preLN__sliding_block__mixer_token_mlp__prompt_kernel_g2r22
    v_max_u32 v22, v215, v219
    v_cmp_eq_u32 vcc, -1, v22
    s_cbranch_vccnz sequential_preLN__sliding_block__mixer_token_mlp__prompt_kernel_g2s22
    s_branch sequential_preLN__sliding_block__mixer_token_mlp__prompt_kernel_g2r22
sequential_preLN__sliding_block__mixer_token_mlp__prompt_kernel_g2s23:
    s_add_u32 s42, s93, 11
    s_sub_u32 s51, s42, 14
    s_min_u32 s42, s42, s51
    s_mul_i32 s42, s42, 3584
    buffer_load_dwordx4 v[220:223], v7, s[12:15], s42 offen offset:1792 sc1
    buffer_load_dwordx4 v[224:227], v8, s[12:15], s42 offen offset:1792 sc1
    s_add_u32 s42, s93, 12
    s_sub_u32 s51, s42, 14
    s_min_u32 s42, s42, s51
    s_mul_i32 s42, s42, 3584
    buffer_load_dwordx4 v[132:135], v7, s[12:15], s42 offen offset:0 sc1
    buffer_load_dwordx4 v[136:139], v8, s[12:15], s42 offen offset:0 sc1
    buffer_load_dwordx4 v[140:143], v7, s[12:15], s42 offen offset:1792 sc1
    buffer_load_dwordx4 v[144:147], v8, s[12:15], s42 offen offset:1792 sc1
    s_add_u32 s42, s93, 13
    s_sub_u32 s51, s42, 14
    s_min_u32 s42, s42, s51
    s_mul_i32 s42, s42, 3584
    buffer_load_dwordx4 v[148:151], v7, s[12:15], s42 offen offset:0 sc1
    buffer_load_dwordx4 v[152:155], v8, s[12:15], s42 offen offset:0 sc1
    buffer_load_dwordx4 v[156:159], v7, s[12:15], s42 offen offset:1792 sc1
    buffer_load_dwordx4 v[160:163], v8, s[12:15], s42 offen offset:1792 sc1
    s_add_u32 s49, s49, 1
    s_cmp_ge_u32 s49, 20000
    s_waitcnt vmcnt(0)
    s_cbranch_scc1 sequential_preLN__sliding_block__mixer_token_mlp__prompt_kernel_g2r23
    v_max_u32 v22, v223, v227
    v_cmp_eq_u32 vcc, -1, v22
    s_cbranch_vccnz sequential_preLN__sliding_block__mixer_token_mlp__prompt_kernel_g2s23
    s_branch sequential_preLN__sliding_block__mixer_token_mlp__prompt_kernel_g2r23
sequential_preLN__sliding_block__mixer_token_mlp__prompt_kernel_g2s24:
    s_add_u32 s42, s93, 12
    s_sub_u32 s51, s42, 14
    s_min_u32 s42, s42, s51
    s_mul_i32 s42, s42, 3584
    buffer_load_dwordx4 v[132:135], v7, s[12:15], s42 offen offset:0 sc1
    buffer_load_dwordx4 v[136:139], v8, s[12:15], s42 offen offset:0 sc1
    buffer_load_dwordx4 v[140:143], v7, s[12:15], s42 offen offset:1792 sc1
    buffer_load_dwordx4 v[144:147], v8, s[12:15], s42 offen offset:1792 sc1
    s_add_u32 s42, s93, 13
    s_sub_u32 s51, s42, 14
    s_min_u32 s42, s42, s51
    s_mul_i32 s42, s42, 3584
    buffer_load_dwordx4 v[148:151], v7, s[12:15], s42 offen offset:0 sc1
    buffer_load_dwordx4 v[152:155], v8, s[12:15], s42 offen offset:0 sc1
    buffer_load_dwordx4 v[156:159], v7, s[12:15], s42 offen offset:1792 sc1
    buffer_load_dwordx4 v[160:163], v8, s[12:15], s42 offen offset:1792 sc1
    s_add_u32 s49, s49, 1
    s_cmp_ge_u32 s49, 20000
    s_waitcnt vmcnt(0)
    s_cbranch_scc1 sequential_preLN__sliding_block__mixer_token_mlp__prompt_kernel_g2r24
    v_max_u32 v22, v135, v139
    v_cmp_eq_u32 vcc, -1, v22
    s_cbranch_vccnz sequential_preLN__sliding_block__mixer_token_mlp__prompt_kernel_g2s24
    s_branch sequential_preLN__sliding_block__mixer_token_mlp__prompt_kernel_g2r24
sequential_preLN__sliding_block__mixer_token_mlp__prompt_kernel_g2s25:
    s_add_u32 s42, s93, 12
    s_sub_u32 s51, s42, 14
    s_min_u32 s42, s42, s51
    s_mul_i32 s42, s42, 3584
    buffer_load_dwordx4 v[140:143], v7, s[12:15], s42 offen offset:1792 sc1
    buffer_load_dwordx4 v[144:147], v8, s[12:15], s42 offen offset:1792 sc1
    s_add_u32 s42, s93, 13
    s_sub_u32 s51, s42, 14
    s_min_u32 s42, s42, s51
    s_mul_i32 s42, s42, 3584
    buffer_load_dwordx4 v[148:151], v7, s[12:15], s42 offen offset:0 sc1
    buffer_load_dwordx4 v[152:155], v8, s[12:15], s42 offen offset:0 sc1
    buffer_load_dwordx4 v[156:159], v7, s[12:15], s42 offen offset:1792 sc1
    buffer_load_dwordx4 v[160:163], v8, s[12:15], s42 offen offset:1792 sc1
    s_add_u32 s49, s49, 1
    s_cmp_ge_u32 s49, 20000
    s_waitcnt vmcnt(0)
    s_cbranch_scc1 sequential_preLN__sliding_block__mixer_token_mlp__prompt_kernel_g2r25
    v_max_u32 v22, v143, v147
    v_cmp_eq_u32 vcc, -1, v22
    s_cbranch_vccnz sequential_preLN__sliding_block__mixer_token_mlp__prompt_kernel_g2s25
    s_branch sequential_preLN__sliding_block__mixer_token_mlp__prompt_kernel_g2r25
sequential_preLN__sliding_block__mixer_token_mlp__prompt_kernel_g2s26:
    s_add_u32 s42, s93, 13
    s_sub_u32 s51, s42, 14
    s_min_u32 s42, s42, s51
    s_mul_i32 s42, s42, 3584
    buffer_load_dwordx4 v[148:151], v7, s[12:15], s42 offen offset:0 sc1
    buffer_load_dwordx4 v[152:155], v8, s[12:15], s42 offen offset:0 sc1
    buffer_load_dwordx4 v[156:159], v7, s[12:15], s42 offen offset:1792 sc1
    buffer_load_dwordx4 v[160:163], v8, s[12:15], s42 offen offset:1792 sc1
    s_add_u32 s49, s49, 1
    s_cmp_ge_u32 s49, 20000
    s_waitcnt vmcnt(0)
    s_cbranch_scc1 sequential_preLN__sliding_block__mixer_token_mlp__prompt_kernel_g2r26
    v_max_u32 v22, v151, v155
    v_cmp_eq_u32 vcc, -1, v22
    s_cbranch_vccnz sequential_preLN__sliding_block__mixer_token_mlp__prompt_kernel_g2s26
    s_branch sequential_preLN__sliding_block__mixer_token_mlp__prompt_kernel_g2r26
sequential_preLN__sliding_block__mixer_token_mlp__prompt_kernel_g2s27:
    s_add_u32 s42, s93, 13
    s_sub_u32 s51, s42, 14
    s_min_u32 s42, s42, s51
    s_mul_i32 s42, s42, 3584
    buffer_load_dwordx4 v[156:159], v7, s[12:15], s42 offen offset:1792 sc1
    buffer_load_dwordx4 v[160:163], v8, s[12:15], s42 offen offset:1792 sc1
    s_add_u32 s49, s49, 1
    s_cmp_ge_u32 s49, 20000
    s_waitcnt vmcnt(0)
    s_cbranch_scc1 sequential_preLN__sliding_block__mixer_token_mlp__prompt_kernel_g2r27
    v_max_u32 v22, v159, v163
    v_cmp_eq_u32 vcc, -1, v22
    s_cbranch_vccnz sequential_preLN__sliding_block__mixer_token_mlp__prompt_kernel_g2s27
    s_branch sequential_preLN__sliding_block__mixer_token_mlp__prompt_kernel_g2r27
sequential_preLN__sliding_block__mixer_token_mlp__prompt_kernel_nbk:
    s_mov_b32 s49, 0
sequential_preLN__sliding_block__mixer_token_mlp__prompt_kernel_nlk:
    buffer_load_dwordx4 v[112:115], v2, s[12:15], s95 offen offset:0 sc1
    buffer_load_dwordx4 v[116:119], v2, s[12:15], s95 offen offset:1024 sc1
    buffer_load_dwordx4 v[120:123], v2, s[12:15], s95 offen offset:2048 sc1
    buffer_load_dwordx4 v[124:127], v2, s[12:15], s95 offen offset:3072 sc1
    s_add_u32 s49, s49, 1
    s_cmp_ge_u32 s49, 20000
    s_waitcnt vmcnt(0)
    s_cbranch_scc1 sequential_preLN__sliding_block__mixer_token_mlp__prompt_kernel_nrk
    v_max3_u32 v26, v115, v119, v123
    v_max_u32 v26, v26, v127
    v_cmp_eq_u32 vcc, -1, v26
    s_cbranch_vccnz sequential_preLN__sliding_block__mixer_token_mlp__prompt_kernel_nlk
    s_branch sequential_preLN__sliding_block__mixer_token_mlp__prompt_kernel_nrk
sequential_preLN__sliding_block__mixer_token_mlp__prompt_kernel_nbv:
    s_mov_b32 s49, 0
sequential_preLN__sliding_block__mixer_token_mlp__prompt_kernel_nlv:
    buffer_load_dwordx4 v[184:187], v2, s[12:15], s100 offen offset:0 sc1
    buffer_load_dwordx4 v[188:191], v2, s[12:15], s100 offen offset:1024 sc1
    buffer_load_dwordx4 v[192:195], v2, s[12:15], s100 offen offset:2048 sc1
    buffer_load_dwordx4 v[196:199], v2, s[12:15], s100 offen offset:3072 sc1
    s_add_u32 s49, s49, 1
    s_cmp_ge_u32 s49, 20000
    s_waitcnt vmcnt(0)
    s_cbranch_scc1 sequential_preLN__sliding_block__mixer_token_mlp__prompt_kernel_nrv
    v_max3_u32 v26, v187, v191, v195
    v_max_u32 v26, v26, v199
    v_cmp_eq_u32 vcc, -1, v26
    s_cbranch_vccnz sequential_preLN__sliding_block__mixer_token_mlp__prompt_kernel_nlv
    s_branch sequential_preLN__sliding_block__mixer_token_mlp__prompt_kernel_nrv
sequential_preLN__sliding_block__mixer_token_mlp__prompt_kernel_done:
    s_endpgm
.section .rodata,"a"
.p2align 6
.amdhsa_kernel sequential_preLN__sliding_block__mixer_token_mlp__prompt_kernel
.amdhsa_next_free_vgpr 512
.amdhsa_next_free_sgpr 102
.amdhsa_accum_offset 256
.amdhsa_group_segment_fixed_size 0
.amdhsa_kernarg_size 88
.amdhsa_user_sgpr_count 2
.amdhsa_user_sgpr_kernarg_segment_ptr 1
.amdhsa_system_sgpr_workgroup_id_x 1
.amdhsa_float_denorm_mode_32 3
.end_amdhsa_kernel
```
